```python
import torch

def _softmax(x, axis=-1):
    return torch.softmax(x, dim=axis)
def _gelu(x):
    return torch.nn.functional.gelu(x, approximate="tanh")
def _silu(x):
    return torch.nn.functional.silu(x)
def _sigmoid(x):
    return torch.sigmoid(x)
def _layernorm(x, axis=-1, eps=1e-5):
    m = x.mean(dim=axis, keepdim=True)
    v = x.var(dim=axis, keepdim=True, unbiased=False)
    return (x - m) / torch.sqrt(v + eps)
def _scatter_add(tgt, idx, src, axis=0):
    return tgt.clone().index_add_(axis, idx, src)
def _segment_sum(src, seg, n):
    out = torch.zeros((n,) + src.shape[1:], dtype=src.dtype)
    return out.index_add_(0, seg, src)
def _pad(x, pw):
    flat = tuple(v for pair in reversed(pw) for v in pair)
    return torch.nn.functional.pad(x, flat)

kernel_name = 'recurrent_scan__ssm_conv_s5__glu_gated_geglu__prompt'

def setup_inputs():

    _w = (lambda a: (lambda t: t.to(torch.bfloat16) if t.is_floating_point() else t)(torch.as_tensor(a)))
    def _A_setup():
        B, S, D = 1, 2048, 512
        P = D
        Lambda_re = -0.5 * (lambda _x: torch.exp(torch.as_tensor(_x)))((lambda *s: torch.randn(*s, dtype=torch.bfloat16) * 0.8)(P))
        Lambda_im = (lambda *s: torch.randn(*s, dtype=torch.bfloat16) * 0.8)(P) * 1.0
        B_re = (lambda *s: torch.randn(*s, dtype=torch.bfloat16) * 1.6)(P, D) * (D ** -0.5)
        B_im = (lambda *s: torch.randn(*s, dtype=torch.bfloat16) * 0.8)(P, D) * (D ** -0.5)
        C_re = (lambda *s: torch.randn(*s, dtype=torch.bfloat16) * 1.6)(D, P) * (P ** -0.5)
        C_im = (lambda *s: torch.randn(*s, dtype=torch.bfloat16) * 1.6)(D, P) * (P ** -0.5)
        log_dt = (lambda *s: torch.randn(*s, dtype=torch.bfloat16) * 0.8)(P) * 0.3 - 2.0
        Dskip = (lambda *s: torch.randn(*s, dtype=torch.bfloat16) * 0.8)(D)
        return {
            "x": _w((lambda *s: torch.randn(*s, dtype=torch.bfloat16) * 0.05)(B, S, D)),
            "Lambda_re": _w(Lambda_re),
            "Lambda_im": _w(Lambda_im),
            "B_re": _w(B_re),
            "B_im": _w(B_im),
            "C_re": _w(C_re),
            "C_im": _w(C_im),
            "log_dt": _w(log_dt),
            "Dskip": _w(Dskip),
        }
    _A_in = _A_setup()

    def _B_setup():
        B, S, Dm, Df = 1, 2048, 512, 1376
        return {
            "x": _w((lambda *s: torch.randn(*s, dtype=torch.bfloat16) * 0.05)(B, S, Dm)),
            "w_gate": _w((lambda *s: torch.randn(*s, dtype=torch.bfloat16) * 0.2)(Dm, Df) * (Dm ** -0.5)),
            "w_up": _w((lambda *s: torch.randn(*s, dtype=torch.bfloat16) * 0.2)(Dm, Df) * (Dm ** -0.5)),
            "w_down": _w((lambda *s: torch.randn(*s, dtype=torch.bfloat16) * 0.2)(Df, Dm) * (Df ** -0.5)),
        }
    _B_in = _B_setup()

    return {
        "A_x": _A_in["x"],
        "A_Lambda_re": _A_in["Lambda_re"],
        "A_Lambda_im": _A_in["Lambda_im"],
        "A_B_re": _A_in["B_re"],
        "A_B_im": _A_in["B_im"],
        "A_C_re": _A_in["C_re"],
        "A_C_im": _A_in["C_im"],
        "A_log_dt": _A_in["log_dt"],
        "A_Dskip": _A_in["Dskip"],
        "B_x": _B_in["x"],
        "B_w_gate": _B_in["w_gate"],
        "B_w_up": _B_in["w_up"],
        "B_w_down": _B_in["w_down"],
    }

def reference(A_x, A_Lambda_re, A_Lambda_im, A_B_re, A_B_im, A_C_re, A_C_im, A_log_dt, A_Dskip, B_x, B_w_gate, B_w_up, B_w_down):
    def _A_ref(x, Lambda_re, Lambda_im, B_re, B_im, C_re, C_im, log_dt, Dskip):
        Bsz, L, H = x.shape
        Lam = Lambda_re + 1j * Lambda_im
        Bmat = B_re + 1j * B_im
        Cmat = C_re + 1j * C_im
        dt = torch.exp(log_dt)
        Lam_bar = torch.exp(dt * Lam)
        B_bar = ((Lam_bar - 1.0) / Lam)[:, None] * Bmat
        Bu = torch.einsum("bld,pd->blp", x + 0j, B_bar)
        h = torch.zeros_like(Bu[:, 0, :])
        hs = []
        for t in range(L):
            h = Lam_bar[None, :] * h + Bu[:, t, :]
            hs.append(h)
        hseq = torch.stack(hs, 1)
        y = 2.0 * torch.einsum("blp,dp->bld", hseq, Cmat).real + x * Dskip[None, None, :]
        return y

    def _B_ref(x, w_gate, w_up, w_down):
        g = torch.einsum("bsd,df->bsf", x, w_gate)
        u = torch.einsum("bsd,df->bsf", x, w_up)
        h = _gelu(g) * u
        return torch.einsum("bsf,fd->bsd", h, w_down)

    x = A_x
    xn = _layernorm(x, axis=-1)
    s = _A_ref(xn, A_Lambda_re, A_Lambda_im, A_B_re, A_B_im, A_C_re, A_C_im, A_log_dt, A_Dskip)
    g = _silu(_B_ref(xn, B_w_gate, B_w_up, B_w_down))
    return x + s * g
```

```asm
; @launch grid=(256,1,1) block=(256,1,1) lds=163840
.amdgcn_target "amdgcn-amd-amdhsa--gfx950"
.text
.globl recurrent_scan__ssm_conv_s5__glu_gated_geglu__prompt_kernel
.p2align 8
.type recurrent_scan__ssm_conv_s5__glu_gated_geglu__prompt_kernel,@function
recurrent_scan__ssm_conv_s5__glu_gated_geglu__prompt_kernel:
    s_cmp_ge_u32 s2, 256
    s_cbranch_scc1 L_end
    s_load_dwordx16 s[32:47], s[0:1], 0
    s_load_dwordx16 s[48:63], s[0:1], 64
    s_getpc_b64 s[94:95]
Lpc0:
    v_lshrrev_b32 v2, 6, v0
    v_and_b32 v1, 63, v0
    s_lshr_b32 s79, s2, 3
    v_readfirstlane_b32 s64, v2
    s_and_b32 s65, s2, 1
    s_lshl_b32 s65, s65, 2
    s_and_b32 s80, s79, 3
    s_add_u32 s65, s65, s80
    s_lshr_b32 s79, s79, 2
    s_bfe_u32 s80, s2, 0x20001
    v_lshrrev_b32 v6, 3, v1
    v_and_b32 v7, 7, v1
    v_lshrrev_b32 v8, 4, v1
    v_xor_b32 v9, v7, v8
    v_lshlrev_b32 v9, 4, v9
    v_xor_b32 v10, 64, v9
    s_and_b32 s70, s64, 1
    s_lshr_b32 s71, s64, 1
    s_lshl_b32 s75, s64, 13
    s_lshl_b32 s76, s64, 12
    s_add_u32 s76, s76, 32768
    s_lshl_b32 s81, s65, 8
    s_lshl_b32 s82, s64, 6
    s_add_u32 s81, s81, s82
    v_add_u32 v11, s81, v6
    v_lshlrev_b32 v11, 10, v11
    v_add_u32 v12, v11, v9
    v_add_u32 v13, v11, v10
    v_add_u32 v24, 0, v12
    v_add_u32 v25, 7168, v13
    v_add_u32 v26, 14336, v12
    v_add_u32 v27, 21504, v13
    v_add_u32 v28, 32768, v12
    v_add_u32 v29, 39936, v13
    v_add_u32 v30, 47104, v12
    v_add_u32 v31, 54272, v13
    v_and_b32 v11, 1, v8
    v_lshlrev_b32 v11, 2, v11
    v_xor_b32 v11, v11, v7
    v_lshlrev_b32 v14, 4, v11
    s_add_u32 s72, s65, s79
    s_and_b32 s72, s72, 3
    s_lshl_b32 s72, s72, 8
    s_mov_b32 s6, 2097152
    s_mov_b32 s7, 0x00020000
    s_mov_b32 s11, 0x00020000
    s_cmp_lt_u32 s79, 2
    s_cbranch_scc1 L_ssm
    s_mul_i32 s80, s80, 6
    s_add_u32 s66, s80, s79
    s_sub_u32 s66, s66, 2
    s_cmp_ge_u32 s66, 22
    s_cbranch_scc1 L_stats
    s_mov_b32 s10, 1409024
    s_mov_b32 s74, 1376
    s_lshl_b32 s81, s70, 5
    v_add_u32 v11, s81, v6
    v_mul_u32_u24 v11, 2752, v11
    s_lshl_b32 s81, s66, 7
    v_add3_u32 v11, v11, v14, s81
    v_add_u32 v32, 0, v11
    v_add_u32 v33, 20992, v11
    v_add_u32 v34, 41984, v11
    v_add_u32 v35, 62976, v11
    s_cmp_lt_u32 s64, 2
    s_waitcnt lgkmcnt(0)
    s_cselect_b32 s8, s52, s54
    s_cselect_b32 s9, s53, s55
    s_mov_b32 s4, s32
    s_mov_b32 s5, s33
    s_add_u32 m0, s76, 0
    s_mul_i32 s73, s72, s74
    buffer_load_dwordx4 v32, s[8:11], s73 offen offset:0 lds
    buffer_load_dwordx4 v33, s[8:11], s73 offen offset:1024 lds
    buffer_load_dwordx4 v34, s[8:11], s73 offen offset:2048 lds
    buffer_load_dwordx4 v35, s[8:11], s73 offen offset:3072 lds
    s_add_u32 m0, s75, 0
    s_nop 0
    buffer_load_dwordx4 v24, s[4:7], s72 offen offset:0 lds
    buffer_load_dwordx4 v25, s[4:7], s72 offen offset:1024 lds
    buffer_load_dwordx4 v26, s[4:7], s72 offen offset:2048 lds
    buffer_load_dwordx4 v27, s[4:7], s72 offen offset:3072 lds
    s_add_u32 m0, s75, 4096
    s_nop 0
    buffer_load_dwordx4 v28, s[4:7], s72 offen offset:0 lds
    buffer_load_dwordx4 v29, s[4:7], s72 offen offset:1024 lds
    buffer_load_dwordx4 v30, s[4:7], s72 offen offset:2048 lds
    buffer_load_dwordx4 v31, s[4:7], s72 offen offset:3072 lds
    s_add_u32 s72, s72, 128
    s_and_b32 s72, s72, 0x3ff
    s_mov_b32 s84, 0xffff0000
    s_mov_b32 s12, s62
    s_mov_b32 s13, s63
    s_mov_b32 s14, 11534336
    s_mov_b32 s15, 0x00020000
    s_mov_b32 s16, s42
    s_mov_b32 s17, s43
    s_mov_b32 s18, 524288
    s_mov_b32 s19, 0x00020000
    s_mov_b32 s20, s44
    s_mov_b32 s21, s45
    s_mov_b32 s22, 524288
    s_mov_b32 s23, 0x00020000
    s_mov_b32 s24, s56
    s_mov_b32 s25, s57
    s_mov_b32 s26, 1409024
    s_mov_b32 s27, 0x00020000
    s_bfe_u32 s68, s2, 0x20003
    s_lshr_b32 s69, s2, 6
    s_and_b32 s82, s2, 1
    s_lshl_b32 s82, s82, 2
    s_add_u32 s69, s69, s82
    s_and_b32 s67, s2, 6
    s_bfe_u32 s81, s2, 0x10005
    s_add_u32 s67, s67, s81
    s_mul_i32 s78, s64, 12288
    s_add_u32 s77, s78, 98304
    s_lshl_b32 s85, s64, 8
    s_lshl_b32 s81, s70, 15
    s_add_u32 s86, s85, 32768
    s_sub_u32 s86, s86, s81
    s_add_u32 s85, s85, s81
    s_mul_i32 s87, s64, 360448
    s_lshl_b32 s81, s69, 6
    v_add_u32 v11, s81, v6
    v_lshlrev_b32 v11, 10, v11
    v_add_u32 v12, v11, v9
    v_add_u32 v13, v11, v10
    v_add_u32 v16, 0, v12
    v_add_u32 v17, 7168, v13
    v_add_u32 v18, 14336, v12
    v_add_u32 v19, 21504, v13
    s_lshl_b32 s81, s69, 7
    v_lshl_add_u32 v11, v6, 10, v14
    v_add_u32 v11, s81, v11
    v_add_u32 v20, 0, v11
    v_add_u32 v21, 7168, v11
    v_add_u32 v22, 14336, v11
    v_add_u32 v23, 21504, v11
    s_bfe_u32 s81, s2, 0x30003
    s_lshl_b32 s81, s81, 2
    s_add_u32 s81, s81, s64
    s_mul_i32 s81, s81, ((L_end-Lpc0)/128+32)/32
    v_min_u32 v11, ((L_end-Lpc0)/128+32)/32-1, v1
    v_add_u32 v11, s81, v11
    v_lshlrev_b32 v11, 7, v11
    v_min_u32 v11, L_end-Lpc0, v11
    s_mov_b64 exec, 0xffff
    global_load_dword v0, v11, s[94:95]
    s_mov_b64 exec, -1
    v_bfe_u32 v2, v1, 4, 1
    v_and_b32 v3, 15, v1
    v_lshl_add_u32 v2, v2, 6, v3
    v_lshrrev_b32 v3, 5, v1
    v_bfe_u32 v4, v2, 1, 3
    v_xor_b32 v4, v4, v3
    s_lshl_b32 s81, s70, 14
    v_lshlrev_b32 v2, 7, v2
    v_add_u32 v2, s81, v2
    s_lshl_b32 s81, s70, 1
    v_xor_b32 v4, s81, v4
    v_xor_b32 v5, 0, v4
    v_lshl_add_u32 v36, v5, 4, v2
    v_add_u32 v40, 98304, v36
    v_xor_b32 v5, 2, v4
    v_lshl_add_u32 v37, v5, 4, v2
    v_add_u32 v41, 98304, v37
    v_xor_b32 v5, 4, v4
    v_lshl_add_u32 v38, v5, 4, v2
    v_add_u32 v42, 98304, v38
    v_xor_b32 v5, 6, v4
    v_lshl_add_u32 v39, v5, 4, v2
    v_add_u32 v43, 98304, v39
    v_lshrrev_b32 v2, 5, v1
    v_bfe_u32 v3, v1, 2, 2
    v_lshl_add_u32 v2, v2, 3, v3
    v_lshlrev_b32 v2, 7, v2
    v_bfe_u32 v3, v1, 4, 1
    v_lshl_add_u32 v2, v3, 5, v2
    v_and_b32 v3, 3, v1
    v_lshl_add_u32 v2, v3, 3, v2
    v_bfe_u32 v3, v1, 3, 1
    v_xor_b32 v3, s71, v3
    v_lshl_add_u32 v2, v3, 6, v2
    s_lshl_b32 s81, s70, 11
    s_add_u32 s82, s81, 32768
    s_sub_u32 s81, 32768, s81
    v_add_u32 v44, s82, v2
    v_add_u32 v45, s81, v2
    v_add_u32 v48, 98304, v44
    v_add_u32 v49, 98304, v45
    v_mov_b32 v52, 0
    v_mov_b32 v53, 0
    s_add_u32 m0, s76, 49152
    s_mul_i32 s73, s72, s74
    buffer_load_dwordx4 v32, s[8:11], s73 offen offset:0 lds
    buffer_load_dwordx4 v33, s[8:11], s73 offen offset:1024 lds
    buffer_load_dwordx4 v34, s[8:11], s73 offen offset:2048 lds
    buffer_load_dwordx4 v35, s[8:11], s73 offen offset:3072 lds
    s_add_u32 m0, s75, 49152
    s_nop 0
    buffer_load_dwordx4 v24, s[4:7], s72 offen offset:0 lds
    buffer_load_dwordx4 v25, s[4:7], s72 offen offset:1024 lds
    s_waitcnt vmcnt(7)
    s_barrier
    ds_read_b64_tr_b16 v[96:97], v44 offset:0
    ds_read_b64_tr_b16 v[98:99], v44 offset:512
    ds_read_b128 v[80:83], v36 offset:0
    ds_read_b64_tr_b16 v[100:101], v44 offset:8192
    ds_read_b64_tr_b16 v[102:103], v44 offset:8704
    ds_read_b128 v[84:87], v36 offset:2048
    ds_read_b128 v[88:91], v36 offset:4096
    ds_read_b128 v[92:95], v36 offset:6144
    s_waitcnt lgkmcnt(0)
    v_mfma_f32_32x32x16_bf16 v[128:143], v[96:99], v[80:83], 0
    ds_read_b64_tr_b16 v[120:121], v45 offset:2048
    ds_read_b64_tr_b16 v[122:123], v45 offset:2560
    v_lshlrev_b32 v54, 16, v96
    v_and_b32 v55, s84, v96
    v_mfma_f32_32x32x16_bf16 v[144:159], v[100:103], v[80:83], 0
    ds_read_b128 v[104:107], v37 offset:0
    ds_read_b64_tr_b16 v[124:125], v45 offset:10240
    v_add_f32 v52, v52, v54
    v_add_f32 v52, v52, v55
    v_mfma_f32_32x32x16_bf16 v[160:175], v[96:99], v[84:87], 0
    ds_read_b64_tr_b16 v[126:127], v45 offset:10752
    ds_read_b128 v[108:111], v37 offset:2048
    v_lshlrev_b32 v54, 16, v97
    v_and_b32 v55, s84, v97
    v_mfma_f32_32x32x16_bf16 v[176:191], v[100:103], v[84:87], 0
    ds_read_b128 v[112:115], v37 offset:4096
    ds_read_b128 v[116:119], v37 offset:6144
    v_add_f32 v52, v52, v54
    v_add_f32 v52, v52, v55
    v_mfma_f32_32x32x16_bf16 v[192:207], v[96:99], v[88:91], 0
    v_lshlrev_b32 v54, 16, v98
    v_and_b32 v55, s84, v98
    buffer_load_dwordx4 v26, s[4:7], s72 offen offset:2048 lds
    v_mfma_f32_32x32x16_bf16 v[208:223], v[100:103], v[88:91], 0
    v_add_f32 v52, v52, v54
    v_add_f32 v52, v52, v55
    buffer_load_dwordx4 v27, s[4:7], s72 offen offset:3072 lds
    s_add_u32 m0, s75, 53248
    v_mfma_f32_32x32x16_bf16 v[224:239], v[96:99], v[92:95], 0
    v_lshlrev_b32 v54, 16, v99
    v_and_b32 v55, s84, v99
    buffer_load_dwordx4 v28, s[4:7], s72 offen offset:0 lds
    v_mfma_f32_32x32x16_bf16 v[240:255], v[100:103], v[92:95], 0
    v_add_f32 v52, v52, v54
    v_add_f32 v52, v52, v55
    buffer_load_dwordx4 v29, s[4:7], s72 offen offset:1024 lds
    s_waitcnt lgkmcnt(0)
    v_mfma_f32_32x32x16_bf16 v[128:143], v[120:123], v[104:107], v[128:143]
    ds_read_b64_tr_b16 v[72:73], v44 offset:4096
    ds_read_b64_tr_b16 v[74:75], v44 offset:4608
    v_lshlrev_b32 v54, 16, v100
    v_and_b32 v55, s84, v100
    v_mfma_f32_32x32x16_bf16 v[144:159], v[124:127], v[104:107], v[144:159]
    ds_read_b128 v[80:83], v38 offset:0
    ds_read_b64_tr_b16 v[76:77], v44 offset:12288
    v_add_f32 v53, v53, v54
    v_add_f32 v53, v53, v55
    v_mfma_f32_32x32x16_bf16 v[160:175], v[120:123], v[108:111], v[160:175]
    ds_read_b64_tr_b16 v[78:79], v44 offset:12800
    ds_read_b128 v[84:87], v38 offset:2048
    v_lshlrev_b32 v54, 16, v101
    v_and_b32 v55, s84, v101
    v_mfma_f32_32x32x16_bf16 v[176:191], v[124:127], v[108:111], v[176:191]
    ds_read_b128 v[88:91], v38 offset:4096
    ds_read_b128 v[92:95], v38 offset:6144
    v_add_f32 v53, v53, v54
    v_add_f32 v53, v53, v55
    v_mfma_f32_32x32x16_bf16 v[192:207], v[120:123], v[112:115], v[192:207]
    v_lshlrev_b32 v54, 16, v102
    v_and_b32 v55, s84, v102
    buffer_load_dwordx4 v30, s[4:7], s72 offen offset:2048 lds
    v_mfma_f32_32x32x16_bf16 v[208:223], v[124:127], v[112:115], v[208:223]
    v_add_f32 v53, v53, v54
    v_add_f32 v53, v53, v55
    buffer_load_dwordx4 v31, s[4:7], s72 offen offset:3072 lds
    s_add_u32 s72, s72, 128
    s_and_b32 s72, s72, 0x3ff
    s_add_u32 m0, s76, 98304
    v_mfma_f32_32x32x16_bf16 v[224:239], v[120:123], v[116:119], v[224:239]
    v_lshlrev_b32 v54, 16, v103
    v_and_b32 v55, s84, v103
    s_mul_i32 s73, s72, s74
    buffer_load_dwordx4 v32, s[8:11], s73 offen offset:0 lds
    v_mfma_f32_32x32x16_bf16 v[240:255], v[124:127], v[116:119], v[240:255]
    v_add_f32 v53, v53, v54
    v_add_f32 v53, v53, v55
    buffer_load_dwordx4 v33, s[8:11], s73 offen offset:1024 lds
    s_waitcnt lgkmcnt(0)
    v_mfma_f32_32x32x16_bf16 v[128:143], v[72:75], v[80:83], v[128:143]
    ds_read_b64_tr_b16 v[96:97], v45 offset:6144
    ds_read_b64_tr_b16 v[98:99], v45 offset:6656
    v_lshlrev_b32 v54, 16, v72
    v_and_b32 v55, s84, v72
    v_mfma_f32_32x32x16_bf16 v[144:159], v[76:79], v[80:83], v[144:159]
    ds_read_b128 v[104:107], v39 offset:0
    ds_read_b64_tr_b16 v[100:101], v45 offset:14336
    v_add_f32 v52, v52, v54
    v_add_f32 v52, v52, v55
    v_mfma_f32_32x32x16_bf16 v[160:175], v[72:75], v[84:87], v[160:175]
    ds_read_b64_tr_b16 v[102:103], v45 offset:14848
    ds_read_b128 v[108:111], v39 offset:2048
    v_lshlrev_b32 v54, 16, v73
    v_and_b32 v55, s84, v73
    v_mfma_f32_32x32x16_bf16 v[176:191], v[76:79], v[84:87], v[176:191]
    ds_read_b128 v[112:115], v39 offset:4096
    ds_read_b128 v[116:119], v39 offset:6144
    v_add_f32 v52, v52, v54
    v_add_f32 v52, v52, v55
    v_mfma_f32_32x32x16_bf16 v[192:207], v[72:75], v[88:91], v[192:207]
    v_lshlrev_b32 v54, 16, v74
    v_and_b32 v55, s84, v74
    buffer_load_dwordx4 v34, s[8:11], s73 offen offset:2048 lds
    v_mfma_f32_32x32x16_bf16 v[208:223], v[76:79], v[88:91], v[208:223]
    v_add_f32 v52, v52, v54
    v_add_f32 v52, v52, v55
    buffer_load_dwordx4 v35, s[8:11], s73 offen offset:3072 lds
    s_add_u32 m0, s75, 98304
    v_mfma_f32_32x32x16_bf16 v[224:239], v[72:75], v[92:95], v[224:239]
    v_lshlrev_b32 v54, 16, v75
    v_and_b32 v55, s84, v75
    buffer_load_dwordx4 v24, s[4:7], s72 offen offset:0 lds
    v_mfma_f32_32x32x16_bf16 v[240:255], v[76:79], v[92:95], v[240:255]
    v_add_f32 v52, v52, v54
    v_add_f32 v52, v52, v55
    buffer_load_dwordx4 v25, s[4:7], s72 offen offset:1024 lds
    s_waitcnt lgkmcnt(0)
    v_mfma_f32_32x32x16_bf16 v[128:143], v[96:99], v[104:107], v[128:143]
    s_waitcnt vmcnt(6)
    s_barrier
    ds_read_b64_tr_b16 v[120:121], v44 offset:49152
    ds_read_b64_tr_b16 v[122:123], v44 offset:49664
    v_lshlrev_b32 v54, 16, v76
    v_and_b32 v55, s84, v76
    v_mfma_f32_32x32x16_bf16 v[144:159], v[100:103], v[104:107], v[144:159]
    ds_read_b128 v[80:83], v36 offset:49152
    ds_read_b64_tr_b16 v[124:125], v44 offset:57344
    v_add_f32 v53, v53, v54
    v_add_f32 v53, v53, v55
    v_mfma_f32_32x32x16_bf16 v[160:175], v[96:99], v[108:111], v[160:175]
    ds_read_b64_tr_b16 v[126:127], v44 offset:57856
    ds_read_b128 v[84:87], v36 offset:51200
    v_lshlrev_b32 v54, 16, v77
    v_and_b32 v55, s84, v77
    v_mfma_f32_32x32x16_bf16 v[176:191], v[100:103], v[108:111], v[176:191]
    ds_read_b128 v[88:91], v36 offset:53248
    ds_read_b128 v[92:95], v36 offset:55296
    v_add_f32 v53, v53, v54
    v_add_f32 v53, v53, v55
    v_mfma_f32_32x32x16_bf16 v[192:207], v[96:99], v[112:115], v[192:207]
    v_lshlrev_b32 v54, 16, v78
    v_and_b32 v55, s84, v78
    buffer_load_dwordx4 v26, s[4:7], s72 offen offset:2048 lds
    v_mfma_f32_32x32x16_bf16 v[208:223], v[100:103], v[112:115], v[208:223]
    v_add_f32 v53, v53, v54
    v_add_f32 v53, v53, v55
    buffer_load_dwordx4 v27, s[4:7], s72 offen offset:3072 lds
    s_add_u32 m0, s75, 102400
    v_mfma_f32_32x32x16_bf16 v[224:239], v[96:99], v[116:119], v[224:239]
    v_lshlrev_b32 v54, 16, v79
    v_and_b32 v55, s84, v79
    buffer_load_dwordx4 v28, s[4:7], s72 offen offset:0 lds
    v_mfma_f32_32x32x16_bf16 v[240:255], v[100:103], v[116:119], v[240:255]
    v_add_f32 v53, v53, v54
    v_add_f32 v53, v53, v55
    buffer_load_dwordx4 v29, s[4:7], s72 offen offset:1024 lds
    s_waitcnt lgkmcnt(0)
    v_mfma_f32_32x32x16_bf16 v[128:143], v[120:123], v[80:83], v[128:143]
    ds_read_b64_tr_b16 v[72:73], v45 offset:51200
    ds_read_b64_tr_b16 v[74:75], v45 offset:51712
    v_lshlrev_b32 v54, 16, v120
    v_and_b32 v55, s84, v120
    v_mfma_f32_32x32x16_bf16 v[144:159], v[124:127], v[80:83], v[144:159]
    ds_read_b128 v[104:107], v37 offset:49152
    ds_read_b64_tr_b16 v[76:77], v45 offset:59392
    v_add_f32 v52, v52, v54
    v_add_f32 v52, v52, v55
    v_mfma_f32_32x32x16_bf16 v[160:175], v[120:123], v[84:87], v[160:175]
    ds_read_b64_tr_b16 v[78:79], v45 offset:59904
    ds_read_b128 v[108:111], v37 offset:51200
    v_lshlrev_b32 v54, 16, v121
    v_and_b32 v55, s84, v121
    v_mfma_f32_32x32x16_bf16 v[176:191], v[124:127], v[84:87], v[176:191]
    ds_read_b128 v[112:115], v37 offset:53248
    ds_read_b128 v[116:119], v37 offset:55296
    v_add_f32 v52, v52, v54
    v_add_f32 v52, v52, v55
    v_mfma_f32_32x32x16_bf16 v[192:207], v[120:123], v[88:91], v[192:207]
    v_lshlrev_b32 v54, 16, v122
    v_and_b32 v55, s84, v122
    buffer_load_dwordx4 v30, s[4:7], s72 offen offset:2048 lds
    v_mfma_f32_32x32x16_bf16 v[208:223], v[124:127], v[88:91], v[208:223]
    v_add_f32 v52, v52, v54
    v_add_f32 v52, v52, v55
    buffer_load_dwordx4 v31, s[4:7], s72 offen offset:3072 lds
    s_add_u32 s72, s72, 128
    s_and_b32 s72, s72, 0x3ff
    s_add_u32 m0, s76, 0
    v_mfma_f32_32x32x16_bf16 v[224:239], v[120:123], v[92:95], v[224:239]
    v_lshlrev_b32 v54, 16, v123
    v_and_b32 v55, s84, v123
    s_mul_i32 s73, s72, s74
    buffer_load_dwordx4 v32, s[8:11], s73 offen offset:0 lds
    v_mfma_f32_32x32x16_bf16 v[240:255], v[124:127], v[92:95], v[240:255]
    v_add_f32 v52, v52, v54
    v_add_f32 v52, v52, v55
    buffer_load_dwordx4 v33, s[8:11], s73 offen offset:1024 lds
    s_waitcnt lgkmcnt(0)
    v_mfma_f32_32x32x16_bf16 v[128:143], v[72:75], v[104:107], v[128:143]
    ds_read_b64_tr_b16 v[96:97], v44 offset:53248
    ds_read_b64_tr_b16 v[98:99], v44 offset:53760
    v_lshlrev_b32 v54, 16, v124
    v_and_b32 v55, s84, v124
    v_mfma_f32_32x32x16_bf16 v[144:159], v[76:79], v[104:107], v[144:159]
    ds_read_b128 v[80:83], v38 offset:49152
    ds_read_b64_tr_b16 v[100:101], v44 offset:61440
    v_add_f32 v53, v53, v54
    v_add_f32 v53, v53, v55
    v_mfma_f32_32x32x16_bf16 v[160:175], v[72:75], v[108:111], v[160:175]
    ds_read_b64_tr_b16 v[102:103], v44 offset:61952
    ds_read_b128 v[84:87], v38 offset:51200
    v_lshlrev_b32 v54, 16, v125
    v_and_b32 v55, s84, v125
    v_mfma_f32_32x32x16_bf16 v[176:191], v[76:79], v[108:111], v[176:191]
    ds_read_b128 v[88:91], v38 offset:53248
    ds_read_b128 v[92:95], v38 offset:55296
    v_add_f32 v53, v53, v54
    v_add_f32 v53, v53, v55
    v_mfma_f32_32x32x16_bf16 v[192:207], v[72:75], v[112:115], v[192:207]
    v_lshlrev_b32 v54, 16, v126
    v_and_b32 v55, s84, v126
    buffer_load_dwordx4 v34, s[8:11], s73 offen offset:2048 lds
    v_mfma_f32_32x32x16_bf16 v[208:223], v[76:79], v[112:115], v[208:223]
    v_add_f32 v53, v53, v54
    v_add_f32 v53, v53, v55
    buffer_load_dwordx4 v35, s[8:11], s73 offen offset:3072 lds
    s_add_u32 m0, s75, 0
    v_mfma_f32_32x32x16_bf16 v[224:239], v[72:75], v[116:119], v[224:239]
    v_lshlrev_b32 v54, 16, v127
    v_and_b32 v55, s84, v127
    buffer_load_dwordx4 v24, s[4:7], s72 offen offset:0 lds
    v_mfma_f32_32x32x16_bf16 v[240:255], v[76:79], v[116:119], v[240:255]
    v_add_f32 v53, v53, v54
    v_add_f32 v53, v53, v55
    buffer_load_dwordx4 v25, s[4:7], s72 offen offset:1024 lds
    s_waitcnt lgkmcnt(0)
    v_mfma_f32_32x32x16_bf16 v[128:143], v[96:99], v[80:83], v[128:143]
    ds_read_b64_tr_b16 v[120:121], v45 offset:55296
    ds_read_b64_tr_b16 v[122:123], v45 offset:55808
    v_lshlrev_b32 v54, 16, v96
    v_and_b32 v55, s84, v96
    v_mfma_f32_32x32x16_bf16 v[144:159], v[100:103], v[80:83], v[144:159]
    ds_read_b128 v[104:107], v39 offset:49152
    ds_read_b64_tr_b16 v[124:125], v45 offset:63488
    v_add_f32 v52, v52, v54
    v_add_f32 v52, v52, v55
    v_mfma_f32_32x32x16_bf16 v[160:175], v[96:99], v[84:87], v[160:175]
    ds_read_b64_tr_b16 v[126:127], v45 offset:64000
    ds_read_b128 v[108:111], v39 offset:51200
    v_lshlrev_b32 v54, 16, v97
    v_and_b32 v55, s84, v97
    v_mfma_f32_32x32x16_bf16 v[176:191], v[100:103], v[84:87], v[176:191]
    ds_read_b128 v[112:115], v39 offset:53248
    ds_read_b128 v[116:119], v39 offset:55296
    v_add_f32 v52, v52, v54
    v_add_f32 v52, v52, v55
    v_mfma_f32_32x32x16_bf16 v[192:207], v[96:99], v[88:91], v[192:207]
    v_lshlrev_b32 v54, 16, v98
    v_and_b32 v55, s84, v98
    buffer_load_dwordx4 v26, s[4:7], s72 offen offset:2048 lds
    v_mfma_f32_32x32x16_bf16 v[208:223], v[100:103], v[88:91], v[208:223]
    v_add_f32 v52, v52, v54
    v_add_f32 v52, v52, v55
    buffer_load_dwordx4 v27, s[4:7], s72 offen offset:3072 lds
    s_add_u32 m0, s75, 4096
    v_mfma_f32_32x32x16_bf16 v[224:239], v[96:99], v[92:95], v[224:239]
    v_lshlrev_b32 v54, 16, v99
    v_and_b32 v55, s84, v99
    buffer_load_dwordx4 v28, s[4:7], s72 offen offset:0 lds
    v_mfma_f32_32x32x16_bf16 v[240:255], v[100:103], v[92:95], v[240:255]
    v_add_f32 v52, v52, v54
    v_add_f32 v52, v52, v55
    buffer_load_dwordx4 v29, s[4:7], s72 offen offset:1024 lds
    s_waitcnt lgkmcnt(0)
    v_mfma_f32_32x32x16_bf16 v[128:143], v[120:123], v[104:107], v[128:143]
    s_waitcnt vmcnt(10)
    s_barrier
    ds_read_b64_tr_b16 v[72:73], v48 offset:0
    ds_read_b64_tr_b16 v[74:75], v48 offset:512
    v_lshlrev_b32 v54, 16, v100
    v_and_b32 v55, s84, v100
    v_mfma_f32_32x32x16_bf16 v[144:159], v[124:127], v[104:107], v[144:159]
    ds_read_b128 v[80:83], v40 offset:0
    ds_read_b64_tr_b16 v[76:77], v48 offset:8192
    v_add_f32 v53, v53, v54
    v_add_f32 v53, v53, v55
    v_mfma_f32_32x32x16_bf16 v[160:175], v[120:123], v[108:111], v[160:175]
    ds_read_b64_tr_b16 v[78:79], v48 offset:8704
    ds_read_b128 v[84:87], v40 offset:2048
    v_lshlrev_b32 v54, 16, v101
    v_and_b32 v55, s84, v101
    v_mfma_f32_32x32x16_bf16 v[176:191], v[124:127], v[108:111], v[176:191]
    ds_read_b128 v[88:91], v40 offset:4096
    ds_read_b128 v[92:95], v40 offset:6144
    v_add_f32 v53, v53, v54
    v_add_f32 v53, v53, v55
    v_mfma_f32_32x32x16_bf16 v[192:207], v[120:123], v[112:115], v[192:207]
    v_lshlrev_b32 v54, 16, v102
    v_and_b32 v55, s84, v102
    buffer_load_dwordx4 v30, s[4:7], s72 offen offset:2048 lds
    v_mfma_f32_32x32x16_bf16 v[208:223], v[124:127], v[112:115], v[208:223]
    v_add_f32 v53, v53, v54
    v_add_f32 v53, v53, v55
    buffer_load_dwordx4 v31, s[4:7], s72 offen offset:3072 lds
    s_add_u32 s72, s72, 128
    s_and_b32 s72, s72, 0x3ff
    s_add_u32 m0, s76, 49152
    v_mfma_f32_32x32x16_bf16 v[224:239], v[120:123], v[116:119], v[224:239]
    v_lshlrev_b32 v54, 16, v103
    v_and_b32 v55, s84, v103
    s_mul_i32 s73, s72, s74
    buffer_load_dwordx4 v32, s[8:11], s73 offen offset:0 lds
    v_mfma_f32_32x32x16_bf16 v[240:255], v[124:127], v[116:119], v[240:255]
    v_add_f32 v53, v53, v54
    v_add_f32 v53, v53, v55
    buffer_load_dwordx4 v33, s[8:11], s73 offen offset:1024 lds
    s_waitcnt lgkmcnt(0)
    v_mfma_f32_32x32x16_bf16 v[128:143], v[72:75], v[80:83], v[128:143]
    ds_read_b64_tr_b16 v[96:97], v49 offset:2048
    ds_read_b64_tr_b16 v[98:99], v49 offset:2560
    v_lshlrev_b32 v54, 16, v72
    v_and_b32 v55, s84, v72
    v_mfma_f32_32x32x16_bf16 v[144:159], v[76:79], v[80:83], v[144:159]
    ds_read_b128 v[104:107], v41 offset:0
    ds_read_b64_tr_b16 v[100:101], v49 offset:10240
    v_add_f32 v52, v52, v54
    v_add_f32 v52, v52, v55
    v_mfma_f32_32x32x16_bf16 v[160:175], v[72:75], v[84:87], v[160:175]
    ds_read_b64_tr_b16 v[102:103], v49 offset:10752
    ds_read_b128 v[108:111], v41 offset:2048
    v_lshlrev_b32 v54, 16, v73
    v_and_b32 v55, s84, v73
    v_mfma_f32_32x32x16_bf16 v[176:191], v[76:79], v[84:87], v[176:191]
    ds_read_b128 v[112:115], v41 offset:4096
    ds_read_b128 v[116:119], v41 offset:6144
    v_add_f32 v52, v52, v54
    v_add_f32 v52, v52, v55
    v_mfma_f32_32x32x16_bf16 v[192:207], v[72:75], v[88:91], v[192:207]
    v_lshlrev_b32 v54, 16, v74
    v_and_b32 v55, s84, v74
    v_mfma_f32_32x32x16_bf16 v[208:223], v[76:79], v[88:91], v[208:223]
    v_add_f32 v52, v52, v54
    v_add_f32 v52, v52, v55
    buffer_load_dwordx4 v34, s[8:11], s73 offen offset:2048 lds
    v_mfma_f32_32x32x16_bf16 v[224:239], v[72:75], v[92:95], v[224:239]
    v_lshlrev_b32 v54, 16, v75
    v_and_b32 v55, s84, v75
    buffer_load_dwordx4 v35, s[8:11], s73 offen offset:3072 lds
    s_add_u32 m0, s75, 49152
    v_mfma_f32_32x32x16_bf16 v[240:255], v[76:79], v[92:95], v[240:255]
    v_add_f32 v52, v52, v54
    v_add_f32 v52, v52, v55
    buffer_load_dwordx4 v24, s[4:7], s72 offen offset:0 lds
    s_waitcnt lgkmcnt(0)
    v_mfma_f32_32x32x16_bf16 v[128:143], v[96:99], v[104:107], v[128:143]
    ds_read_b64_tr_b16 v[120:121], v48 offset:4096
    ds_read_b64_tr_b16 v[122:123], v48 offset:4608
    v_lshlrev_b32 v54, 16, v76
    v_and_b32 v55, s84, v76
    v_mfma_f32_32x32x16_bf16 v[144:159], v[100:103], v[104:107], v[144:159]
    ds_read_b128 v[80:83], v42 offset:0
    ds_read_b64_tr_b16 v[124:125], v48 offset:12288
    v_add_f32 v53, v53, v54
    v_add_f32 v53, v53, v55
    v_mfma_f32_32x32x16_bf16 v[160:175], v[96:99], v[108:111], v[160:175]
    ds_read_b64_tr_b16 v[126:127], v48 offset:12800
    ds_read_b128 v[84:87], v42 offset:2048
    v_lshlrev_b32 v54, 16, v77
    v_and_b32 v55, s84, v77
    v_mfma_f32_32x32x16_bf16 v[176:191], v[100:103], v[108:111], v[176:191]
    ds_read_b128 v[88:91], v42 offset:4096
    ds_read_b128 v[92:95], v42 offset:6144
    v_add_f32 v53, v53, v54
    v_add_f32 v53, v53, v55
    v_mfma_f32_32x32x16_bf16 v[192:207], v[96:99], v[112:115], v[192:207]
    v_lshlrev_b32 v54, 16, v78
    v_and_b32 v55, s84, v78
    v_mfma_f32_32x32x16_bf16 v[208:223], v[100:103], v[112:115], v[208:223]
    v_add_f32 v53, v53, v54
    v_add_f32 v53, v53, v55
    buffer_load_dwordx4 v25, s[4:7], s72 offen offset:1024 lds
    v_mfma_f32_32x32x16_bf16 v[224:239], v[96:99], v[116:119], v[224:239]
    v_lshlrev_b32 v54, 16, v79
    v_and_b32 v55, s84, v79
    buffer_load_dwordx4 v26, s[4:7], s72 offen offset:2048 lds
    v_mfma_f32_32x32x16_bf16 v[240:255], v[100:103], v[116:119], v[240:255]
    v_add_f32 v53, v53, v54
    v_add_f32 v53, v53, v55
    buffer_load_dwordx4 v27, s[4:7], s72 offen offset:3072 lds
    s_waitcnt lgkmcnt(0)
    v_mfma_f32_32x32x16_bf16 v[128:143], v[120:123], v[80:83], v[128:143]
    ds_read_b64_tr_b16 v[72:73], v49 offset:6144
    ds_read_b64_tr_b16 v[74:75], v49 offset:6656
    v_lshlrev_b32 v54, 16, v120
    v_and_b32 v55, s84, v120
    v_mfma_f32_32x32x16_bf16 v[144:159], v[124:127], v[80:83], v[144:159]
    ds_read_b128 v[104:107], v43 offset:0
    ds_read_b64_tr_b16 v[76:77], v49 offset:14336
    v_add_f32 v52, v52, v54
    v_add_f32 v52, v52, v55
    v_mfma_f32_32x32x16_bf16 v[160:175], v[120:123], v[84:87], v[160:175]
    ds_read_b64_tr_b16 v[78:79], v49 offset:14848
    ds_read_b128 v[108:111], v43 offset:2048
    v_lshlrev_b32 v54, 16, v121
    v_and_b32 v55, s84, v121
    v_mfma_f32_32x32x16_bf16 v[176:191], v[124:127], v[84:87], v[176:191]
    ds_read_b128 v[112:115], v43 offset:4096
    ds_read_b128 v[116:119], v43 offset:6144
    v_add_f32 v52, v52, v54
    v_add_f32 v52, v52, v55
    v_mfma_f32_32x32x16_bf16 v[192:207], v[120:123], v[88:91], v[192:207]
    v_lshlrev_b32 v54, 16, v122
    v_and_b32 v55, s84, v122
    s_add_u32 m0, s75, 53248
    v_mfma_f32_32x32x16_bf16 v[208:223], v[124:127], v[88:91], v[208:223]
    v_add_f32 v52, v52, v54
    v_add_f32 v52, v52, v55
    buffer_load_dwordx4 v28, s[4:7], s72 offen offset:0 lds
    v_mfma_f32_32x32x16_bf16 v[224:239], v[120:123], v[92:95], v[224:239]
    v_lshlrev_b32 v54, 16, v123
    v_and_b32 v55, s84, v123
    buffer_load_dwordx4 v29, s[4:7], s72 offen offset:1024 lds
    v_mfma_f32_32x32x16_bf16 v[240:255], v[124:127], v[92:95], v[240:255]
    v_add_f32 v52, v52, v54
    v_add_f32 v52, v52, v55
    buffer_load_dwordx4 v30, s[4:7], s72 offen offset:2048 lds
    s_lshl_b32 s81, s2, 2
    s_add_u32 s81, s81, s64
    s_mul_i32 s82, s81, 1408
    s_lshl_b32 s81, s81, 9
    v_lshlrev_b32 v2, 7, v1
    s_waitcnt lgkmcnt(0)
    v_mfma_f32_32x32x16_bf16 v[128:143], v[72:75], v[104:107], v[128:143]
    s_waitcnt vmcnt(11)
    s_barrier
    ds_read_b64_tr_b16 v[96:97], v44 offset:0
    ds_read_b64_tr_b16 v[98:99], v44 offset:512
    v_lshlrev_b32 v54, 16, v124
    v_and_b32 v55, s84, v124
    v_mfma_f32_32x32x16_bf16 v[144:159], v[76:79], v[104:107], v[144:159]
    ds_read_b128 v[80:83], v36 offset:0
    ds_read_b64_tr_b16 v[100:101], v44 offset:8192
    v_add_f32 v53, v53, v54
    v_add_f32 v53, v53, v55
    v_mfma_f32_32x32x16_bf16 v[160:175], v[72:75], v[108:111], v[160:175]
    ds_read_b64_tr_b16 v[102:103], v44 offset:8704
    ds_read_b128 v[84:87], v36 offset:2048
    v_lshlrev_b32 v54, 16, v125
    v_and_b32 v55, s84, v125
    v_mfma_f32_32x32x16_bf16 v[176:191], v[76:79], v[108:111], v[176:191]
    ds_read_b128 v[88:91], v36 offset:4096
    ds_read_b128 v[92:95], v36 offset:6144
    v_add_f32 v53, v53, v54
    v_add_f32 v53, v53, v55
    v_mfma_f32_32x32x16_bf16 v[192:207], v[72:75], v[112:115], v[192:207]
    v_lshlrev_b32 v54, 16, v126
    v_and_b32 v55, s84, v126
    v_mfma_f32_32x32x16_bf16 v[208:223], v[76:79], v[112:115], v[208:223]
    v_add_f32 v53, v53, v54
    v_add_f32 v53, v53, v55
    buffer_load_dwordx4 v31, s[4:7], s72 offen offset:3072 lds
    s_add_u32 s72, s72, 128
    s_and_b32 s72, s72, 0x3ff
    s_add_u32 m0, s76, 98304
    v_mfma_f32_32x32x16_bf16 v[224:239], v[72:75], v[116:119], v[224:239]
    v_lshlrev_b32 v54, 16, v127
    v_and_b32 v55, s84, v127
    s_mul_i32 s73, s72, s74
    buffer_load_dwordx4 v32, s[8:11], s73 offen offset:0 lds
    v_mfma_f32_32x32x16_bf16 v[240:255], v[76:79], v[116:119], v[240:255]
    v_add_f32 v53, v53, v54
    v_add_f32 v53, v53, v55
    buffer_load_dwordx4 v33, s[8:11], s73 offen offset:1024 lds
    s_mov_b64 exec, 0x7ff
    buffer_load_dword v0, v2, s[24:27], s82 offen
    s_mov_b64 exec, 15
    buffer_load_dword v0, v2, s[16:19], s81 offen
    buffer_load_dword v0, v2, s[20:23], s81 offen
    s_mov_b64 exec, -1
    s_waitcnt lgkmcnt(0)
    v_mfma_f32_32x32x16_bf16 v[128:143], v[96:99], v[80:83], v[128:143]
    ds_read_b64_tr_b16 v[120:121], v45 offset:2048
    ds_read_b64_tr_b16 v[122:123], v45 offset:2560
    v_lshlrev_b32 v54, 16, v96
    v_and_b32 v55, s84, v96
    v_mfma_f32_32x32x16_bf16 v[144:159], v[100:103], v[80:83], v[144:159]
    ds_read_b128 v[104:107], v37 offset:0
    ds_read_b64_tr_b16 v[124:125], v45 offset:10240
    v_add_f32 v52, v52, v54
    v_add_f32 v52, v52, v55
    v_mfma_f32_32x32x16_bf16 v[160:175], v[96:99], v[84:87], v[160:175]
    ds_read_b64_tr_b16 v[126:127], v45 offset:10752
    ds_read_b128 v[108:111], v37 offset:2048
    v_lshlrev_b32 v54, 16, v97
    v_and_b32 v55, s84, v97
    v_mfma_f32_32x32x16_bf16 v[176:191], v[100:103], v[84:87], v[176:191]
    ds_read_b128 v[112:115], v37 offset:4096
    ds_read_b128 v[116:119], v37 offset:6144
    v_add_f32 v52, v52, v54
    v_add_f32 v52, v52, v55
    v_mfma_f32_32x32x16_bf16 v[192:207], v[96:99], v[88:91], v[192:207]
    v_lshlrev_b32 v54, 16, v98
    v_and_b32 v55, s84, v98
    v_mfma_f32_32x32x16_bf16 v[208:223], v[100:103], v[88:91], v[208:223]
    v_add_f32 v52, v52, v54
    v_add_f32 v52, v52, v55
    buffer_load_dwordx4 v34, s[8:11], s73 offen offset:2048 lds
    v_mfma_f32_32x32x16_bf16 v[224:239], v[96:99], v[92:95], v[224:239]
    v_lshlrev_b32 v54, 16, v99
    v_and_b32 v55, s84, v99
    buffer_load_dwordx4 v35, s[8:11], s73 offen offset:3072 lds
    s_add_u32 m0, s75, 98304
    v_mfma_f32_32x32x16_bf16 v[240:255], v[100:103], v[92:95], v[240:255]
    v_add_f32 v52, v52, v54
    v_add_f32 v52, v52, v55
    buffer_load_dwordx4 v24, s[4:7], s72 offen offset:0 lds
    s_waitcnt lgkmcnt(0)
    v_mfma_f32_32x32x16_bf16 v[128:143], v[120:123], v[104:107], v[128:143]
    ds_read_b64_tr_b16 v[72:73], v44 offset:4096
    ds_read_b64_tr_b16 v[74:75], v44 offset:4608
    v_lshlrev_b32 v54, 16, v100
    v_and_b32 v55, s84, v100
    v_mfma_f32_32x32x16_bf16 v[144:159], v[124:127], v[104:107], v[144:159]
    ds_read_b128 v[80:83], v38 offset:0
    ds_read_b64_tr_b16 v[76:77], v44 offset:12288
    v_add_f32 v53, v53, v54
    v_add_f32 v53, v53, v55
    v_mfma_f32_32x32x16_bf16 v[160:175], v[120:123], v[108:111], v[160:175]
    ds_read_b64_tr_b16 v[78:79], v44 offset:12800
    ds_read_b128 v[84:87], v38 offset:2048
    v_lshlrev_b32 v54, 16, v101
    v_and_b32 v55, s84, v101
    v_mfma_f32_32x32x16_bf16 v[176:191], v[124:127], v[108:111], v[176:191]
    ds_read_b128 v[88:91], v38 offset:4096
    ds_read_b128 v[92:95], v38 offset:6144
    v_add_f32 v53, v53, v54
    v_add_f32 v53, v53, v55
    v_mfma_f32_32x32x16_bf16 v[192:207], v[120:123], v[112:115], v[192:207]
    v_lshlrev_b32 v54, 16, v102
    v_and_b32 v55, s84, v102
    v_mfma_f32_32x32x16_bf16 v[208:223], v[124:127], v[112:115], v[208:223]
    v_add_f32 v53, v53, v54
    v_add_f32 v53, v53, v55
    buffer_load_dwordx4 v25, s[4:7], s72 offen offset:1024 lds
    v_mfma_f32_32x32x16_bf16 v[224:239], v[120:123], v[116:119], v[224:239]
    v_lshlrev_b32 v54, 16, v103
    v_and_b32 v55, s84, v103
    buffer_load_dwordx4 v26, s[4:7], s72 offen offset:2048 lds
    v_mfma_f32_32x32x16_bf16 v[240:255], v[124:127], v[116:119], v[240:255]
    v_add_f32 v53, v53, v54
    v_add_f32 v53, v53, v55
    buffer_load_dwordx4 v27, s[4:7], s72 offen offset:3072 lds
    s_waitcnt lgkmcnt(0)
    v_mfma_f32_32x32x16_bf16 v[128:143], v[72:75], v[80:83], v[128:143]
    ds_read_b64_tr_b16 v[96:97], v45 offset:6144
    ds_read_b64_tr_b16 v[98:99], v45 offset:6656
    v_lshlrev_b32 v54, 16, v72
    v_and_b32 v55, s84, v72
    v_mfma_f32_32x32x16_bf16 v[144:159], v[76:79], v[80:83], v[144:159]
    ds_read_b128 v[104:107], v39 offset:0
    ds_read_b64_tr_b16 v[100:101], v45 offset:14336
    v_add_f32 v52, v52, v54
    v_add_f32 v52, v52, v55
    v_mfma_f32_32x32x16_bf16 v[160:175], v[72:75], v[84:87], v[160:175]
    ds_read_b64_tr_b16 v[102:103], v45 offset:14848
    ds_read_b128 v[108:111], v39 offset:2048
    v_lshlrev_b32 v54, 16, v73
    v_and_b32 v55, s84, v73
    v_mfma_f32_32x32x16_bf16 v[176:191], v[76:79], v[84:87], v[176:191]
    ds_read_b128 v[112:115], v39 offset:4096
    ds_read_b128 v[116:119], v39 offset:6144
    v_add_f32 v52, v52, v54
    v_add_f32 v52, v52, v55
    v_mfma_f32_32x32x16_bf16 v[192:207], v[72:75], v[88:91], v[192:207]
    v_lshlrev_b32 v54, 16, v74
    v_and_b32 v55, s84, v74
    s_add_u32 m0, s75, 102400
    v_mfma_f32_32x32x16_bf16 v[208:223], v[76:79], v[88:91], v[208:223]
    v_add_f32 v52, v52, v54
    v_add_f32 v52, v52, v55
    buffer_load_dwordx4 v28, s[4:7], s72 offen offset:0 lds
    v_mfma_f32_32x32x16_bf16 v[224:239], v[72:75], v[92:95], v[224:239]
    v_lshlrev_b32 v54, 16, v75
    v_and_b32 v55, s84, v75
    buffer_load_dwordx4 v29, s[4:7], s72 offen offset:1024 lds
    v_mfma_f32_32x32x16_bf16 v[240:255], v[76:79], v[92:95], v[240:255]
    v_add_f32 v52, v52, v54
    v_add_f32 v52, v52, v55
    buffer_load_dwordx4 v30, s[4:7], s72 offen offset:2048 lds
    s_waitcnt lgkmcnt(0)
    v_mfma_f32_32x32x16_bf16 v[128:143], v[96:99], v[104:107], v[128:143]
    s_waitcnt vmcnt(14)
    s_barrier
    ds_read_b64_tr_b16 v[120:121], v44 offset:49152
    ds_read_b64_tr_b16 v[122:123], v44 offset:49664
    v_lshlrev_b32 v54, 16, v76
    v_and_b32 v55, s84, v76
    v_mfma_f32_32x32x16_bf16 v[144:159], v[100:103], v[104:107], v[144:159]
    ds_read_b128 v[80:83], v36 offset:49152
    ds_read_b64_tr_b16 v[124:125], v44 offset:57344
    v_add_f32 v53, v53, v54
    v_add_f32 v53, v53, v55
    v_mfma_f32_32x32x16_bf16 v[160:175], v[96:99], v[108:111], v[160:175]
    ds_read_b64_tr_b16 v[126:127], v44 offset:57856
    ds_read_b128 v[84:87], v36 offset:51200
    v_lshlrev_b32 v54, 16, v77
    v_and_b32 v55, s84, v77
    v_mfma_f32_32x32x16_bf16 v[176:191], v[100:103], v[108:111], v[176:191]
    ds_read_b128 v[88:91], v36 offset:53248
    ds_read_b128 v[92:95], v36 offset:55296
    v_add_f32 v53, v53, v54
    v_add_f32 v53, v53, v55
    v_mfma_f32_32x32x16_bf16 v[192:207], v[96:99], v[112:115], v[192:207]
    v_lshlrev_b32 v54, 16, v78
    v_and_b32 v55, s84, v78
    v_mfma_f32_32x32x16_bf16 v[208:223], v[100:103], v[112:115], v[208:223]
    v_add_f32 v53, v53, v54
    v_add_f32 v53, v53, v55
    buffer_load_dwordx4 v31, s[4:7], s72 offen offset:3072 lds
    s_add_u32 s72, s72, 128
    s_and_b32 s72, s72, 0x3ff
    s_add_u32 m0, s76, 0
    v_mfma_f32_32x32x16_bf16 v[224:239], v[96:99], v[116:119], v[224:239]
    v_lshlrev_b32 v54, 16, v79
    v_and_b32 v55, s84, v79
    s_mul_i32 s73, s72, s74
    buffer_load_dwordx4 v32, s[8:11], s73 offen offset:0 lds
    v_mfma_f32_32x32x16_bf16 v[240:255], v[100:103], v[116:119], v[240:255]
    v_add_f32 v53, v53, v54
    v_add_f32 v53, v53, v55
    buffer_load_dwordx4 v33, s[8:11], s73 offen offset:1024 lds
    s_waitcnt lgkmcnt(0)
    v_mfma_f32_32x32x16_bf16 v[128:143], v[120:123], v[80:83], v[128:143]
    ds_read_b64_tr_b16 v[72:73], v45 offset:51200
    ds_read_b64_tr_b16 v[74:75], v45 offset:51712
    v_lshlrev_b32 v54, 16, v120
    v_and_b32 v55, s84, v120
    v_mfma_f32_32x32x16_bf16 v[144:159], v[124:127], v[80:83], v[144:159]
    ds_read_b128 v[104:107], v37 offset:49152
    ds_read_b64_tr_b16 v[76:77], v45 offset:59392
    v_add_f32 v52, v52, v54
    v_add_f32 v52, v52, v55
    v_mfma_f32_32x32x16_bf16 v[160:175], v[120:123], v[84:87], v[160:175]
    ds_read_b64_tr_b16 v[78:79], v45 offset:59904
    ds_read_b128 v[108:111], v37 offset:51200
    v_lshlrev_b32 v54, 16, v121
    v_and_b32 v55, s84, v121
    v_mfma_f32_32x32x16_bf16 v[176:191], v[124:127], v[84:87], v[176:191]
    ds_read_b128 v[112:115], v37 offset:53248
    ds_read_b128 v[116:119], v37 offset:55296
    v_add_f32 v52, v52, v54
    v_add_f32 v52, v52, v55
    v_mfma_f32_32x32x16_bf16 v[192:207], v[120:123], v[88:91], v[192:207]
    v_lshlrev_b32 v54, 16, v122
    v_and_b32 v55, s84, v122
    v_mfma_f32_32x32x16_bf16 v[208:223], v[124:127], v[88:91], v[208:223]
    v_add_f32 v52, v52, v54
    v_add_f32 v52, v52, v55
    buffer_load_dwordx4 v34, s[8:11], s73 offen offset:2048 lds
    v_mfma_f32_32x32x16_bf16 v[224:239], v[120:123], v[92:95], v[224:239]
    v_lshlrev_b32 v54, 16, v123
    v_and_b32 v55, s84, v123
    buffer_load_dwordx4 v35, s[8:11], s73 offen offset:3072 lds
    s_add_u32 m0, s75, 0
    v_mfma_f32_32x32x16_bf16 v[240:255], v[124:127], v[92:95], v[240:255]
    v_add_f32 v52, v52, v54
    v_add_f32 v52, v52, v55
    buffer_load_dwordx4 v24, s[4:7], s72 offen offset:0 lds
    s_waitcnt lgkmcnt(0)
    v_mfma_f32_32x32x16_bf16 v[128:143], v[72:75], v[104:107], v[128:143]
    ds_read_b64_tr_b16 v[96:97], v44 offset:53248
    ds_read_b64_tr_b16 v[98:99], v44 offset:53760
    v_lshlrev_b32 v54, 16, v124
    v_and_b32 v55, s84, v124
    v_mfma_f32_32x32x16_bf16 v[144:159], v[76:79], v[104:107], v[144:159]
    ds_read_b128 v[80:83], v38 offset:49152
    ds_read_b64_tr_b16 v[100:101], v44 offset:61440
    v_add_f32 v53, v53, v54
    v_add_f32 v53, v53, v55
    v_mfma_f32_32x32x16_bf16 v[160:175], v[72:75], v[108:111], v[160:175]
    ds_read_b64_tr_b16 v[102:103], v44 offset:61952
    ds_read_b128 v[84:87], v38 offset:51200
    v_lshlrev_b32 v54, 16, v125
    v_and_b32 v55, s84, v125
    v_mfma_f32_32x32x16_bf16 v[176:191], v[76:79], v[108:111], v[176:191]
    ds_read_b128 v[88:91], v38 offset:53248
    ds_read_b128 v[92:95], v38 offset:55296
    v_add_f32 v53, v53, v54
    v_add_f32 v53, v53, v55
    v_mfma_f32_32x32x16_bf16 v[192:207], v[72:75], v[112:115], v[192:207]
    v_lshlrev_b32 v54, 16, v126
    v_and_b32 v55, s84, v126
    v_mfma_f32_32x32x16_bf16 v[208:223], v[76:79], v[112:115], v[208:223]
    v_add_f32 v53, v53, v54
    v_add_f32 v53, v53, v55
    buffer_load_dwordx4 v25, s[4:7], s72 offen offset:1024 lds
    v_mfma_f32_32x32x16_bf16 v[224:239], v[72:75], v[116:119], v[224:239]
    v_lshlrev_b32 v54, 16, v127
    v_and_b32 v55, s84, v127
    buffer_load_dwordx4 v26, s[4:7], s72 offen offset:2048 lds
    v_mfma_f32_32x32x16_bf16 v[240:255], v[76:79], v[116:119], v[240:255]
    v_add_f32 v53, v53, v54
    v_add_f32 v53, v53, v55
    buffer_load_dwordx4 v27, s[4:7], s72 offen offset:3072 lds
    s_waitcnt lgkmcnt(0)
    v_mfma_f32_32x32x16_bf16 v[128:143], v[96:99], v[80:83], v[128:143]
    ds_read_b64_tr_b16 v[120:121], v45 offset:55296
    ds_read_b64_tr_b16 v[122:123], v45 offset:55808
    v_lshlrev_b32 v54, 16, v96
    v_and_b32 v55, s84, v96
    v_mfma_f32_32x32x16_bf16 v[144:159], v[100:103], v[80:83], v[144:159]
    ds_read_b128 v[104:107], v39 offset:49152
    ds_read_b64_tr_b16 v[124:125], v45 offset:63488
    v_add_f32 v52, v52, v54
    v_add_f32 v52, v52, v55
    v_mfma_f32_32x32x16_bf16 v[160:175], v[96:99], v[84:87], v[160:175]
    ds_read_b64_tr_b16 v[126:127], v45 offset:64000
    ds_read_b128 v[108:111], v39 offset:51200
    v_lshlrev_b32 v54, 16, v97
    v_and_b32 v55, s84, v97
    v_mfma_f32_32x32x16_bf16 v[176:191], v[100:103], v[84:87], v[176:191]
    ds_read_b128 v[112:115], v39 offset:53248
    ds_read_b128 v[116:119], v39 offset:55296
    v_add_f32 v52, v52, v54
    v_add_f32 v52, v52, v55
    v_mfma_f32_32x32x16_bf16 v[192:207], v[96:99], v[88:91], v[192:207]
    v_lshlrev_b32 v54, 16, v98
    v_and_b32 v55, s84, v98
    s_add_u32 m0, s75, 4096
    v_mfma_f32_32x32x16_bf16 v[208:223], v[100:103], v[88:91], v[208:223]
    v_add_f32 v52, v52, v54
    v_add_f32 v52, v52, v55
    buffer_load_dwordx4 v28, s[4:7], s72 offen offset:0 lds
    v_mfma_f32_32x32x16_bf16 v[224:239], v[96:99], v[92:95], v[224:239]
    v_lshlrev_b32 v54, 16, v99
    v_and_b32 v55, s84, v99
    buffer_load_dwordx4 v29, s[4:7], s72 offen offset:1024 lds
    v_mfma_f32_32x32x16_bf16 v[240:255], v[100:103], v[92:95], v[240:255]
    v_add_f32 v52, v52, v54
    v_add_f32 v52, v52, v55
    buffer_load_dwordx4 v30, s[4:7], s72 offen offset:2048 lds
    s_waitcnt lgkmcnt(0)
    v_mfma_f32_32x32x16_bf16 v[128:143], v[120:123], v[104:107], v[128:143]
    s_waitcnt vmcnt(11)
    s_barrier
    ds_read_b64_tr_b16 v[72:73], v48 offset:0
    ds_read_b64_tr_b16 v[74:75], v48 offset:512
    v_lshlrev_b32 v54, 16, v100
    v_and_b32 v55, s84, v100
    v_mfma_f32_32x32x16_bf16 v[144:159], v[124:127], v[104:107], v[144:159]
    ds_read_b128 v[80:83], v40 offset:0
    ds_read_b64_tr_b16 v[76:77], v48 offset:8192
    v_add_f32 v53, v53, v54
    v_add_f32 v53, v53, v55
    v_mfma_f32_32x32x16_bf16 v[160:175], v[120:123], v[108:111], v[160:175]
    ds_read_b64_tr_b16 v[78:79], v48 offset:8704
    ds_read_b128 v[84:87], v40 offset:2048
    v_lshlrev_b32 v54, 16, v101
    v_and_b32 v55, s84, v101
    v_mfma_f32_32x32x16_bf16 v[176:191], v[124:127], v[108:111], v[176:191]
    ds_read_b128 v[88:91], v40 offset:4096
    ds_read_b128 v[92:95], v40 offset:6144
    v_add_f32 v53, v53, v54
    v_add_f32 v53, v53, v55
    v_mfma_f32_32x32x16_bf16 v[192:207], v[120:123], v[112:115], v[192:207]
    v_lshlrev_b32 v54, 16, v102
    v_and_b32 v55, s84, v102
    v_mfma_f32_32x32x16_bf16 v[208:223], v[124:127], v[112:115], v[208:223]
    v_add_f32 v53, v53, v54
    v_add_f32 v53, v53, v55
    buffer_load_dwordx4 v31, s[4:7], s72 offen offset:3072 lds
    s_add_u32 s72, s72, 128
    s_and_b32 s72, s72, 0x3ff
    s_add_u32 m0, s76, 49152
    v_mfma_f32_32x32x16_bf16 v[224:239], v[120:123], v[116:119], v[224:239]
    v_lshlrev_b32 v54, 16, v103
    v_and_b32 v55, s84, v103
    s_mul_i32 s73, s72, s74
    buffer_load_dwordx4 v32, s[8:11], s73 offen offset:0 lds
    v_mfma_f32_32x32x16_bf16 v[240:255], v[124:127], v[116:119], v[240:255]
    v_add_f32 v53, v53, v54
    v_add_f32 v53, v53, v55
    buffer_load_dwordx4 v33, s[8:11], s73 offen offset:1024 lds
    s_waitcnt lgkmcnt(0)
    v_mfma_f32_32x32x16_bf16 v[128:143], v[72:75], v[80:83], v[128:143]
    ds_read_b64_tr_b16 v[96:97], v49 offset:2048
    ds_read_b64_tr_b16 v[98:99], v49 offset:2560
    v_lshlrev_b32 v54, 16, v72
    v_and_b32 v55, s84, v72
    v_mfma_f32_32x32x16_bf16 v[144:159], v[76:79], v[80:83], v[144:159]
    ds_read_b128 v[104:107], v41 offset:0
    ds_read_b64_tr_b16 v[100:101], v49 offset:10240
    v_add_f32 v52, v52, v54
    v_add_f32 v52, v52, v55
    v_mfma_f32_32x32x16_bf16 v[160:175], v[72:75], v[84:87], v[160:175]
    ds_read_b64_tr_b16 v[102:103], v49 offset:10752
    ds_read_b128 v[108:111], v41 offset:2048
    v_lshlrev_b32 v54, 16, v73
    v_and_b32 v55, s84, v73
    v_mfma_f32_32x32x16_bf16 v[176:191], v[76:79], v[84:87], v[176:191]
    ds_read_b128 v[112:115], v41 offset:4096
    ds_read_b128 v[116:119], v41 offset:6144
    v_add_f32 v52, v52, v54
    v_add_f32 v52, v52, v55
    v_mfma_f32_32x32x16_bf16 v[192:207], v[72:75], v[88:91], v[192:207]
    v_lshlrev_b32 v54, 16, v74
    v_and_b32 v55, s84, v74
    v_mfma_f32_32x32x16_bf16 v[208:223], v[76:79], v[88:91], v[208:223]
    v_add_f32 v52, v52, v54
    v_add_f32 v52, v52, v55
    buffer_load_dwordx4 v34, s[8:11], s73 offen offset:2048 lds
    v_mfma_f32_32x32x16_bf16 v[224:239], v[72:75], v[92:95], v[224:239]
    v_lshlrev_b32 v54, 16, v75
    v_and_b32 v55, s84, v75
    buffer_load_dwordx4 v35, s[8:11], s73 offen offset:3072 lds
    s_add_u32 m0, s75, 49152
    v_mfma_f32_32x32x16_bf16 v[240:255], v[76:79], v[92:95], v[240:255]
    v_add_f32 v52, v52, v54
    v_add_f32 v52, v52, v55
    buffer_load_dwordx4 v24, s[4:7], s72 offen offset:0 lds
    s_waitcnt lgkmcnt(0)
    v_mfma_f32_32x32x16_bf16 v[128:143], v[96:99], v[104:107], v[128:143]
    ds_read_b64_tr_b16 v[120:121], v48 offset:4096
    ds_read_b64_tr_b16 v[122:123], v48 offset:4608
    v_lshlrev_b32 v54, 16, v76
    v_and_b32 v55, s84, v76
    v_mfma_f32_32x32x16_bf16 v[144:159], v[100:103], v[104:107], v[144:159]
    ds_read_b128 v[80:83], v42 offset:0
    ds_read_b64_tr_b16 v[124:125], v48 offset:12288
    v_add_f32 v53, v53, v54
    v_add_f32 v53, v53, v55
    v_mfma_f32_32x32x16_bf16 v[160:175], v[96:99], v[108:111], v[160:175]
    ds_read_b64_tr_b16 v[126:127], v48 offset:12800
    ds_read_b128 v[84:87], v42 offset:2048
    v_lshlrev_b32 v54, 16, v77
    v_and_b32 v55, s84, v77
    v_mfma_f32_32x32x16_bf16 v[176:191], v[100:103], v[108:111], v[176:191]
    ds_read_b128 v[88:91], v42 offset:4096
    ds_read_b128 v[92:95], v42 offset:6144
    v_add_f32 v53, v53, v54
    v_add_f32 v53, v53, v55
    v_mfma_f32_32x32x16_bf16 v[192:207], v[96:99], v[112:115], v[192:207]
    v_lshlrev_b32 v54, 16, v78
    v_and_b32 v55, s84, v78
    v_mfma_f32_32x32x16_bf16 v[208:223], v[100:103], v[112:115], v[208:223]
    v_add_f32 v53, v53, v54
    v_add_f32 v53, v53, v55
    buffer_load_dwordx4 v25, s[4:7], s72 offen offset:1024 lds
    v_mfma_f32_32x32x16_bf16 v[224:239], v[96:99], v[116:119], v[224:239]
    v_lshlrev_b32 v54, 16, v79
    v_and_b32 v55, s84, v79
    buffer_load_dwordx4 v26, s[4:7], s72 offen offset:2048 lds
    v_mfma_f32_32x32x16_bf16 v[240:255], v[100:103], v[116:119], v[240:255]
    v_add_f32 v53, v53, v54
    v_add_f32 v53, v53, v55
    buffer_load_dwordx4 v27, s[4:7], s72 offen offset:3072 lds
    s_waitcnt lgkmcnt(0)
    v_mfma_f32_32x32x16_bf16 v[128:143], v[120:123], v[80:83], v[128:143]
    ds_read_b64_tr_b16 v[72:73], v49 offset:6144
    ds_read_b64_tr_b16 v[74:75], v49 offset:6656
    v_lshlrev_b32 v54, 16, v120
    v_and_b32 v55, s84, v120
    v_mfma_f32_32x32x16_bf16 v[144:159], v[124:127], v[80:83], v[144:159]
    ds_read_b128 v[104:107], v43 offset:0
    ds_read_b64_tr_b16 v[76:77], v49 offset:14336
    v_add_f32 v52, v52, v54
    v_add_f32 v52, v52, v55
    v_mfma_f32_32x32x16_bf16 v[160:175], v[120:123], v[84:87], v[160:175]
    ds_read_b64_tr_b16 v[78:79], v49 offset:14848
    ds_read_b128 v[108:111], v43 offset:2048
    v_lshlrev_b32 v54, 16, v121
    v_and_b32 v55, s84, v121
    v_mfma_f32_32x32x16_bf16 v[176:191], v[124:127], v[84:87], v[176:191]
    ds_read_b128 v[112:115], v43 offset:4096
    ds_read_b128 v[116:119], v43 offset:6144
    v_add_f32 v52, v52, v54
    v_add_f32 v52, v52, v55
    v_mfma_f32_32x32x16_bf16 v[192:207], v[120:123], v[88:91], v[192:207]
    v_lshlrev_b32 v54, 16, v122
    v_and_b32 v55, s84, v122
    s_add_u32 m0, s75, 53248
    v_mfma_f32_32x32x16_bf16 v[208:223], v[124:127], v[88:91], v[208:223]
    v_add_f32 v52, v52, v54
    v_add_f32 v52, v52, v55
    buffer_load_dwordx4 v28, s[4:7], s72 offen offset:0 lds
    v_mfma_f32_32x32x16_bf16 v[224:239], v[120:123], v[92:95], v[224:239]
    v_lshlrev_b32 v54, 16, v123
    v_and_b32 v55, s84, v123
    buffer_load_dwordx4 v29, s[4:7], s72 offen offset:1024 lds
    v_mfma_f32_32x32x16_bf16 v[240:255], v[124:127], v[92:95], v[240:255]
    v_add_f32 v52, v52, v54
    v_add_f32 v52, v52, v55
    buffer_load_dwordx4 v30, s[4:7], s72 offen offset:2048 lds
    s_waitcnt lgkmcnt(0)
    v_mfma_f32_32x32x16_bf16 v[128:143], v[72:75], v[104:107], v[128:143]
    s_waitcnt vmcnt(11)
    s_barrier
    ds_read_b64_tr_b16 v[96:97], v44 offset:0
    ds_read_b64_tr_b16 v[98:99], v44 offset:512
    v_lshlrev_b32 v54, 16, v124
    v_and_b32 v55, s84, v124
    v_mfma_f32_32x32x16_bf16 v[144:159], v[76:79], v[104:107], v[144:159]
    ds_read_b128 v[80:83], v36 offset:0
    ds_read_b64_tr_b16 v[100:101], v44 offset:8192
    v_add_f32 v53, v53, v54
    v_add_f32 v53, v53, v55
    v_mfma_f32_32x32x16_bf16 v[160:175], v[72:75], v[108:111], v[160:175]
    ds_read_b64_tr_b16 v[102:103], v44 offset:8704
    ds_read_b128 v[84:87], v36 offset:2048
    v_lshlrev_b32 v54, 16, v125
    v_and_b32 v55, s84, v125
    v_mfma_f32_32x32x16_bf16 v[176:191], v[76:79], v[108:111], v[176:191]
    ds_read_b128 v[88:91], v36 offset:4096
    ds_read_b128 v[92:95], v36 offset:6144
    s_mov_b32 s28, s60
    s_mov_b32 s29, s61
    s_mov_b32 s30, 256
    s_mov_b32 s31, 0x00020000
    v_min_u32 v2, 15, v1
    v_lshlrev_b32 v2, 2, v2
    buffer_load_dword v3, v2, s[28:31], 0 offen sc1
    v_add_f32 v53, v53, v54
    v_add_f32 v53, v53, v55
    v_mfma_f32_32x32x16_bf16 v[192:207], v[72:75], v[112:115], v[192:207]
    v_lshlrev_b32 v54, 16, v126
    v_and_b32 v55, s84, v126
    v_mfma_f32_32x32x16_bf16 v[208:223], v[76:79], v[112:115], v[208:223]
    v_add_f32 v53, v53, v54
    v_add_f32 v53, v53, v55
    buffer_load_dwordx4 v31, s[4:7], s72 offen offset:3072 lds
    s_add_u32 s72, s72, 128
    s_and_b32 s72, s72, 0x3ff
    s_add_u32 m0, s77, 0
    v_mfma_f32_32x32x16_bf16 v[224:239], v[72:75], v[116:119], v[224:239]
    v_lshlrev_b32 v54, 16, v127
    v_and_b32 v55, s84, v127
    s_add_u32 s89, s85, 0
    buffer_load_dwordx4 v16, s[16:19], s89 offen offset:0 lds
    v_mfma_f32_32x32x16_bf16 v[240:255], v[76:79], v[116:119], v[240:255]
    v_add_f32 v53, v53, v54
    v_add_f32 v53, v53, v55
    buffer_load_dwordx4 v17, s[16:19], s89 offen offset:1024 lds
    s_waitcnt lgkmcnt(0)
    v_mfma_f32_32x32x16_bf16 v[128:143], v[96:99], v[80:83], v[128:143]
    ds_read_b64_tr_b16 v[120:121], v45 offset:2048
    ds_read_b64_tr_b16 v[122:123], v45 offset:2560
    v_lshlrev_b32 v54, 16, v96
    v_and_b32 v55, s84, v96
    v_mfma_f32_32x32x16_bf16 v[144:159], v[100:103], v[80:83], v[144:159]
    ds_read_b128 v[104:107], v37 offset:0
    ds_read_b64_tr_b16 v[124:125], v45 offset:10240
    v_add_f32 v52, v52, v54
    v_add_f32 v52, v52, v55
    v_mfma_f32_32x32x16_bf16 v[160:175], v[96:99], v[84:87], v[160:175]
    ds_read_b64_tr_b16 v[126:127], v45 offset:10752
    ds_read_b128 v[108:111], v37 offset:2048
    v_lshlrev_b32 v54, 16, v97
    v_and_b32 v55, s84, v97
    v_mfma_f32_32x32x16_bf16 v[176:191], v[100:103], v[84:87], v[176:191]
    ds_read_b128 v[112:115], v37 offset:4096
    ds_read_b128 v[116:119], v37 offset:6144
    v_add_f32 v52, v52, v54
    v_add_f32 v52, v52, v55
    v_mfma_f32_32x32x16_bf16 v[192:207], v[96:99], v[88:91], v[192:207]
    v_lshlrev_b32 v54, 16, v98
    v_and_b32 v55, s84, v98
    v_mfma_f32_32x32x16_bf16 v[208:223], v[100:103], v[88:91], v[208:223]
    v_add_f32 v52, v52, v54
    v_add_f32 v52, v52, v55
    buffer_load_dwordx4 v18, s[16:19], s89 offen offset:2048 lds
    v_mfma_f32_32x32x16_bf16 v[224:239], v[96:99], v[92:95], v[224:239]
    v_lshlrev_b32 v54, 16, v99
    v_and_b32 v55, s84, v99
    buffer_load_dwordx4 v19, s[16:19], s89 offen offset:3072 lds
    s_add_u32 m0, s77, 4096
    v_mfma_f32_32x32x16_bf16 v[240:255], v[100:103], v[92:95], v[240:255]
    v_add_f32 v52, v52, v54
    v_add_f32 v52, v52, v55
    s_add_u32 s89, s86, 0
    buffer_load_dwordx4 v16, s[16:19], s89 offen offset:0 lds
    s_waitcnt lgkmcnt(0)
    v_mfma_f32_32x32x16_bf16 v[128:143], v[120:123], v[104:107], v[128:143]
    ds_read_b64_tr_b16 v[72:73], v44 offset:4096
    ds_read_b64_tr_b16 v[74:75], v44 offset:4608
    v_lshlrev_b32 v54, 16, v100
    v_and_b32 v55, s84, v100
    v_mfma_f32_32x32x16_bf16 v[144:159], v[124:127], v[104:107], v[144:159]
    ds_read_b128 v[80:83], v38 offset:0
    ds_read_b64_tr_b16 v[76:77], v44 offset:12288
    v_add_f32 v53, v53, v54
    v_add_f32 v53, v53, v55
    v_mfma_f32_32x32x16_bf16 v[160:175], v[120:123], v[108:111], v[160:175]
    ds_read_b64_tr_b16 v[78:79], v44 offset:12800
    ds_read_b128 v[84:87], v38 offset:2048
    v_lshlrev_b32 v54, 16, v101
    v_and_b32 v55, s84, v101
    v_mfma_f32_32x32x16_bf16 v[176:191], v[124:127], v[108:111], v[176:191]
    ds_read_b128 v[88:91], v38 offset:4096
    ds_read_b128 v[92:95], v38 offset:6144
    v_add_f32 v53, v53, v54
    v_add_f32 v53, v53, v55
    v_mfma_f32_32x32x16_bf16 v[192:207], v[120:123], v[112:115], v[192:207]
    v_lshlrev_b32 v54, 16, v102
    v_and_b32 v55, s84, v102
    v_mfma_f32_32x32x16_bf16 v[208:223], v[124:127], v[112:115], v[208:223]
    v_add_f32 v53, v53, v54
    v_add_f32 v53, v53, v55
    buffer_load_dwordx4 v17, s[16:19], s89 offen offset:1024 lds
    v_mfma_f32_32x32x16_bf16 v[224:239], v[120:123], v[116:119], v[224:239]
    v_lshlrev_b32 v54, 16, v103
    v_and_b32 v55, s84, v103
    buffer_load_dwordx4 v18, s[16:19], s89 offen offset:2048 lds
    v_mfma_f32_32x32x16_bf16 v[240:255], v[124:127], v[116:119], v[240:255]
    v_add_f32 v53, v53, v54
    v_add_f32 v53, v53, v55
    buffer_load_dwordx4 v19, s[16:19], s89 offen offset:3072 lds
    s_waitcnt lgkmcnt(0)
    v_mfma_f32_32x32x16_bf16 v[128:143], v[72:75], v[80:83], v[128:143]
    ds_read_b64_tr_b16 v[96:97], v45 offset:6144
    ds_read_b64_tr_b16 v[98:99], v45 offset:6656
    v_lshlrev_b32 v54, 16, v72
    v_and_b32 v55, s84, v72
    v_mfma_f32_32x32x16_bf16 v[144:159], v[76:79], v[80:83], v[144:159]
    ds_read_b128 v[104:107], v39 offset:0
    ds_read_b64_tr_b16 v[100:101], v45 offset:14336
    v_add_f32 v52, v52, v54
    v_add_f32 v52, v52, v55
    v_mfma_f32_32x32x16_bf16 v[160:175], v[72:75], v[84:87], v[160:175]
    ds_read_b64_tr_b16 v[102:103], v45 offset:14848
    ds_read_b128 v[108:111], v39 offset:2048
    v_lshlrev_b32 v54, 16, v73
    v_and_b32 v55, s84, v73
    v_mfma_f32_32x32x16_bf16 v[176:191], v[76:79], v[84:87], v[176:191]
    ds_read_b128 v[112:115], v39 offset:4096
    ds_read_b128 v[116:119], v39 offset:6144
    v_add_f32 v52, v52, v54
    v_add_f32 v52, v52, v55
    v_mfma_f32_32x32x16_bf16 v[192:207], v[72:75], v[88:91], v[192:207]
    v_lshlrev_b32 v54, 16, v74
    v_and_b32 v55, s84, v74
    s_add_u32 m0, s77, 8192
    v_mfma_f32_32x32x16_bf16 v[208:223], v[76:79], v[88:91], v[208:223]
    v_add_f32 v52, v52, v54
    v_add_f32 v52, v52, v55
    s_add_u32 s89, s85, 0
    buffer_load_dwordx4 v16, s[20:23], s89 offen offset:0 lds
    v_mfma_f32_32x32x16_bf16 v[224:239], v[72:75], v[92:95], v[224:239]
    v_lshlrev_b32 v54, 16, v75
    v_and_b32 v55, s84, v75
    buffer_load_dwordx4 v17, s[20:23], s89 offen offset:1024 lds
    v_mfma_f32_32x32x16_bf16 v[240:255], v[76:79], v[92:95], v[240:255]
    v_add_f32 v52, v52, v54
    v_add_f32 v52, v52, v55
    buffer_load_dwordx4 v18, s[20:23], s89 offen offset:2048 lds
    s_waitcnt lgkmcnt(0)
    v_mfma_f32_32x32x16_bf16 v[128:143], v[96:99], v[104:107], v[128:143]
    s_waitcnt vmcnt(11)
    s_barrier
    ds_read_b64_tr_b16 v[120:121], v44 offset:49152
    ds_read_b64_tr_b16 v[122:123], v44 offset:49664
    v_lshlrev_b32 v54, 16, v76
    v_and_b32 v55, s84, v76
    v_mfma_f32_32x32x16_bf16 v[144:159], v[100:103], v[104:107], v[144:159]
    ds_read_b128 v[80:83], v36 offset:49152
    ds_read_b64_tr_b16 v[124:125], v44 offset:57344
    v_add_f32 v53, v53, v54
    v_add_f32 v53, v53, v55
    v_mfma_f32_32x32x16_bf16 v[160:175], v[96:99], v[108:111], v[160:175]
    ds_read_b64_tr_b16 v[126:127], v44 offset:57856
    ds_read_b128 v[84:87], v36 offset:51200
    v_lshlrev_b32 v54, 16, v77
    v_and_b32 v55, s84, v77
    v_mfma_f32_32x32x16_bf16 v[176:191], v[100:103], v[108:111], v[176:191]
    ds_read_b128 v[88:91], v36 offset:53248
    ds_read_b128 v[92:95], v36 offset:55296
    s_mov_b32 s83, 200000
    s_branch Lpchk_3
Lpoll_1:
    buffer_load_dword v3, v2, s[28:31], 0 offen sc1
    s_waitcnt vmcnt(0)
Lpchk_3:
    v_cmp_ne_u32 vcc, 0, v3
    s_nop 1
    s_cmp_eq_u64 vcc, -1
    s_cbranch_scc1 Lpdone_2
    s_sub_u32 s83, s83, 1
    s_cbranch_scc1 Lpdone_2
    s_sleep 1
    s_branch Lpoll_1
Lpdone_2:
    s_lshl_b32 s81, s65, 1
    s_add_u32 s81, s81, s70
    s_lshl_b32 s82, s81, 9
    s_add_u32 s82, s82, 10551296
    s_lshl_b32 s81, s81, 11
    s_add_u32 s81, s81, 10485760
    v_bfe_u32 v4, v1, 4, 1
    v_and_b32 v5, 15, v1
    v_lshl_add_u32 v4, v4, 6, v5
    v_lshlrev_b32 v4, 4, v4
    buffer_load_dwordx4 v[56:59], v4, s[12:15], s81 offen offset:0 sc1
    buffer_load_dwordx4 v[60:63], v4, s[12:15], s81 offen offset:256 sc1
    buffer_load_dwordx4 v[64:67], v4, s[12:15], s81 offen offset:512 sc1
    buffer_load_dwordx4 v[68:71], v4, s[12:15], s81 offen offset:768 sc1
    v_add_f32 v53, v53, v54
    v_add_f32 v53, v53, v55
    v_mfma_f32_32x32x16_bf16 v[192:207], v[96:99], v[112:115], v[192:207]
    ds_read_b64_tr_b16 v[24:25], v44 offset:53248
    ds_read_b64_tr_b16 v[26:27], v44 offset:53760
    ds_read_b64_tr_b16 v[28:29], v44 offset:61440
    ds_read_b64_tr_b16 v[30:31], v44 offset:61952
    v_lshlrev_b32 v54, 16, v78
    v_and_b32 v55, s84, v78
    v_mfma_f32_32x32x16_bf16 v[208:223], v[100:103], v[112:115], v[208:223]
    v_add_f32 v53, v53, v54
    v_add_f32 v53, v53, v55
    buffer_load_dwordx4 v19, s[20:23], s89 offen offset:3072 lds
    s_add_u32 m0, s78, 0
    v_mfma_f32_32x32x16_bf16 v[224:239], v[96:99], v[116:119], v[224:239]
    v_lshlrev_b32 v54, 16, v79
    v_and_b32 v55, s84, v79
    s_add_u32 s89, s86, 0
    buffer_load_dwordx4 v16, s[20:23], s89 offen offset:0 lds
    v_mfma_f32_32x32x16_bf16 v[240:255], v[100:103], v[116:119], v[240:255]
    v_add_f32 v53, v53, v54
    v_add_f32 v53, v53, v55
    buffer_load_dwordx4 v17, s[20:23], s89 offen offset:1024 lds
    s_waitcnt lgkmcnt(0)
    v_mfma_f32_32x32x16_bf16 v[128:143], v[120:123], v[80:83], v[128:143]
    ds_read_b64_tr_b16 v[72:73], v45 offset:51200
    ds_read_b64_tr_b16 v[74:75], v45 offset:51712
    v_lshlrev_b32 v54, 16, v120
    v_and_b32 v55, s84, v120
    v_add_f32 v52, v52, v54
    v_add_f32 v52, v52, v55
    v_mfma_f32_32x32x16_bf16 v[144:159], v[124:127], v[80:83], v[144:159]
    ds_read_b128 v[104:107], v37 offset:49152
    ds_read_b64_tr_b16 v[76:77], v45 offset:59392
    v_lshlrev_b32 v54, 16, v121
    v_and_b32 v55, s84, v121
    v_add_f32 v52, v52, v54
    v_add_f32 v52, v52, v55
    v_mfma_f32_32x32x16_bf16 v[160:175], v[120:123], v[84:87], v[160:175]
    ds_read_b64_tr_b16 v[78:79], v45 offset:59904
    ds_read_b128 v[108:111], v37 offset:51200
    v_lshlrev_b32 v54, 16, v122
    v_and_b32 v55, s84, v122
    v_add_f32 v52, v52, v54
    v_add_f32 v52, v52, v55
    v_mfma_f32_32x32x16_bf16 v[176:191], v[124:127], v[84:87], v[176:191]
    ds_read_b128 v[112:115], v37 offset:53248
    ds_read_b128 v[116:119], v37 offset:55296
    v_lshlrev_b32 v54, 16, v123
    v_and_b32 v55, s84, v123
    v_add_f32 v52, v52, v54
    v_add_f32 v52, v52, v55
    v_mfma_f32_32x32x16_bf16 v[192:207], v[120:123], v[88:91], v[192:207]
    v_lshlrev_b32 v54, 16, v24
    v_and_b32 v55, s84, v24
    v_add_f32 v52, v52, v54
    v_add_f32 v52, v52, v55
    v_mfma_f32_32x32x16_bf16 v[208:223], v[124:127], v[88:91], v[208:223]
    v_lshlrev_b32 v54, 16, v25
    v_and_b32 v55, s84, v25
    v_add_f32 v52, v52, v54
    v_add_f32 v52, v52, v55
    buffer_load_dwordx4 v18, s[20:23], s89 offen offset:2048 lds
    v_mfma_f32_32x32x16_bf16 v[224:239], v[120:123], v[92:95], v[224:239]
    v_lshlrev_b32 v54, 16, v26
    v_and_b32 v55, s84, v26
    v_add_f32 v52, v52, v54
    v_add_f32 v52, v52, v55
    buffer_load_dwordx4 v19, s[20:23], s89 offen offset:3072 lds
    s_add_u32 m0, s78, 4096
    v_mfma_f32_32x32x16_bf16 v[240:255], v[124:127], v[92:95], v[240:255]
    v_lshlrev_b32 v54, 16, v27
    v_and_b32 v55, s84, v27
    v_add_f32 v52, v52, v54
    v_add_f32 v52, v52, v55
    s_add_u32 s89, s85, 128
    buffer_load_dwordx4 v16, s[16:19], s89 offen offset:0 lds
    s_waitcnt lgkmcnt(0)
    v_mfma_f32_32x32x16_bf16 v[128:143], v[72:75], v[104:107], v[128:143]
    ds_read_b64_tr_b16 v[96:97], v44 offset:53248
    ds_read_b64_tr_b16 v[98:99], v44 offset:53760
    v_lshlrev_b32 v54, 16, v124
    v_and_b32 v55, s84, v124
    v_add_f32 v53, v53, v54
    v_add_f32 v53, v53, v55
    v_mfma_f32_32x32x16_bf16 v[144:159], v[76:79], v[104:107], v[144:159]
    ds_read_b128 v[80:83], v38 offset:49152
    ds_read_b64_tr_b16 v[100:101], v44 offset:61440
    v_lshlrev_b32 v54, 16, v125
    v_and_b32 v55, s84, v125
    v_add_f32 v53, v53, v54
    v_add_f32 v53, v53, v55
    v_mfma_f32_32x32x16_bf16 v[160:175], v[72:75], v[108:111], v[160:175]
    ds_read_b64_tr_b16 v[102:103], v44 offset:61952
    ds_read_b128 v[84:87], v38 offset:51200
    v_lshlrev_b32 v54, 16, v126
    v_and_b32 v55, s84, v126
    v_add_f32 v53, v53, v54
    v_add_f32 v53, v53, v55
    v_mfma_f32_32x32x16_bf16 v[176:191], v[76:79], v[108:111], v[176:191]
    ds_read_b128 v[88:91], v38 offset:53248
    ds_read_b128 v[92:95], v38 offset:55296
    v_lshlrev_b32 v54, 16, v127
    v_and_b32 v55, s84, v127
    v_add_f32 v53, v53, v54
    v_add_f32 v53, v53, v55
    v_mfma_f32_32x32x16_bf16 v[192:207], v[72:75], v[112:115], v[192:207]
    v_lshlrev_b32 v54, 16, v28
    v_and_b32 v55, s84, v28
    v_add_f32 v53, v53, v54
    v_add_f32 v53, v53, v55
    v_mfma_f32_32x32x16_bf16 v[208:223], v[76:79], v[112:115], v[208:223]
    v_lshlrev_b32 v54, 16, v29
    v_and_b32 v55, s84, v29
    v_add_f32 v53, v53, v54
    v_add_f32 v53, v53, v55
    buffer_load_dwordx4 v17, s[16:19], s89 offen offset:1024 lds
    v_mfma_f32_32x32x16_bf16 v[224:239], v[72:75], v[116:119], v[224:239]
    v_lshlrev_b32 v54, 16, v30
    v_and_b32 v55, s84, v30
    v_add_f32 v53, v53, v54
    v_add_f32 v53, v53, v55
    buffer_load_dwordx4 v18, s[16:19], s89 offen offset:2048 lds
    v_mfma_f32_32x32x16_bf16 v[240:255], v[76:79], v[116:119], v[240:255]
    v_lshlrev_b32 v54, 16, v31
    v_and_b32 v55, s84, v31
    v_add_f32 v53, v53, v54
    v_add_f32 v53, v53, v55
    buffer_load_dwordx4 v19, s[16:19], s89 offen offset:3072 lds
    s_waitcnt lgkmcnt(0)
    v_mfma_f32_32x32x16_bf16 v[128:143], v[96:99], v[80:83], v[128:143]
    ds_read_b64_tr_b16 v[120:121], v45 offset:55296
    ds_read_b64_tr_b16 v[122:123], v45 offset:55808
    v_mfma_f32_32x32x16_bf16 v[144:159], v[100:103], v[80:83], v[144:159]
    ds_read_b128 v[104:107], v39 offset:49152
    ds_read_b64_tr_b16 v[124:125], v45 offset:63488
    v_mfma_f32_32x32x16_bf16 v[160:175], v[96:99], v[84:87], v[160:175]
    ds_read_b64_tr_b16 v[126:127], v45 offset:64000
    ds_read_b128 v[108:111], v39 offset:51200
    s_waitcnt vmcnt(9)
    v_mul_f32 v32, 0xc0135761, v57
    v_mul_f32 v33, v57, v57
    v_mfma_f32_32x32x16_bf16 v[176:191], v[100:103], v[84:87], v[176:191]
    ds_read_b128 v[112:115], v39 offset:53248
    ds_read_b128 v[116:119], v39 offset:55296
    v_mov_b32 v48, v58
    v_mul_f32 v33, 0x3d372713, v33
    v_mfma_f32_32x32x16_bf16 v[192:207], v[96:99], v[88:91], v[192:207]
    v_permlane32_swap_b32 v52, v53
    s_lshl_b32 s81, s64, 8
    s_add_u32 s81, s81, 147456
    v_add_f32 v52, v52, v53
    v_mul_f32 v33, v33, v32
    s_add_u32 m0, s78, 8192
    v_mfma_f32_32x32x16_bf16 v[208:223], v[100:103], v[88:91], v[208:223]
    v_lshl_add_u32 v54, v1, 2, s81
    v_xor_b32 v55, 256, v54
    ds_write_b32 v54, v52
    v_mul_f32 v34, 0xc0135761, v61
    s_add_u32 s89, s86, 128
    buffer_load_dwordx4 v16, s[16:19], s89 offen offset:0 lds
    v_mfma_f32_32x32x16_bf16 v[224:239], v[96:99], v[92:95], v[224:239]
    v_mul_f32 v35, v61, v61
    v_mov_b32 v49, v62
    v_mul_f32 v35, 0x3d372713, v35
    buffer_load_dwordx4 v17, s[16:19], s89 offen offset:1024 lds
    v_mfma_f32_32x32x16_bf16 v[240:255], v[100:103], v[92:95], v[240:255]
    v_mul_f32 v35, v35, v34
    v_mul_f32 v40, 0xc0135761, v65
    v_mul_f32 v41, v65, v65
    buffer_load_dwordx4 v18, s[16:19], s89 offen offset:2048 lds
    s_waitcnt lgkmcnt(0)
    v_mfma_f32_32x32x16_bf16 v[128:143], v[120:123], v[104:107], v[128:143]
    s_barrier
    ds_read_b32 v53, v55
    v_cmp_gt_u32 vcc, 32, v1
    v_mfma_f32_32x32x16_bf16 v[144:159], v[124:127], v[104:107], v[144:159]
    v_mov_b32 v50, v66
    v_mul_f32 v41, 0x3d372713, v41
    v_mul_f32 v41, v41, v40
    v_mul_f32 v42, 0xc0135761, v69
    v_mul_f32 v43, v69, v69
    v_mfma_f32_32x32x16_bf16 v[160:175], v[120:123], v[108:111], v[160:175]
    v_mov_b32 v51, v70
    v_mul_f32 v43, 0x3d372713, v43
    v_mul_f32 v43, v43, v42
    v_mov_b32 v57, v56
    v_mov_b32 v58, 0
    v_mfma_f32_32x32x16_bf16 v[176:191], v[124:127], v[108:111], v[176:191]
    v_mov_b32 v59, 0
    v_mov_b32 v61, v60
    v_mov_b32 v62, 0
    v_mov_b32 v63, 0
    v_mov_b32 v65, v64
    v_mfma_f32_32x32x16_bf16 v[192:207], v[120:123], v[112:115], v[192:207]
    v_mov_b32 v66, 0
    v_mov_b32 v67, 0
    v_mov_b32 v69, v68
    v_mov_b32 v70, 0
    v_mov_b32 v71, 0
    v_mfma_f32_32x32x16_bf16 v[208:223], v[124:127], v[112:115], v[208:223]
    s_waitcnt lgkmcnt(0)
    v_add_f32 v52, v52, v53
    v_mov_b32 v74, 0
    v_cvt_pk_bf16_f32 v54, v52, v52
    v_mov_b32 v75, 0
    v_mfma_f32_32x32x16_bf16 v[224:239], v[120:123], v[116:119], v[224:239]
    v_and_b32 v55, s84, v54
    v_sub_f32 v55, v52, v55
    v_cndmask_b32 v72, 0, v54, vcc
    v_cvt_pk_bf16_f32 v55, v55, v55
    v_cndmask_b32 v76, v54, 0, vcc
    v_mfma_f32_32x32x16_bf16 v[240:255], v[124:127], v[116:119], v[240:255]
    v_mov_b32 v78, 0
    v_mov_b32 v79, 0
    v_cndmask_b32 v73, 0, v55, vcc
    v_cndmask_b32 v77, v55, 0, vcc
    s_nop 0
    v_mfma_f32_32x32x16_bf16 v[128:143], v[72:75], v[56:59], v[128:143]
    s_lshl_b32 s79, s66, 1
    s_add_u32 s79, s79, s71
    s_lshl_b32 s80, s65, 1
    s_add_u32 s80, s80, s70
    s_mul_i32 s80, s80, 352256
    v_mfma_f32_32x32x16_bf16 v[144:159], v[76:79], v[56:59], v[144:159]
    s_lshl_b32 s81, s79, 12
    s_add_u32 s88, s80, s81
    s_add_u32 s92, s88, 176128
    s_cmp_eq_u32 s79, 43
    s_cselect_b32 s81, 2130706432, 0
    v_mfma_f32_32x32x16_bf16 v[160:175], v[72:75], v[60:63], v[160:175]
    v_lshl_add_u32 v2, v1, 4, s81
    v_and_b32 v36, 31, v1
    v_lshrrev_b32 v37, 5, v1
    v_bfe_u32 v38, v1, 1, 3
    v_xor_b32 v38, v38, v37
    v_mfma_f32_32x32x16_bf16 v[176:191], v[76:79], v[60:63], v[176:191]
    v_lshlrev_b32 v36, 7, v36
    v_add_u32 v36, s77, v36
    v_xor_b32 v39, 0, v38
    v_lshl_add_u32 v24, v39, 4, v36
    v_xor_b32 v39, 2, v38
    v_mfma_f32_32x32x16_bf16 v[192:207], v[72:75], v[64:67], v[192:207]
    v_lshl_add_u32 v25, v39, 4, v36
    v_xor_b32 v39, 4, v38
    v_lshl_add_u32 v26, v39, 4, v36
    v_xor_b32 v39, 6, v38
    v_lshl_add_u32 v27, v39, 4, v36
    v_mfma_f32_32x32x16_bf16 v[208:223], v[76:79], v[64:67], v[208:223]
    v_bfe_u32 v36, v1, 2, 2
    v_lshl_add_u32 v36, v37, 2, v36
    v_lshlrev_b32 v36, 7, v36
    v_add_u32 v36, s78, v36
    v_bfe_u32 v38, v1, 4, 1
    v_mfma_f32_32x32x16_bf16 v[224:239], v[72:75], v[68:71], v[224:239]
    v_lshl_add_u32 v36, v38, 5, v36
    v_and_b32 v38, 3, v1
    v_lshl_add_u32 v36, v38, 3, v36
    v_bfe_u32 v38, v1, 3, 1
    v_xor_b32 v38, s70, v38
    v_mfma_f32_32x32x16_bf16 v[240:255], v[76:79], v[68:71], v[240:255]
    v_lshl_add_u32 v28, v38, 6, v36
    v_xor_b32 v29, 64, v28
    v_add_u32 v30, 98304, v28
    v_add_u32 v31, 98304, v29
    v_pk_mul_f32 v[96:97], v[128:129], v[128:129]
    s_waitcnt vmcnt(11)
    v_pk_mul_f32 v[98:99], v[130:131], v[130:131]
    v_pk_fma_f32 v[96:97], v[96:97], v[32:33], v[32:33] op_sel:[0,1,0] op_sel_hi:[1,1,0]
    v_pk_fma_f32 v[98:99], v[98:99], v[32:33], v[32:33] op_sel:[0,1,0] op_sel_hi:[1,1,0]
    ds_read_b128 a[0:3], v24 offset:0
    ds_read_b128 a[8:11], v25 offset:0
    v_pk_mul_f32 v[96:97], v[96:97], v[128:129]
    v_pk_mul_f32 v[98:99], v[98:99], v[130:131]
    v_exp_f32 v96, v96
    v_exp_f32 v97, v97
    ds_read_b128 a[32:35], v26 offset:0
    ds_read_b128 a[40:43], v27 offset:0
    v_exp_f32 v98, v98
    v_exp_f32 v99, v99
    v_pk_mul_f32 v[100:101], v[128:129], v[144:145]
    v_pk_mul_f32 v[102:103], v[130:131], v[146:147]
    ds_read_b128 a[4:7], v24 offset:4096
    ds_read_b128 a[12:15], v25 offset:4096
    buffer_load_dwordx4 v19, s[16:19], s89 offen offset:3072 lds
    v_pk_fma_f32 v[96:97], v[96:97], v[48:49], v[48:49] op_sel:[0,0,0] op_sel_hi:[1,0,0]
    v_pk_fma_f32 v[98:99], v[98:99], v[48:49], v[48:49] op_sel:[0,0,0] op_sel_hi:[1,0,0]
    v_rcp_f32 v96, v96
    v_rcp_f32 v97, v97
    ds_read_b128 a[36:39], v26 offset:4096
    ds_read_b128 a[44:47], v27 offset:4096
    v_rcp_f32 v98, v98
    v_rcp_f32 v99, v99
    v_pk_mul_f32 v[100:101], v[100:101], v[96:97]
    ds_read_b128 a[16:19], v24 offset:8192
    ds_read_b128 a[24:27], v25 offset:8192
    v_pk_mul_f32 v[102:103], v[102:103], v[98:99]
    s_add_u32 m0, s78, 49152
    s_add_u32 s89, s85, 128
    buffer_load_dwordx4 v16, s[20:23], s89 offen offset:0 lds
    v_cvt_pk_bf16_f32 v104, v100, v101
    v_cvt_pk_bf16_f32 v105, v102, v103
    v_pk_mul_f32 v[96:97], v[132:133], v[132:133]
    ds_read_b128 a[48:51], v26 offset:8192
    ds_read_b128 a[56:59], v27 offset:8192
    v_pk_mul_f32 v[98:99], v[134:135], v[134:135]
    v_pk_fma_f32 v[96:97], v[96:97], v[32:33], v[32:33] op_sel:[0,1,0] op_sel_hi:[1,1,0]
    v_pk_fma_f32 v[98:99], v[98:99], v[32:33], v[32:33] op_sel:[0,1,0] op_sel_hi:[1,1,0]
    v_pk_mul_f32 v[96:97], v[96:97], v[132:133]
    v_subrev_u32 v24, 98304, v24
    v_subrev_u32 v25, 98304, v25
    v_subrev_u32 v26, 98304, v26
    v_subrev_u32 v27, 98304, v27
    buffer_load_dwordx4 v17, s[20:23], s89 offen offset:1024 lds
    v_pk_mul_f32 v[98:99], v[98:99], v[134:135]
    v_exp_f32 v96, v96
    v_exp_f32 v97, v97
    v_exp_f32 v98, v98
    v_exp_f32 v99, v99
    v_pk_mul_f32 v[100:101], v[132:133], v[148:149]
    v_pk_mul_f32 v[102:103], v[134:135], v[150:151]
    v_pk_fma_f32 v[96:97], v[96:97], v[48:49], v[48:49] op_sel:[0,0,0] op_sel_hi:[1,0,0]
    v_pk_fma_f32 v[98:99], v[98:99], v[48:49], v[48:49] op_sel:[0,0,0] op_sel_hi:[1,0,0]
    v_rcp_f32 v96, v96
    v_rcp_f32 v97, v97
    v_rcp_f32 v98, v98
    v_rcp_f32 v99, v99
    buffer_load_dwordx4 v18, s[20:23], s89 offen offset:2048 lds
    v_pk_mul_f32 v[100:101], v[100:101], v[96:97]
    v_pk_mul_f32 v[102:103], v[102:103], v[98:99]
    v_cvt_pk_bf16_f32 v106, v100, v101
    v_cvt_pk_bf16_f32 v107, v102, v103
    buffer_store_dwordx4 v[104:107], v2, s[12:15], s88 offen offset:0 sc1
    v_pk_mul_f32 v[96:97], v[136:137], v[136:137]
    v_pk_mul_f32 v[98:99], v[138:139], v[138:139]
    v_pk_fma_f32 v[96:97], v[96:97], v[32:33], v[32:33] op_sel:[0,1,0] op_sel_hi:[1,1,0]
    v_pk_fma_f32 v[98:99], v[98:99], v[32:33], v[32:33] op_sel:[0,1,0] op_sel_hi:[1,1,0]
    v_pk_mul_f32 v[96:97], v[96:97], v[136:137]
    v_pk_mul_f32 v[98:99], v[98:99], v[138:139]
    v_exp_f32 v96, v96
    v_exp_f32 v97, v97
    buffer_load_dwordx4 v19, s[20:23], s89 offen offset:3072 lds
    v_exp_f32 v98, v98
    v_exp_f32 v99, v99
    v_pk_mul_f32 v[100:101], v[136:137], v[152:153]
    v_pk_mul_f32 v[102:103], v[138:139], v[154:155]
    v_pk_fma_f32 v[96:97], v[96:97], v[48:49], v[48:49] op_sel:[0,0,0] op_sel_hi:[1,0,0]
    v_pk_fma_f32 v[98:99], v[98:99], v[48:49], v[48:49] op_sel:[0,0,0] op_sel_hi:[1,0,0]
    v_rcp_f32 v96, v96
    v_rcp_f32 v97, v97
    v_rcp_f32 v98, v98
    v_rcp_f32 v99, v99
    v_pk_mul_f32 v[100:101], v[100:101], v[96:97]
    v_pk_mul_f32 v[102:103], v[102:103], v[98:99]
    v_cvt_pk_bf16_f32 v108, v100, v101
    s_add_u32 m0, s78, 53248
    s_add_u32 s89, s86, 128
    buffer_load_dwordx4 v16, s[20:23], s89 offen offset:0 lds
    v_cvt_pk_bf16_f32 v109, v102, v103
    v_pk_mul_f32 v[96:97], v[140:141], v[140:141]
    v_pk_mul_f32 v[98:99], v[142:143], v[142:143]
    v_pk_fma_f32 v[96:97], v[96:97], v[32:33], v[32:33] op_sel:[0,1,0] op_sel_hi:[1,1,0]
    v_pk_fma_f32 v[98:99], v[98:99], v[32:33], v[32:33] op_sel:[0,1,0] op_sel_hi:[1,1,0]
    v_pk_mul_f32 v[96:97], v[96:97], v[140:141]
    v_pk_mul_f32 v[98:99], v[98:99], v[142:143]
    v_exp_f32 v96, v96
    v_exp_f32 v97, v97
    v_exp_f32 v98, v98
    v_exp_f32 v99, v99
    v_pk_mul_f32 v[100:101], v[140:141], v[156:157]
    v_pk_mul_f32 v[102:103], v[142:143], v[158:159]
    buffer_load_dwordx4 v17, s[20:23], s89 offen offset:1024 lds
    v_pk_fma_f32 v[96:97], v[96:97], v[48:49], v[48:49] op_sel:[0,0,0] op_sel_hi:[1,0,0]
    v_pk_fma_f32 v[98:99], v[98:99], v[48:49], v[48:49] op_sel:[0,0,0] op_sel_hi:[1,0,0]
    v_rcp_f32 v96, v96
    v_rcp_f32 v97, v97
    v_rcp_f32 v98, v98
    v_rcp_f32 v99, v99
    v_pk_mul_f32 v[100:101], v[100:101], v[96:97]
    v_pk_mul_f32 v[102:103], v[102:103], v[98:99]
    v_cvt_pk_bf16_f32 v110, v100, v101
    v_cvt_pk_bf16_f32 v111, v102, v103
    buffer_store_dwordx4 v[108:111], v2, s[12:15], s88 offen offset:2048 sc1
    v_pk_mul_f32 v[96:97], v[160:161], v[160:161]
    buffer_load_dwordx4 v18, s[20:23], s89 offen offset:2048 lds
    v_pk_mul_f32 v[98:99], v[162:163], v[162:163]
    v_pk_fma_f32 v[96:97], v[96:97], v[34:35], v[34:35] op_sel:[0,1,0] op_sel_hi:[1,1,0]
    v_pk_fma_f32 v[98:99], v[98:99], v[34:35], v[34:35] op_sel:[0,1,0] op_sel_hi:[1,1,0]
    v_pk_mul_f32 v[96:97], v[96:97], v[160:161]
    v_pk_mul_f32 v[98:99], v[98:99], v[162:163]
    v_exp_f32 v96, v96
    v_exp_f32 v97, v97
    v_exp_f32 v98, v98
    v_exp_f32 v99, v99
    v_pk_mul_f32 v[100:101], v[160:161], v[176:177]
    v_pk_mul_f32 v[102:103], v[162:163], v[178:179]
    v_pk_fma_f32 v[96:97], v[96:97], v[48:49], v[48:49] op_sel:[0,1,1] op_sel_hi:[1,1,1]
    v_pk_fma_f32 v[98:99], v[98:99], v[48:49], v[48:49] op_sel:[0,1,1] op_sel_hi:[1,1,1]
    buffer_load_dwordx4 v19, s[20:23], s89 offen offset:3072 lds
    v_rcp_f32 v96, v96
    v_rcp_f32 v97, v97
    v_rcp_f32 v98, v98
    v_rcp_f32 v99, v99
    v_pk_mul_f32 v[100:101], v[100:101], v[96:97]
    v_pk_mul_f32 v[102:103], v[102:103], v[98:99]
    v_cvt_pk_bf16_f32 v112, v100, v101
    v_cvt_pk_bf16_f32 v113, v102, v103
    v_pk_mul_f32 v[96:97], v[164:165], v[164:165]
    v_pk_mul_f32 v[98:99], v[166:167], v[166:167]
    v_pk_fma_f32 v[96:97], v[96:97], v[34:35], v[34:35] op_sel:[0,1,0] op_sel_hi:[1,1,0]
    v_pk_fma_f32 v[98:99], v[98:99], v[34:35], v[34:35] op_sel:[0,1,0] op_sel_hi:[1,1,0]
    v_pk_mul_f32 v[96:97], v[96:97], v[164:165]
    s_add_u32 m0, s78, 57344
    s_add_u32 s89, s87, 0
    buffer_load_dwordx4 v20, s[24:27], s89 offen offset:0 lds
    v_pk_mul_f32 v[98:99], v[98:99], v[166:167]
    v_exp_f32 v96, v96
    v_exp_f32 v97, v97
    v_exp_f32 v98, v98
    v_exp_f32 v99, v99
    v_pk_mul_f32 v[100:101], v[164:165], v[180:181]
    v_pk_mul_f32 v[102:103], v[166:167], v[182:183]
    v_pk_fma_f32 v[96:97], v[96:97], v[48:49], v[48:49] op_sel:[0,1,1] op_sel_hi:[1,1,1]
    v_pk_fma_f32 v[98:99], v[98:99], v[48:49], v[48:49] op_sel:[0,1,1] op_sel_hi:[1,1,1]
    v_rcp_f32 v96, v96
    v_rcp_f32 v97, v97
    v_rcp_f32 v98, v98
    v_rcp_f32 v99, v99
    buffer_load_dwordx4 v21, s[24:27], s89 offen offset:1024 lds
    v_pk_mul_f32 v[100:101], v[100:101], v[96:97]
    v_pk_mul_f32 v[102:103], v[102:103], v[98:99]
    v_cvt_pk_bf16_f32 v114, v100, v101
    v_cvt_pk_bf16_f32 v115, v102, v103
    buffer_store_dwordx4 v[112:115], v2, s[12:15], s88 offen offset:1024 sc1
    v_pk_mul_f32 v[96:97], v[168:169], v[168:169]
    v_pk_mul_f32 v[98:99], v[170:171], v[170:171]
    v_pk_fma_f32 v[96:97], v[96:97], v[34:35], v[34:35] op_sel:[0,1,0] op_sel_hi:[1,1,0]
    v_pk_fma_f32 v[98:99], v[98:99], v[34:35], v[34:35] op_sel:[0,1,0] op_sel_hi:[1,1,0]
    v_pk_mul_f32 v[96:97], v[96:97], v[168:169]
    v_pk_mul_f32 v[98:99], v[98:99], v[170:171]
    v_exp_f32 v96, v96
    v_exp_f32 v97, v97
    buffer_load_dwordx4 v22, s[24:27], s89 offen offset:2048 lds
    v_exp_f32 v98, v98
    v_exp_f32 v99, v99
    v_pk_mul_f32 v[100:101], v[168:169], v[184:185]
    v_pk_mul_f32 v[102:103], v[170:171], v[186:187]
    v_pk_fma_f32 v[96:97], v[96:97], v[48:49], v[48:49] op_sel:[0,1,1] op_sel_hi:[1,1,1]
    v_pk_fma_f32 v[98:99], v[98:99], v[48:49], v[48:49] op_sel:[0,1,1] op_sel_hi:[1,1,1]
    v_rcp_f32 v96, v96
    v_rcp_f32 v97, v97
    v_rcp_f32 v98, v98
    v_rcp_f32 v99, v99
    v_pk_mul_f32 v[100:101], v[100:101], v[96:97]
    v_pk_mul_f32 v[102:103], v[102:103], v[98:99]
    v_cvt_pk_bf16_f32 v116, v100, v101
    buffer_load_dwordx4 v23, s[24:27], s89 offen offset:3072 lds
    v_cvt_pk_bf16_f32 v117, v102, v103
    v_pk_mul_f32 v[96:97], v[172:173], v[172:173]
    v_pk_mul_f32 v[98:99], v[174:175], v[174:175]
    v_pk_fma_f32 v[96:97], v[96:97], v[34:35], v[34:35] op_sel:[0,1,0] op_sel_hi:[1,1,0]
    v_pk_fma_f32 v[98:99], v[98:99], v[34:35], v[34:35] op_sel:[0,1,0] op_sel_hi:[1,1,0]
    v_pk_mul_f32 v[96:97], v[96:97], v[172:173]
    v_pk_mul_f32 v[98:99], v[98:99], v[174:175]
    v_exp_f32 v96, v96
    v_exp_f32 v97, v97
    v_exp_f32 v98, v98
    v_exp_f32 v99, v99
    v_pk_mul_f32 v[100:101], v[172:173], v[188:189]
    s_waitcnt lgkmcnt(0)
    v_pk_mul_f32 v[102:103], v[174:175], v[190:191]
    v_pk_fma_f32 v[96:97], v[96:97], v[48:49], v[48:49] op_sel:[0,1,1] op_sel_hi:[1,1,1]
    v_pk_fma_f32 v[98:99], v[98:99], v[48:49], v[48:49] op_sel:[0,1,1] op_sel_hi:[1,1,1]
    v_rcp_f32 v96, v96
    v_rcp_f32 v97, v97
    v_rcp_f32 v98, v98
    v_rcp_f32 v99, v99
    v_pk_mul_f32 v[100:101], v[100:101], v[96:97]
    v_pk_mul_f32 v[102:103], v[102:103], v[98:99]
    v_cvt_pk_bf16_f32 v118, v100, v101
    v_cvt_pk_bf16_f32 v119, v102, v103
    buffer_store_dwordx4 v[116:119], v2, s[12:15], s88 offen offset:3072 sc1
    v_pk_mul_f32 v[96:97], v[192:193], v[192:193]
    s_add_u32 m0, s77, 0
    s_add_u32 s89, s87, 32768
    buffer_load_dwordx4 v20, s[24:27], s89 offen offset:0 lds
    v_pk_mul_f32 v[98:99], v[194:195], v[194:195]
    v_pk_fma_f32 v[96:97], v[96:97], v[40:41], v[40:41] op_sel:[0,1,0] op_sel_hi:[1,1,0]
    v_pk_fma_f32 v[98:99], v[98:99], v[40:41], v[40:41] op_sel:[0,1,0] op_sel_hi:[1,1,0]
    v_pk_mul_f32 v[96:97], v[96:97], v[192:193]
    v_pk_mul_f32 v[98:99], v[98:99], v[194:195]
    v_exp_f32 v96, v96
    v_exp_f32 v97, v97
    v_exp_f32 v98, v98
    v_exp_f32 v99, v99
    v_pk_mul_f32 v[100:101], v[192:193], v[208:209]
    v_pk_mul_f32 v[102:103], v[194:195], v[210:211]
    v_pk_fma_f32 v[96:97], v[96:97], v[50:51], v[50:51] op_sel:[0,0,0] op_sel_hi:[1,0,0]
    v_pk_fma_f32 v[98:99], v[98:99], v[50:51], v[50:51] op_sel:[0,0,0] op_sel_hi:[1,0,0]
    buffer_load_dwordx4 v21, s[24:27], s89 offen offset:1024 lds
    v_rcp_f32 v96, v96
    v_rcp_f32 v97, v97
    v_rcp_f32 v98, v98
    v_rcp_f32 v99, v99
    v_pk_mul_f32 v[100:101], v[100:101], v[96:97]
    v_pk_mul_f32 v[102:103], v[102:103], v[98:99]
    v_cvt_pk_bf16_f32 v104, v100, v101
    v_cvt_pk_bf16_f32 v105, v102, v103
    v_pk_mul_f32 v[96:97], v[196:197], v[196:197]
    v_pk_mul_f32 v[98:99], v[198:199], v[198:199]
    v_pk_fma_f32 v[96:97], v[96:97], v[40:41], v[40:41] op_sel:[0,1,0] op_sel_hi:[1,1,0]
    v_pk_fma_f32 v[98:99], v[98:99], v[40:41], v[40:41] op_sel:[0,1,0] op_sel_hi:[1,1,0]
    v_pk_mul_f32 v[96:97], v[96:97], v[196:197]
    s_waitcnt vmcnt(18)
    v_pk_mul_f32 v[98:99], v[98:99], v[198:199]
    v_exp_f32 v96, v96
    v_exp_f32 v97, v97
    v_exp_f32 v98, v98
    v_exp_f32 v99, v99
    v_pk_mul_f32 v[100:101], v[196:197], v[212:213]
    v_pk_mul_f32 v[102:103], v[198:199], v[214:215]
    v_pk_fma_f32 v[96:97], v[96:97], v[50:51], v[50:51] op_sel:[0,0,0] op_sel_hi:[1,0,0]
    v_pk_fma_f32 v[98:99], v[98:99], v[50:51], v[50:51] op_sel:[0,0,0] op_sel_hi:[1,0,0]
    v_rcp_f32 v96, v96
    v_rcp_f32 v97, v97
    v_rcp_f32 v98, v98
    v_rcp_f32 v99, v99
    buffer_load_dwordx4 v22, s[24:27], s89 offen offset:2048 lds
    v_pk_mul_f32 v[100:101], v[100:101], v[96:97]
    v_pk_mul_f32 v[102:103], v[102:103], v[98:99]
    v_cvt_pk_bf16_f32 v106, v100, v101
    v_cvt_pk_bf16_f32 v107, v102, v103
    buffer_store_dwordx4 v[104:107], v2, s[12:15], s92 offen offset:0 sc1
    v_pk_mul_f32 v[96:97], v[200:201], v[200:201]
    v_pk_mul_f32 v[98:99], v[202:203], v[202:203]
    v_pk_fma_f32 v[96:97], v[96:97], v[40:41], v[40:41] op_sel:[0,1,0] op_sel_hi:[1,1,0]
    v_pk_fma_f32 v[98:99], v[98:99], v[40:41], v[40:41] op_sel:[0,1,0] op_sel_hi:[1,1,0]
    v_pk_mul_f32 v[96:97], v[96:97], v[200:201]
    v_pk_mul_f32 v[98:99], v[98:99], v[202:203]
    v_exp_f32 v96, v96
    v_exp_f32 v97, v97
    ds_read_b128 a[20:23], v24 offset:0
    ds_read_b128 a[28:31], v25 offset:0
    v_exp_f32 v98, v98
    v_exp_f32 v99, v99
    v_pk_mul_f32 v[100:101], v[200:201], v[216:217]
    v_pk_mul_f32 v[102:103], v[202:203], v[218:219]
    v_pk_fma_f32 v[96:97], v[96:97], v[50:51], v[50:51] op_sel:[0,0,0] op_sel_hi:[1,0,0]
    v_pk_fma_f32 v[98:99], v[98:99], v[50:51], v[50:51] op_sel:[0,0,0] op_sel_hi:[1,0,0]
    v_rcp_f32 v96, v96
    v_rcp_f32 v97, v97
    v_rcp_f32 v98, v98
    v_rcp_f32 v99, v99
    v_pk_mul_f32 v[100:101], v[100:101], v[96:97]
    v_pk_mul_f32 v[102:103], v[102:103], v[98:99]
    buffer_load_dwordx4 v23, s[24:27], s89 offen offset:3072 lds
    v_cvt_pk_bf16_f32 v108, v100, v101
    v_cvt_pk_bf16_f32 v109, v102, v103
    v_pk_mul_f32 v[96:97], v[204:205], v[204:205]
    v_pk_mul_f32 v[98:99], v[206:207], v[206:207]
    v_pk_fma_f32 v[96:97], v[96:97], v[40:41], v[40:41] op_sel:[0,1,0] op_sel_hi:[1,1,0]
    v_pk_fma_f32 v[98:99], v[98:99], v[40:41], v[40:41] op_sel:[0,1,0] op_sel_hi:[1,1,0]
    v_pk_mul_f32 v[96:97], v[96:97], v[204:205]
    v_pk_mul_f32 v[98:99], v[98:99], v[206:207]
    v_exp_f32 v96, v96
    v_exp_f32 v97, v97
    v_exp_f32 v98, v98
    v_exp_f32 v99, v99
    v_pk_mul_f32 v[100:101], v[204:205], v[220:221]
    ds_read_b128 a[52:55], v26 offset:0
    ds_read_b128 a[60:63], v27 offset:0
    v_pk_mul_f32 v[102:103], v[206:207], v[222:223]
    v_pk_fma_f32 v[96:97], v[96:97], v[50:51], v[50:51] op_sel:[0,0,0] op_sel_hi:[1,0,0]
    v_pk_fma_f32 v[98:99], v[98:99], v[50:51], v[50:51] op_sel:[0,0,0] op_sel_hi:[1,0,0]
    v_rcp_f32 v96, v96
    v_rcp_f32 v97, v97
    v_rcp_f32 v98, v98
    v_rcp_f32 v99, v99
    v_pk_mul_f32 v[100:101], v[100:101], v[96:97]
    v_pk_mul_f32 v[102:103], v[102:103], v[98:99]
    v_cvt_pk_bf16_f32 v110, v100, v101
    v_cvt_pk_bf16_f32 v111, v102, v103
    buffer_store_dwordx4 v[108:111], v2, s[12:15], s92 offen offset:2048 sc1
    v_pk_mul_f32 v[96:97], v[224:225], v[224:225]
    s_add_u32 m0, s77, 4096
    s_add_u32 s89, s87, 65536
    buffer_load_dwordx4 v20, s[24:27], s89 offen offset:0 lds
    v_pk_mul_f32 v[98:99], v[226:227], v[226:227]
    v_pk_fma_f32 v[96:97], v[96:97], v[42:43], v[42:43] op_sel:[0,1,0] op_sel_hi:[1,1,0]
    v_pk_fma_f32 v[98:99], v[98:99], v[42:43], v[42:43] op_sel:[0,1,0] op_sel_hi:[1,1,0]
    v_pk_mul_f32 v[96:97], v[96:97], v[224:225]
    v_pk_mul_f32 v[98:99], v[98:99], v[226:227]
    v_exp_f32 v96, v96
    v_exp_f32 v97, v97
    v_exp_f32 v98, v98
    v_exp_f32 v99, v99
    v_pk_mul_f32 v[100:101], v[224:225], v[240:241]
    v_pk_mul_f32 v[102:103], v[226:227], v[242:243]
    v_pk_fma_f32 v[96:97], v[96:97], v[50:51], v[50:51] op_sel:[0,1,1] op_sel_hi:[1,1,1]
    v_pk_fma_f32 v[98:99], v[98:99], v[50:51], v[50:51] op_sel:[0,1,1] op_sel_hi:[1,1,1]
    buffer_load_dwordx4 v21, s[24:27], s89 offen offset:1024 lds
    v_rcp_f32 v96, v96
    v_rcp_f32 v97, v97
    v_rcp_f32 v98, v98
    v_rcp_f32 v99, v99
    v_pk_mul_f32 v[100:101], v[100:101], v[96:97]
    v_pk_mul_f32 v[102:103], v[102:103], v[98:99]
    v_cvt_pk_bf16_f32 v112, v100, v101
    v_cvt_pk_bf16_f32 v113, v102, v103
    v_pk_mul_f32 v[96:97], v[228:229], v[228:229]
    v_pk_mul_f32 v[98:99], v[230:231], v[230:231]
    v_pk_fma_f32 v[96:97], v[96:97], v[42:43], v[42:43] op_sel:[0,1,0] op_sel_hi:[1,1,0]
    v_pk_fma_f32 v[98:99], v[98:99], v[42:43], v[42:43] op_sel:[0,1,0] op_sel_hi:[1,1,0]
    v_pk_mul_f32 v[96:97], v[96:97], v[228:229]
    ds_read_b128 a[64:67], v24 offset:4096
    ds_read_b128 a[72:75], v25 offset:4096
    v_pk_mul_f32 v[98:99], v[98:99], v[230:231]
    v_exp_f32 v96, v96
    v_exp_f32 v97, v97
    v_exp_f32 v98, v98
    v_exp_f32 v99, v99
    v_pk_mul_f32 v[100:101], v[228:229], v[244:245]
    v_pk_mul_f32 v[102:103], v[230:231], v[246:247]
    v_pk_fma_f32 v[96:97], v[96:97], v[50:51], v[50:51] op_sel:[0,1,1] op_sel_hi:[1,1,1]
    v_pk_fma_f32 v[98:99], v[98:99], v[50:51], v[50:51] op_sel:[0,1,1] op_sel_hi:[1,1,1]
    v_rcp_f32 v96, v96
    v_rcp_f32 v97, v97
    v_rcp_f32 v98, v98
    v_rcp_f32 v99, v99
    buffer_load_dwordx4 v22, s[24:27], s89 offen offset:2048 lds
    v_pk_mul_f32 v[100:101], v[100:101], v[96:97]
    v_pk_mul_f32 v[102:103], v[102:103], v[98:99]
    v_cvt_pk_bf16_f32 v114, v100, v101
    v_cvt_pk_bf16_f32 v115, v102, v103
    buffer_store_dwordx4 v[112:115], v2, s[12:15], s92 offen offset:1024 sc1
    v_pk_mul_f32 v[96:97], v[232:233], v[232:233]
    v_pk_mul_f32 v[98:99], v[234:235], v[234:235]
    v_pk_fma_f32 v[96:97], v[96:97], v[42:43], v[42:43] op_sel:[0,1,0] op_sel_hi:[1,1,0]
    v_pk_fma_f32 v[98:99], v[98:99], v[42:43], v[42:43] op_sel:[0,1,0] op_sel_hi:[1,1,0]
    v_pk_mul_f32 v[96:97], v[96:97], v[232:233]
    v_pk_mul_f32 v[98:99], v[98:99], v[234:235]
    v_exp_f32 v96, v96
    v_exp_f32 v97, v97
    v_exp_f32 v98, v98
    v_exp_f32 v99, v99
    v_pk_mul_f32 v[100:101], v[232:233], v[248:249]
    v_pk_mul_f32 v[102:103], v[234:235], v[250:251]
    v_pk_fma_f32 v[96:97], v[96:97], v[50:51], v[50:51] op_sel:[0,1,1] op_sel_hi:[1,1,1]
    v_pk_fma_f32 v[98:99], v[98:99], v[50:51], v[50:51] op_sel:[0,1,1] op_sel_hi:[1,1,1]
    v_rcp_f32 v96, v96
    v_rcp_f32 v97, v97
    v_rcp_f32 v98, v98
    v_rcp_f32 v99, v99
    v_pk_mul_f32 v[100:101], v[100:101], v[96:97]
    v_pk_mul_f32 v[102:103], v[102:103], v[98:99]
    v_cvt_pk_bf16_f32 v116, v100, v101
    v_cvt_pk_bf16_f32 v117, v102, v103
    v_pk_mul_f32 v[96:97], v[236:237], v[236:237]
    v_pk_mul_f32 v[98:99], v[238:239], v[238:239]
    v_pk_fma_f32 v[96:97], v[96:97], v[42:43], v[42:43] op_sel:[0,1,0] op_sel_hi:[1,1,0]
    v_pk_fma_f32 v[98:99], v[98:99], v[42:43], v[42:43] op_sel:[0,1,0] op_sel_hi:[1,1,0]
    v_pk_mul_f32 v[96:97], v[96:97], v[236:237]
    v_pk_mul_f32 v[98:99], v[98:99], v[238:239]
    v_exp_f32 v96, v96
    v_exp_f32 v97, v97
    v_exp_f32 v98, v98
    v_exp_f32 v99, v99
    v_pk_mul_f32 v[100:101], v[236:237], v[252:253]
    v_pk_mul_f32 v[102:103], v[238:239], v[254:255]
    v_pk_fma_f32 v[96:97], v[96:97], v[50:51], v[50:51] op_sel:[0,1,1] op_sel_hi:[1,1,1]
    v_pk_fma_f32 v[98:99], v[98:99], v[50:51], v[50:51] op_sel:[0,1,1] op_sel_hi:[1,1,1]
    v_rcp_f32 v96, v96
    v_rcp_f32 v97, v97
    v_rcp_f32 v98, v98
    v_rcp_f32 v99, v99
    v_pk_mul_f32 v[100:101], v[100:101], v[96:97]
    v_pk_mul_f32 v[102:103], v[102:103], v[98:99]
    v_cvt_pk_bf16_f32 v118, v100, v101
    v_cvt_pk_bf16_f32 v119, v102, v103
    buffer_store_dwordx4 v[116:119], v2, s[12:15], s92 offen offset:3072 sc1
    s_lshl_b32 s79, s66, 1
    ds_read_b128 a[96:99], v26 offset:4096
    ds_read_b128 a[104:107], v27 offset:4096
    s_add_u32 s79, s79, s71
    s_lshl_b32 s80, s65, 1
    s_add_u32 s80, s80, s70
    s_lshl_b32 s80, s80, 6
    s_add_u32 s79, s79, s80
    s_lshl_b32 s79, s79, 7
    s_add_u32 s75, s79, 10747904
    v_mov_b32 v91, 0
    s_lshl_b32 s79, s71, 10
    buffer_load_dwordx4 v23, s[24:27], s89 offen offset:3072 lds
    v_lshl_add_u32 v84, v1, 4, s79
    v_xor_b32 v85, 1024, v84
    s_lshl_b32 s79, s67, 2
    s_add_u32 s79, s79, s68
    s_mul_i32 s76, s79, 176128
    s_mul_i32 s80, s64, 45056
    s_add_u32 s76, s76, s80
    s_lshl_b32 s73, s79, 17
    s_lshl_b32 s80, s64, 15
    s_add_u32 s73, s73, s80
    s_add_u32 m0, s77, 8192
    s_add_u32 s89, s87, 98304
    buffer_load_dwordx4 v20, s[24:27], s89 offen offset:0 lds
    s_add_u32 s73, s73, 6291456
    s_lshr_b32 s79, s79, 1
    s_lshl_b32 s79, s79, 13
    s_add_u32 s74, s79, 10747904
    s_mul_i32 s80, s64, 11
    v_min_u32 v89, 10, v1
    v_add_u32 v89, s80, v89
    v_min_u32 v89, 42, v89
    v_lshlrev_b32 v89, 7, v89
    s_lshl_b32 s80, s64, 2
    ds_read_b128 a[68:71], v24 offset:8192
    ds_read_b128 a[76:79], v25 offset:8192
    s_add_u32 s80, s80, 48
    v_min_u32 v90, 3, v1
    v_add_u32 v90, s80, v90
    v_lshlrev_b32 v90, 7, v90
    s_lshl_b32 s79, s67, 8
    s_lshr_b32 s80, s68, 1
    s_lshl_b32 s80, s80, 7
    s_add_u32 s79, s79, s80
    s_and_b32 s80, s68, 1
    s_lshl_b32 s80, s80, 5
    buffer_load_dwordx4 v21, s[24:27], s89 offen offset:1024 lds
    s_add_u32 s79, s79, s80
    s_lshl_b32 s80, s71, 4
    s_add_u32 s79, s79, s80
    v_bfe_u32 v2, v1, 4, 1
    v_and_b32 v3, 15, v1
    v_lshl_add_u32 v2, v2, 6, v3
    v_add_u32 v2, s79, v2
    v_lshrrev_b32 v88, 3, v1
    v_add_u32 v88, s79, v88
    s_lshl_b32 s79, s69, 7
    ds_read_b128 a[100:103], v26 offset:8192
    ds_read_b128 a[108:111], v27 offset:8192
    s_lshl_b32 s80, s70, 6
    s_add_u32 s79, s79, s80
    v_and_b32 v3, 32, v1
    v_add_u32 v94, s79, v3
    v_lshl_add_u32 v93, v2, 10, v94
    v_lshlrev_b32 v95, 4, v2
    v_add_u32 v95, 10485760, v95
    s_lshl_b32 s79, s79, 1
    v_and_b32 v3, 7, v1
    v_lshl_add_u32 v3, v3, 4, s79
    buffer_load_dwordx4 v22, s[24:27], s89 offen offset:2048 lds
    v_lshl_add_u32 v88, v88, 11, v3
    s_and_b32 s79, s70, s71
    s_mul_i32 s79, s79, 2130706432
    v_add_u32 v86, s79, v84
    v_add_u32 v87, s79, v85
    s_mov_b32 s28, s48
    s_mov_b32 s29, s49
    s_mov_b32 s30, 1024
    s_mov_b32 s31, 0x00020000
    buffer_load_dwordx4 a[128:131], v93, s[4:7], 0 offen offset:0
    buffer_load_dwordx4 a[136:139], v94, s[28:31], 0 offen offset:0
    buffer_load_dwordx4 a[132:135], v93, s[4:7], 0 offen offset:16
    buffer_load_dwordx4 a[140:143], v94, s[28:31], 0 offen offset:16
    buffer_load_dwordx4 a[144:147], v95, s[12:15], 0 offen sc1
    s_waitcnt vmcnt(9)
    v_mov_b32 v2, 1
    s_mov_b64 exec, 1
    buffer_store_dword v2, v91, s[12:15], s75 offen sc1
    s_mov_b64 exec, -1
    buffer_load_dwordx4 v23, s[24:27], s89 offen offset:3072 lds
    s_waitcnt lgkmcnt(0)
    s_add_u32 m0, s78, 0
    s_add_u32 s89, s87, 131072
    buffer_load_dwordx4 v20, s[24:27], s89 offen offset:0 lds
    buffer_load_dwordx4 v21, s[24:27], s89 offen offset:1024 lds
    ds_read_b128 a[80:83], v24 offset:49152
    ds_read_b128 a[88:91], v25 offset:49152
    buffer_load_dwordx4 v22, s[24:27], s89 offen offset:2048 lds
    ds_read_b128 a[112:115], v26 offset:49152
    ds_read_b128 a[120:123], v27 offset:49152
    buffer_load_dwordx4 v23, s[24:27], s89 offen offset:3072 lds
    ds_read_b128 a[84:87], v24 offset:53248
    ds_read_b128 a[92:95], v25 offset:53248
    s_add_u32 m0, s78, 4096
    s_add_u32 s89, s87, 163840
    buffer_load_dwordx4 v20, s[24:27], s89 offen offset:0 lds
    ds_read_b128 a[116:119], v26 offset:53248
    ds_read_b128 a[124:127], v27 offset:53248
    buffer_load_dwordx4 v21, s[24:27], s89 offen offset:1024 lds
    buffer_load_dwordx4 v22, s[24:27], s89 offen offset:2048 lds
    ds_read_b64_tr_b16 a[192:193], v28 offset:57344
    ds_read_b64_tr_b16 a[194:195], v28 offset:58368
    buffer_load_dwordx4 v23, s[24:27], s89 offen offset:3072 lds
    ds_read_b64_tr_b16 a[196:197], v29 offset:57344
    ds_read_b64_tr_b16 a[198:199], v29 offset:58368
    s_add_u32 m0, s78, 8192
    s_add_u32 s89, s87, 196608
    buffer_load_dwordx4 v20, s[24:27], s89 offen offset:0 lds
    ds_read_b64_tr_b16 a[200:201], v28 offset:59392
    ds_read_b64_tr_b16 a[202:203], v28 offset:60416
    buffer_load_dwordx4 v21, s[24:27], s89 offen offset:1024 lds
    ds_read_b64_tr_b16 a[204:205], v29 offset:59392
    ds_read_b64_tr_b16 a[206:207], v29 offset:60416
    buffer_load_dwordx4 v22, s[24:27], s89 offen offset:2048 lds
    buffer_load_dwordx4 v23, s[24:27], s89 offen offset:3072 lds
    s_waitcnt lgkmcnt(0)
    s_add_u32 m0, s78, 49152
    s_add_u32 s89, s87, 229376
    buffer_load_dwordx4 v20, s[24:27], s89 offen offset:0 lds
    s_waitcnt vmcnt(13)
    ds_read_b64_tr_b16 a[208:209], v30 offset:0
    ds_read_b64_tr_b16 a[210:211], v30 offset:1024
    buffer_load_dwordx4 v21, s[24:27], s89 offen offset:1024 lds
    ds_read_b64_tr_b16 a[212:213], v31 offset:0
    ds_read_b64_tr_b16 a[214:215], v31 offset:1024
    buffer_load_dwordx4 v22, s[24:27], s89 offen offset:2048 lds
    ds_read_b64_tr_b16 a[216:217], v30 offset:2048
    ds_read_b64_tr_b16 a[218:219], v30 offset:3072
    buffer_load_dwordx4 v23, s[24:27], s89 offen offset:3072 lds
    ds_read_b64_tr_b16 a[220:221], v31 offset:2048
    ds_read_b64_tr_b16 a[222:223], v31 offset:3072
    s_add_u32 m0, s78, 53248
    s_add_u32 s89, s87, 262144
    buffer_load_dwordx4 v20, s[24:27], s89 offen offset:0 lds
    ds_read_b64_tr_b16 a[224:225], v30 offset:4096
    ds_read_b64_tr_b16 a[226:227], v30 offset:5120
    buffer_load_dwordx4 v21, s[24:27], s89 offen offset:1024 lds
    buffer_load_dword v92, v89, s[12:15], s74 offen sc1
    ds_read_b64_tr_b16 a[228:229], v31 offset:4096
    ds_read_b64_tr_b16 a[230:231], v31 offset:5120
    ds_read_b64_tr_b16 a[232:233], v30 offset:6144
    ds_read_b64_tr_b16 a[234:235], v30 offset:7168
    buffer_load_dwordx4 v22, s[24:27], s89 offen offset:2048 lds
    ds_read_b64_tr_b16 a[236:237], v31 offset:6144
    ds_read_b64_tr_b16 a[238:239], v31 offset:7168
    buffer_load_dwordx4 v23, s[24:27], s89 offen offset:3072 lds
    ds_read_b64_tr_b16 a[240:241], v30 offset:8192
    ds_read_b64_tr_b16 a[242:243], v30 offset:9216
    s_add_u32 m0, s78, 57344
    s_add_u32 s89, s87, 294912
    buffer_load_dwordx4 v20, s[24:27], s89 offen offset:0 lds
    ds_read_b64_tr_b16 a[244:245], v31 offset:8192
    ds_read_b64_tr_b16 a[246:247], v31 offset:9216
    buffer_load_dwordx4 v21, s[24:27], s89 offen offset:1024 lds
    ds_read_b64_tr_b16 a[248:249], v30 offset:10240
    ds_read_b64_tr_b16 a[250:251], v30 offset:11264
    buffer_load_dwordx4 v22, s[24:27], s89 offen offset:2048 lds
    ds_read_b64_tr_b16 a[252:253], v31 offset:10240
    ds_read_b64_tr_b16 a[254:255], v31 offset:11264
    buffer_load_dwordx4 v23, s[24:27], s89 offen offset:3072 lds
    s_waitcnt lgkmcnt(0)
    s_add_u32 m0, s77, 0
    s_add_u32 s89, s87, 327680
    buffer_load_dwordx4 v20, s[24:27], s89 offen offset:0 lds
    buffer_load_dwordx4 v21, s[24:27], s89 offen offset:1024 lds
    buffer_load_dwordx4 v22, s[24:27], s89 offen offset:2048 lds
    buffer_load_dwordx4 v23, s[24:27], s89 offen offset:3072 lds
    s_waitcnt vmcnt(10)
    s_mov_b32 s83, 200000
    s_branch Lpchk_6
Lpoll_4:
    buffer_load_dword v92, v89, s[12:15], s74 offen sc1
    s_waitcnt vmcnt(0)
Lpchk_6:
    v_cmp_ne_u32 vcc, 0, v92
    s_nop 1
    s_cmp_eq_u64 vcc, -1
    s_cbranch_scc1 Lpdone_5
    s_sub_u32 s83, s83, 1
    s_cbranch_scc1 Lpdone_5
    s_sleep 1
    s_branch Lpoll_4
Lpdone_5:
    s_branch L_phase2
L_ssm:
    s_lshl_b32 s80, s80, 1
    s_add_u32 s66, s80, s79
    s_mov_b32 s10, 524288
    s_mov_b32 s74, 1
    s_lshl_b32 s81, s70, 5
    s_lshl_b32 s82, s66, 6
    s_add_u32 s81, s81, s82
    v_add_u32 v11, s81, v6
    v_lshlrev_b32 v11, 10, v11
    v_add_u32 v12, v11, v9
    v_add_u32 v13, v11, v10
    v_add_u32 v32, 0, v12
    v_add_u32 v33, 7168, v13
    v_add_u32 v34, 14336, v12
    v_add_u32 v35, 21504, v13
    v_and_b32 v62, 19, v1
    v_bfe_u32 v2, v1, 2, 1
    v_lshl_or_b32 v62, v2, 3, v62
    v_bfe_u32 v2, v1, 3, 1
    v_lshl_or_b32 v62, v2, 2, v62
    s_lshl_b32 s81, s71, 5
    v_add_u32 v62, s81, v62
    v_add_u32 v2, s82, v62
    v_lshlrev_b32 v2, 1, v2
    s_mov_b32 s30, 1024
    s_mov_b32 s31, 0x00020000
    s_cmp_lt_u32 s64, 2
    s_waitcnt lgkmcnt(0)
    s_cselect_b32 s8, s38, s40
    s_cselect_b32 s9, s39, s41
    s_mov_b32 s4, s32
    s_mov_b32 s5, s33
    s_mov_b32 s28, s34
    s_mov_b32 s29, s35
    buffer_load_ushort v56, v2, s[28:31], 0 offen
    s_mov_b32 s28, s36
    s_mov_b32 s29, s37
    buffer_load_ushort v57, v2, s[28:31], 0 offen
    s_mov_b32 s28, s46
    s_mov_b32 s29, s47
    buffer_load_ushort v58, v2, s[28:31], 0 offen
    s_add_u32 m0, s76, 0
    s_mul_i32 s73, s72, s74
    buffer_load_dwordx4 v32, s[8:11], s73 offen offset:0 lds
    buffer_load_dwordx4 v33, s[8:11], s73 offen offset:1024 lds
    buffer_load_dwordx4 v34, s[8:11], s73 offen offset:2048 lds
    buffer_load_dwordx4 v35, s[8:11], s73 offen offset:3072 lds
    s_add_u32 m0, s75, 0
    s_nop 0
    buffer_load_dwordx4 v24, s[4:7], s72 offen offset:0 lds
    buffer_load_dwordx4 v25, s[4:7], s72 offen offset:1024 lds
    buffer_load_dwordx4 v26, s[4:7], s72 offen offset:2048 lds
    buffer_load_dwordx4 v27, s[4:7], s72 offen offset:3072 lds
    s_add_u32 m0, s75, 4096
    s_nop 0
    buffer_load_dwordx4 v28, s[4:7], s72 offen offset:0 lds
    buffer_load_dwordx4 v29, s[4:7], s72 offen offset:1024 lds
    buffer_load_dwordx4 v30, s[4:7], s72 offen offset:2048 lds
    buffer_load_dwordx4 v31, s[4:7], s72 offen offset:3072 lds
    s_add_u32 s72, s72, 128
    s_and_b32 s72, s72, 0x3ff
    s_mov_b32 s84, 0xffff0000
    s_mov_b32 s12, s62
    s_mov_b32 s13, s63
    s_mov_b32 s14, 11534336
    s_mov_b32 s15, 0x00020000
    s_mov_b32 s16, s42
    s_mov_b32 s17, s43
    s_mov_b32 s18, 524288
    s_mov_b32 s19, 0x00020000
    s_mov_b32 s20, s44
    s_mov_b32 s21, s45
    s_mov_b32 s22, 524288
    s_mov_b32 s23, 0x00020000
    s_mov_b32 s24, s56
    s_mov_b32 s25, s57
    s_mov_b32 s26, 1409024
    s_mov_b32 s27, 0x00020000
    s_bfe_u32 s68, s2, 0x20003
    s_lshr_b32 s69, s2, 6
    s_and_b32 s82, s2, 1
    s_lshl_b32 s82, s82, 2
    s_add_u32 s69, s69, s82
    s_and_b32 s67, s2, 6
    s_bfe_u32 s81, s2, 0x10005
    s_add_u32 s67, s67, s81
    s_mul_i32 s78, s64, 12288
    s_add_u32 s77, s78, 98304
    s_lshl_b32 s85, s64, 8
    s_lshl_b32 s81, s70, 15
    s_add_u32 s86, s85, 32768
    s_sub_u32 s86, s86, s81
    s_add_u32 s85, s85, s81
    s_mul_i32 s87, s64, 360448
    s_lshl_b32 s81, s69, 6
    v_add_u32 v11, s81, v6
    v_lshlrev_b32 v11, 10, v11
    v_add_u32 v12, v11, v9
    v_add_u32 v13, v11, v10
    v_add_u32 v16, 0, v12
    v_add_u32 v17, 7168, v13
    v_add_u32 v18, 14336, v12
    v_add_u32 v19, 21504, v13
    s_lshl_b32 s81, s69, 7
    v_lshl_add_u32 v11, v6, 10, v14
    v_add_u32 v11, s81, v11
    v_add_u32 v20, 0, v11
    v_add_u32 v21, 7168, v11
    v_add_u32 v22, 14336, v11
    v_add_u32 v23, 21504, v11
    s_bfe_u32 s81, s2, 0x30003
    s_lshl_b32 s81, s81, 2
    s_add_u32 s81, s81, s64
    s_mul_i32 s81, s81, ((L_end-Lpc0)/128+32)/32
    v_min_u32 v11, ((L_end-Lpc0)/128+32)/32-1, v1
    v_add_u32 v11, s81, v11
    v_lshlrev_b32 v11, 7, v11
    v_min_u32 v11, L_end-Lpc0, v11
    s_mov_b64 exec, 0xffff
    global_load_dword v0, v11, s[94:95]
    s_mov_b64 exec, -1
    v_bfe_u32 v2, v1, 2, 1
    v_and_b32 v3, 3, v1
    v_lshl_add_u32 v2, v2, 6, v3
    v_bfe_u32 v3, v1, 3, 2
    v_lshl_add_u32 v2, v3, 2, v2
    v_lshrrev_b32 v3, 5, v1
    v_bfe_u32 v4, v2, 1, 3
    v_xor_b32 v4, v4, v3
    s_lshl_b32 s81, s70, 14
    v_lshlrev_b32 v2, 7, v2
    v_add_u32 v2, s81, v2
    s_lshl_b32 s81, s70, 1
    v_xor_b32 v4, s81, v4
    v_xor_b32 v5, 0, v4
    v_lshl_add_u32 v36, v5, 4, v2
    v_add_u32 v40, 98304, v36
    v_xor_b32 v5, 2, v4
    v_lshl_add_u32 v37, v5, 4, v2
    v_add_u32 v41, 98304, v37
    v_xor_b32 v5, 4, v4
    v_lshl_add_u32 v38, v5, 4, v2
    v_add_u32 v42, 98304, v38
    v_xor_b32 v5, 6, v4
    v_lshl_add_u32 v39, v5, 4, v2
    v_add_u32 v43, 98304, v39
    v_lshrrev_b32 v3, 5, v1
    v_bfe_u32 v4, v62, 1, 3
    v_xor_b32 v4, v4, v3
    s_lshl_b32 s81, s70, 1
    v_xor_b32 v4, s81, v4
    v_lshlrev_b32 v2, 7, v62
    v_add_u32 v2, 32768, v2
    v_xor_b32 v5, 0, v4
    v_lshl_add_u32 v44, v5, 4, v2
    v_add_u32 v48, 98304, v44
    v_xor_b32 v5, 2, v4
    v_lshl_add_u32 v45, v5, 4, v2
    v_add_u32 v49, 98304, v45
    v_xor_b32 v5, 4, v4
    v_lshl_add_u32 v46, v5, 4, v2
    v_add_u32 v50, 98304, v46
    v_xor_b32 v5, 6, v4
    v_lshl_add_u32 v47, v5, 4, v2
    v_add_u32 v51, 98304, v47
    s_waitcnt vmcnt(13)
    v_lshlrev_b32 v56, 16, v56
    v_lshlrev_b32 v57, 16, v57
    v_lshlrev_b32 v58, 16, v58
    v_mul_f32 v58, 0x3fb8aa3b, v58
    v_exp_f32 v58, v58
    s_nop 0
    v_cvt_pk_bf16_f32 v58, v58, v58
    v_and_b32 v58, s84, v58
    v_mul_f32 v59, v58, v56
    v_mul_f32 v60, v58, v57
    v_mul_f32 v59, 0x3fb8aa3b, v59
    v_mul_f32 v60, 0x3e22f983, v60
    v_exp_f32 v59, v59
    v_rndne_f32 v61, v60
    v_sub_f32 v60, v60, v61
    v_cos_f32 v61, v60
    v_sin_f32 v60, v60
    v_mul_f32 v8, v59, v61
    v_mul_f32 v58, v56, v56
    v_mul_f32 v9, v59, v60
    v_fmac_f32 v58, v57, v57
    v_add_f32 v59, -1.0, v8
    v_rcp_f32 v58, v58
    v_mul_f32 v60, v59, v56
    v_mul_f32 v61, v9, v56
    v_fmac_f32 v60, v9, v57
    v_fma_f32 v61, -v59, v57, v61
    v_add_f32 v58, v58, v58
    v_mul_f32 v10, v60, v58
    v_mul_f32 v11, v61, v58
    v_pk_mul_f32 v[2:3], v[8:9], v[8:9] op_sel:[1,1] op_sel_hi:[0,1] neg_lo:[0,1]
    v_pk_fma_f32 v[4:5], v[8:9], v[8:9], v[2:3] op_sel:[0,0,0] op_sel_hi:[1,0,1]
    v_pk_mul_f32 v[2:3], v[4:5], v[4:5] op_sel:[1,1] op_sel_hi:[0,1] neg_lo:[0,1]
    v_pk_fma_f32 v[12:13], v[4:5], v[4:5], v[2:3] op_sel:[0,0,0] op_sel_hi:[1,0,1]
    v_pk_mul_f32 v[2:3], v[12:13], v[12:13] op_sel:[1,1] op_sel_hi:[0,1] neg_lo:[0,1]
    v_pk_fma_f32 v[4:5], v[12:13], v[12:13], v[2:3] op_sel:[0,0,0] op_sel_hi:[1,0,1]
    v_pk_mul_f32 v[2:3], v[4:5], v[4:5] op_sel:[1,1] op_sel_hi:[0,1] neg_lo:[0,1]
    v_pk_fma_f32 v[12:13], v[4:5], v[4:5], v[2:3] op_sel:[0,0,0] op_sel_hi:[1,0,1]
    v_pk_mul_f32 v[2:3], v[12:13], v[12:13] op_sel:[1,1] op_sel_hi:[0,1] neg_lo:[0,1]
    v_pk_fma_f32 v[4:5], v[12:13], v[12:13], v[2:3] op_sel:[0,0,0] op_sel_hi:[1,0,1]
    v_pk_mul_f32 v[2:3], v[4:5], v[4:5] op_sel:[1,1] op_sel_hi:[0,1] neg_lo:[0,1]
    v_pk_fma_f32 v[12:13], v[4:5], v[4:5], v[2:3] op_sel:[0,0,0] op_sel_hi:[1,0,1]
    v_pk_mul_f32 v[2:3], v[12:13], v[12:13] op_sel:[1,1] op_sel_hi:[0,1] neg_lo:[0,1]
    v_pk_fma_f32 v[4:5], v[12:13], v[12:13], v[2:3] op_sel:[0,0,0] op_sel_hi:[1,0,1]
    v_pk_mul_f32 v[2:3], v[4:5], v[4:5] op_sel:[1,1] op_sel_hi:[0,1] neg_lo:[0,1]
    v_pk_fma_f32 v[6:7], v[4:5], v[4:5], v[2:3] op_sel:[0,0,0] op_sel_hi:[1,0,1]
    v_mov_b32 v52, 0
    v_mov_b32 v53, 0
    s_add_u32 m0, s76, 49152
    s_mul_i32 s73, s72, s74
    buffer_load_dwordx4 v32, s[8:11], s73 offen offset:0 lds
    buffer_load_dwordx4 v33, s[8:11], s73 offen offset:1024 lds
    buffer_load_dwordx4 v34, s[8:11], s73 offen offset:2048 lds
    buffer_load_dwordx4 v35, s[8:11], s73 offen offset:3072 lds
    s_add_u32 m0, s75, 49152
    s_nop 0
    buffer_load_dwordx4 v24, s[4:7], s72 offen offset:0 lds
    buffer_load_dwordx4 v25, s[4:7], s72 offen offset:1024 lds
    s_waitcnt vmcnt(7)
    s_barrier
    ds_read_b128 v[96:99], v44 offset:0
    ds_read_b128 v[80:83], v36 offset:0
    ds_read_b128 v[100:103], v44 offset:8192
    ds_read_b128 v[84:87], v36 offset:2048
    ds_read_b128 v[88:91], v36 offset:4096
    ds_read_b128 v[92:95], v36 offset:6144
    s_waitcnt lgkmcnt(0)
    v_mfma_f32_32x32x16_bf16 v[128:143], v[80:83], v[96:99], 0
    ds_read_b128 v[120:123], v45 offset:0
    ds_read_b128 v[104:107], v37 offset:0
    v_lshlrev_b32 v54, 16, v96
    v_and_b32 v55, s84, v96
    v_mfma_f32_32x32x16_bf16 v[144:159], v[80:83], v[100:103], 0
    ds_read_b128 v[124:127], v45 offset:8192
    ds_read_b128 v[108:111], v37 offset:2048
    v_add_f32 v52, v52, v54
    v_add_f32 v52, v52, v55
    v_mfma_f32_32x32x16_bf16 v[160:175], v[84:87], v[96:99], 0
    ds_read_b128 v[112:115], v37 offset:4096
    ds_read_b128 v[116:119], v37 offset:6144
    v_lshlrev_b32 v54, 16, v97
    v_and_b32 v55, s84, v97
    v_mfma_f32_32x32x16_bf16 v[176:191], v[84:87], v[100:103], 0
    v_add_f32 v52, v52, v54
    v_add_f32 v52, v52, v55
    v_mfma_f32_32x32x16_bf16 v[192:207], v[88:91], v[96:99], 0
    v_lshlrev_b32 v54, 16, v98
    v_and_b32 v55, s84, v98
    buffer_load_dwordx4 v26, s[4:7], s72 offen offset:2048 lds
    v_mfma_f32_32x32x16_bf16 v[208:223], v[88:91], v[100:103], 0
    v_add_f32 v52, v52, v54
    v_add_f32 v52, v52, v55
    buffer_load_dwordx4 v27, s[4:7], s72 offen offset:3072 lds
    s_add_u32 m0, s75, 53248
    v_mfma_f32_32x32x16_bf16 v[224:239], v[92:95], v[96:99], 0
    v_lshlrev_b32 v54, 16, v99
    v_and_b32 v55, s84, v99
    buffer_load_dwordx4 v28, s[4:7], s72 offen offset:0 lds
    v_mfma_f32_32x32x16_bf16 v[240:255], v[92:95], v[100:103], 0
    v_add_f32 v52, v52, v54
    v_add_f32 v52, v52, v55
    buffer_load_dwordx4 v29, s[4:7], s72 offen offset:1024 lds
    s_waitcnt lgkmcnt(0)
    v_mfma_f32_32x32x16_bf16 v[128:143], v[104:107], v[120:123], v[128:143]
    ds_read_b128 v[72:75], v46 offset:0
    ds_read_b128 v[80:83], v38 offset:0
    v_lshlrev_b32 v54, 16, v100
    v_and_b32 v55, s84, v100
    v_mfma_f32_32x32x16_bf16 v[144:159], v[104:107], v[124:127], v[144:159]
    ds_read_b128 v[76:79], v46 offset:8192
    ds_read_b128 v[84:87], v38 offset:2048
    v_add_f32 v53, v53, v54
    v_add_f32 v53, v53, v55
    v_mfma_f32_32x32x16_bf16 v[160:175], v[108:111], v[120:123], v[160:175]
    ds_read_b128 v[88:91], v38 offset:4096
    ds_read_b128 v[92:95], v38 offset:6144
    v_lshlrev_b32 v54, 16, v101
    v_and_b32 v55, s84, v101
    v_mfma_f32_32x32x16_bf16 v[176:191], v[108:111], v[124:127], v[176:191]
    v_add_f32 v53, v53, v54
    v_add_f32 v53, v53, v55
    v_mfma_f32_32x32x16_bf16 v[192:207], v[112:115], v[120:123], v[192:207]
    v_lshlrev_b32 v54, 16, v102
    v_and_b32 v55, s84, v102
    buffer_load_dwordx4 v30, s[4:7], s72 offen offset:2048 lds
    v_mfma_f32_32x32x16_bf16 v[208:223], v[112:115], v[124:127], v[208:223]
    v_add_f32 v53, v53, v54
    v_add_f32 v53, v53, v55
    buffer_load_dwordx4 v31, s[4:7], s72 offen offset:3072 lds
    s_add_u32 s72, s72, 128
    s_and_b32 s72, s72, 0x3ff
    s_add_u32 m0, s76, 98304
    v_mfma_f32_32x32x16_bf16 v[224:239], v[116:119], v[120:123], v[224:239]
    v_lshlrev_b32 v54, 16, v103
    v_and_b32 v55, s84, v103
    s_mul_i32 s73, s72, s74
    buffer_load_dwordx4 v32, s[8:11], s73 offen offset:0 lds
    v_mfma_f32_32x32x16_bf16 v[240:255], v[116:119], v[124:127], v[240:255]
    v_add_f32 v53, v53, v54
    v_add_f32 v53, v53, v55
    buffer_load_dwordx4 v33, s[8:11], s73 offen offset:1024 lds
    s_waitcnt lgkmcnt(0)
    v_mfma_f32_32x32x16_bf16 v[128:143], v[80:83], v[72:75], v[128:143]
    ds_read_b128 v[96:99], v47 offset:0
    ds_read_b128 v[104:107], v39 offset:0
    v_lshlrev_b32 v54, 16, v72
    v_and_b32 v55, s84, v72
    v_mfma_f32_32x32x16_bf16 v[144:159], v[80:83], v[76:79], v[144:159]
    ds_read_b128 v[100:103], v47 offset:8192
    ds_read_b128 v[108:111], v39 offset:2048
    v_add_f32 v52, v52, v54
    v_add_f32 v52, v52, v55
    v_mfma_f32_32x32x16_bf16 v[160:175], v[84:87], v[72:75], v[160:175]
    ds_read_b128 v[112:115], v39 offset:4096
    ds_read_b128 v[116:119], v39 offset:6144
    v_lshlrev_b32 v54, 16, v73
    v_and_b32 v55, s84, v73
    v_mfma_f32_32x32x16_bf16 v[176:191], v[84:87], v[76:79], v[176:191]
    v_add_f32 v52, v52, v54
    v_add_f32 v52, v52, v55
    v_mfma_f32_32x32x16_bf16 v[192:207], v[88:91], v[72:75], v[192:207]
    v_lshlrev_b32 v54, 16, v74
    v_and_b32 v55, s84, v74
    buffer_load_dwordx4 v34, s[8:11], s73 offen offset:2048 lds
    v_mfma_f32_32x32x16_bf16 v[208:223], v[88:91], v[76:79], v[208:223]
    v_add_f32 v52, v52, v54
    v_add_f32 v52, v52, v55
    buffer_load_dwordx4 v35, s[8:11], s73 offen offset:3072 lds
    s_add_u32 m0, s75, 98304
    v_mfma_f32_32x32x16_bf16 v[224:239], v[92:95], v[72:75], v[224:239]
    v_lshlrev_b32 v54, 16, v75
    v_and_b32 v55, s84, v75
    buffer_load_dwordx4 v24, s[4:7], s72 offen offset:0 lds
    v_mfma_f32_32x32x16_bf16 v[240:255], v[92:95], v[76:79], v[240:255]
    v_add_f32 v52, v52, v54
    v_add_f32 v52, v52, v55
    buffer_load_dwordx4 v25, s[4:7], s72 offen offset:1024 lds
    s_waitcnt lgkmcnt(0)
    v_mfma_f32_32x32x16_bf16 v[128:143], v[104:107], v[96:99], v[128:143]
    s_waitcnt vmcnt(6)
    s_barrier
    ds_read_b128 v[120:123], v44 offset:49152
    ds_read_b128 v[80:83], v36 offset:49152
    v_lshlrev_b32 v54, 16, v76
    v_and_b32 v55, s84, v76
    v_mfma_f32_32x32x16_bf16 v[144:159], v[104:107], v[100:103], v[144:159]
    ds_read_b128 v[124:127], v44 offset:57344
    ds_read_b128 v[84:87], v36 offset:51200
    v_add_f32 v53, v53, v54
    v_add_f32 v53, v53, v55
    v_mfma_f32_32x32x16_bf16 v[160:175], v[108:111], v[96:99], v[160:175]
    ds_read_b128 v[88:91], v36 offset:53248
    ds_read_b128 v[92:95], v36 offset:55296
    v_lshlrev_b32 v54, 16, v77
    v_and_b32 v55, s84, v77
    v_mfma_f32_32x32x16_bf16 v[176:191], v[108:111], v[100:103], v[176:191]
    v_add_f32 v53, v53, v54
    v_add_f32 v53, v53, v55
    v_mfma_f32_32x32x16_bf16 v[192:207], v[112:115], v[96:99], v[192:207]
    v_lshlrev_b32 v54, 16, v78
    v_and_b32 v55, s84, v78
    buffer_load_dwordx4 v26, s[4:7], s72 offen offset:2048 lds
    v_mfma_f32_32x32x16_bf16 v[208:223], v[112:115], v[100:103], v[208:223]
    v_add_f32 v53, v53, v54
    v_add_f32 v53, v53, v55
    buffer_load_dwordx4 v27, s[4:7], s72 offen offset:3072 lds
    s_add_u32 m0, s75, 102400
    v_mfma_f32_32x32x16_bf16 v[224:239], v[116:119], v[96:99], v[224:239]
    v_lshlrev_b32 v54, 16, v79
    v_and_b32 v55, s84, v79
    buffer_load_dwordx4 v28, s[4:7], s72 offen offset:0 lds
    v_mfma_f32_32x32x16_bf16 v[240:255], v[116:119], v[100:103], v[240:255]
    v_add_f32 v53, v53, v54
    v_add_f32 v53, v53, v55
    buffer_load_dwordx4 v29, s[4:7], s72 offen offset:1024 lds
    s_waitcnt lgkmcnt(0)
    v_mfma_f32_32x32x16_bf16 v[128:143], v[80:83], v[120:123], v[128:143]
    ds_read_b128 v[72:75], v45 offset:49152
    ds_read_b128 v[104:107], v37 offset:49152
    v_lshlrev_b32 v54, 16, v120
    v_and_b32 v55, s84, v120
    v_mfma_f32_32x32x16_bf16 v[144:159], v[80:83], v[124:127], v[144:159]
    ds_read_b128 v[76:79], v45 offset:57344
    ds_read_b128 v[108:111], v37 offset:51200
    v_add_f32 v52, v52, v54
    v_add_f32 v52, v52, v55
    v_mfma_f32_32x32x16_bf16 v[160:175], v[84:87], v[120:123], v[160:175]
    ds_read_b128 v[112:115], v37 offset:53248
    ds_read_b128 v[116:119], v37 offset:55296
    v_lshlrev_b32 v54, 16, v121
    v_and_b32 v55, s84, v121
    v_mfma_f32_32x32x16_bf16 v[176:191], v[84:87], v[124:127], v[176:191]
    v_add_f32 v52, v52, v54
    v_add_f32 v52, v52, v55
    v_mfma_f32_32x32x16_bf16 v[192:207], v[88:91], v[120:123], v[192:207]
    v_lshlrev_b32 v54, 16, v122
    v_and_b32 v55, s84, v122
    buffer_load_dwordx4 v30, s[4:7], s72 offen offset:2048 lds
    v_mfma_f32_32x32x16_bf16 v[208:223], v[88:91], v[124:127], v[208:223]
    v_add_f32 v52, v52, v54
    v_add_f32 v52, v52, v55
    buffer_load_dwordx4 v31, s[4:7], s72 offen offset:3072 lds
    s_add_u32 s72, s72, 128
    s_and_b32 s72, s72, 0x3ff
    s_add_u32 m0, s76, 0
    v_mfma_f32_32x32x16_bf16 v[224:239], v[92:95], v[120:123], v[224:239]
    v_lshlrev_b32 v54, 16, v123
    v_and_b32 v55, s84, v123
    s_mul_i32 s73, s72, s74
    buffer_load_dwordx4 v32, s[8:11], s73 offen offset:0 lds
    v_mfma_f32_32x32x16_bf16 v[240:255], v[92:95], v[124:127], v[240:255]
    v_add_f32 v52, v52, v54
    v_add_f32 v52, v52, v55
    buffer_load_dwordx4 v33, s[8:11], s73 offen offset:1024 lds
    s_waitcnt lgkmcnt(0)
    v_mfma_f32_32x32x16_bf16 v[128:143], v[104:107], v[72:75], v[128:143]
    ds_read_b128 v[96:99], v46 offset:49152
    ds_read_b128 v[80:83], v38 offset:49152
    v_lshlrev_b32 v54, 16, v124
    v_and_b32 v55, s84, v124
    v_mfma_f32_32x32x16_bf16 v[144:159], v[104:107], v[76:79], v[144:159]
    ds_read_b128 v[100:103], v46 offset:57344
    ds_read_b128 v[84:87], v38 offset:51200
    v_add_f32 v53, v53, v54
    v_add_f32 v53, v53, v55
    v_mfma_f32_32x32x16_bf16 v[160:175], v[108:111], v[72:75], v[160:175]
    ds_read_b128 v[88:91], v38 offset:53248
    ds_read_b128 v[92:95], v38 offset:55296
    v_lshlrev_b32 v54, 16, v125
    v_and_b32 v55, s84, v125
    v_mfma_f32_32x32x16_bf16 v[176:191], v[108:111], v[76:79], v[176:191]
    v_add_f32 v53, v53, v54
    v_add_f32 v53, v53, v55
    v_mfma_f32_32x32x16_bf16 v[192:207], v[112:115], v[72:75], v[192:207]
    v_lshlrev_b32 v54, 16, v126
    v_and_b32 v55, s84, v126
    buffer_load_dwordx4 v34, s[8:11], s73 offen offset:2048 lds
    v_mfma_f32_32x32x16_bf16 v[208:223], v[112:115], v[76:79], v[208:223]
    v_add_f32 v53, v53, v54
    v_add_f32 v53, v53, v55
    buffer_load_dwordx4 v35, s[8:11], s73 offen offset:3072 lds
    s_add_u32 m0, s75, 0
    v_mfma_f32_32x32x16_bf16 v[224:239], v[116:119], v[72:75], v[224:239]
    v_lshlrev_b32 v54, 16, v127
    v_and_b32 v55, s84, v127
    buffer_load_dwordx4 v24, s[4:7], s72 offen offset:0 lds
    v_mfma_f32_32x32x16_bf16 v[240:255], v[116:119], v[76:79], v[240:255]
    v_add_f32 v53, v53, v54
    v_add_f32 v53, v53, v55
    buffer_load_dwordx4 v25, s[4:7], s72 offen offset:1024 lds
    s_waitcnt lgkmcnt(0)
    v_mfma_f32_32x32x16_bf16 v[128:143], v[80:83], v[96:99], v[128:143]
    ds_read_b128 v[120:123], v47 offset:49152
    ds_read_b128 v[104:107], v39 offset:49152
    v_lshlrev_b32 v54, 16, v96
    v_and_b32 v55, s84, v96
    v_mfma_f32_32x32x16_bf16 v[144:159], v[80:83], v[100:103], v[144:159]
    ds_read_b128 v[124:127], v47 offset:57344
    ds_read_b128 v[108:111], v39 offset:51200
    v_add_f32 v52, v52, v54
    v_add_f32 v52, v52, v55
    v_mfma_f32_32x32x16_bf16 v[160:175], v[84:87], v[96:99], v[160:175]
    ds_read_b128 v[112:115], v39 offset:53248
    ds_read_b128 v[116:119], v39 offset:55296
    v_lshlrev_b32 v54, 16, v97
    v_and_b32 v55, s84, v97
    v_mfma_f32_32x32x16_bf16 v[176:191], v[84:87], v[100:103], v[176:191]
    v_add_f32 v52, v52, v54
    v_add_f32 v52, v52, v55
    v_mfma_f32_32x32x16_bf16 v[192:207], v[88:91], v[96:99], v[192:207]
    v_lshlrev_b32 v54, 16, v98
    v_and_b32 v55, s84, v98
    buffer_load_dwordx4 v26, s[4:7], s72 offen offset:2048 lds
    v_mfma_f32_32x32x16_bf16 v[208:223], v[88:91], v[100:103], v[208:223]
    v_add_f32 v52, v52, v54
    v_add_f32 v52, v52, v55
    buffer_load_dwordx4 v27, s[4:7], s72 offen offset:3072 lds
    s_add_u32 m0, s75, 4096
    v_mfma_f32_32x32x16_bf16 v[224:239], v[92:95], v[96:99], v[224:239]
    v_lshlrev_b32 v54, 16, v99
    v_and_b32 v55, s84, v99
    buffer_load_dwordx4 v28, s[4:7], s72 offen offset:0 lds
    v_mfma_f32_32x32x16_bf16 v[240:255], v[92:95], v[100:103], v[240:255]
    v_add_f32 v52, v52, v54
    v_add_f32 v52, v52, v55
    buffer_load_dwordx4 v29, s[4:7], s72 offen offset:1024 lds
    s_waitcnt lgkmcnt(0)
    v_mfma_f32_32x32x16_bf16 v[128:143], v[104:107], v[120:123], v[128:143]
    s_waitcnt vmcnt(10)
    s_barrier
    ds_read_b128 v[72:75], v48 offset:0
    ds_read_b128 v[80:83], v40 offset:0
    v_lshlrev_b32 v54, 16, v100
    v_and_b32 v55, s84, v100
    v_mfma_f32_32x32x16_bf16 v[144:159], v[104:107], v[124:127], v[144:159]
    ds_read_b128 v[76:79], v48 offset:8192
    ds_read_b128 v[84:87], v40 offset:2048
    v_add_f32 v53, v53, v54
    v_add_f32 v53, v53, v55
    v_mfma_f32_32x32x16_bf16 v[160:175], v[108:111], v[120:123], v[160:175]
    ds_read_b128 v[88:91], v40 offset:4096
    ds_read_b128 v[92:95], v40 offset:6144
    v_lshlrev_b32 v54, 16, v101
    v_and_b32 v55, s84, v101
    v_mfma_f32_32x32x16_bf16 v[176:191], v[108:111], v[124:127], v[176:191]
    v_add_f32 v53, v53, v54
    v_add_f32 v53, v53, v55
    v_mfma_f32_32x32x16_bf16 v[192:207], v[112:115], v[120:123], v[192:207]
    v_lshlrev_b32 v54, 16, v102
    v_and_b32 v55, s84, v102
    buffer_load_dwordx4 v30, s[4:7], s72 offen offset:2048 lds
    v_mfma_f32_32x32x16_bf16 v[208:223], v[112:115], v[124:127], v[208:223]
    v_add_f32 v53, v53, v54
    v_add_f32 v53, v53, v55
    buffer_load_dwordx4 v31, s[4:7], s72 offen offset:3072 lds
    s_add_u32 s72, s72, 128
    s_and_b32 s72, s72, 0x3ff
    s_add_u32 m0, s76, 49152
    v_mfma_f32_32x32x16_bf16 v[224:239], v[116:119], v[120:123], v[224:239]
    v_lshlrev_b32 v54, 16, v103
    v_and_b32 v55, s84, v103
    s_mul_i32 s73, s72, s74
    buffer_load_dwordx4 v32, s[8:11], s73 offen offset:0 lds
    v_mfma_f32_32x32x16_bf16 v[240:255], v[116:119], v[124:127], v[240:255]
    v_add_f32 v53, v53, v54
    v_add_f32 v53, v53, v55
    buffer_load_dwordx4 v33, s[8:11], s73 offen offset:1024 lds
    s_waitcnt lgkmcnt(0)
    v_mfma_f32_32x32x16_bf16 v[128:143], v[80:83], v[72:75], v[128:143]
    ds_read_b128 v[96:99], v49 offset:0
    ds_read_b128 v[104:107], v41 offset:0
    v_lshlrev_b32 v54, 16, v72
    v_and_b32 v55, s84, v72
    v_mfma_f32_32x32x16_bf16 v[144:159], v[80:83], v[76:79], v[144:159]
    ds_read_b128 v[100:103], v49 offset:8192
    ds_read_b128 v[108:111], v41 offset:2048
    v_add_f32 v52, v52, v54
    v_add_f32 v52, v52, v55
    v_mfma_f32_32x32x16_bf16 v[160:175], v[84:87], v[72:75], v[160:175]
    ds_read_b128 v[112:115], v41 offset:4096
    ds_read_b128 v[116:119], v41 offset:6144
    v_lshlrev_b32 v54, 16, v73
    v_and_b32 v55, s84, v73
    v_mfma_f32_32x32x16_bf16 v[176:191], v[84:87], v[76:79], v[176:191]
    v_add_f32 v52, v52, v54
    v_add_f32 v52, v52, v55
    v_mfma_f32_32x32x16_bf16 v[192:207], v[88:91], v[72:75], v[192:207]
    v_lshlrev_b32 v54, 16, v74
    v_and_b32 v55, s84, v74
    v_mfma_f32_32x32x16_bf16 v[208:223], v[88:91], v[76:79], v[208:223]
    v_add_f32 v52, v52, v54
    v_add_f32 v52, v52, v55
    buffer_load_dwordx4 v34, s[8:11], s73 offen offset:2048 lds
    v_mfma_f32_32x32x16_bf16 v[224:239], v[92:95], v[72:75], v[224:239]
    v_lshlrev_b32 v54, 16, v75
    v_and_b32 v55, s84, v75
    buffer_load_dwordx4 v35, s[8:11], s73 offen offset:3072 lds
    s_add_u32 m0, s75, 49152
    v_mfma_f32_32x32x16_bf16 v[240:255], v[92:95], v[76:79], v[240:255]
    v_add_f32 v52, v52, v54
    v_add_f32 v52, v52, v55
    buffer_load_dwordx4 v24, s[4:7], s72 offen offset:0 lds
    s_waitcnt lgkmcnt(0)
    v_mfma_f32_32x32x16_bf16 v[128:143], v[104:107], v[96:99], v[128:143]
    ds_read_b128 v[120:123], v50 offset:0
    ds_read_b128 v[80:83], v42 offset:0
    v_lshlrev_b32 v54, 16, v76
    v_and_b32 v55, s84, v76
    v_mfma_f32_32x32x16_bf16 v[144:159], v[104:107], v[100:103], v[144:159]
    ds_read_b128 v[124:127], v50 offset:8192
    ds_read_b128 v[84:87], v42 offset:2048
    v_add_f32 v53, v53, v54
    v_add_f32 v53, v53, v55
    v_mfma_f32_32x32x16_bf16 v[160:175], v[108:111], v[96:99], v[160:175]
    ds_read_b128 v[88:91], v42 offset:4096
    ds_read_b128 v[92:95], v42 offset:6144
    v_lshlrev_b32 v54, 16, v77
    v_and_b32 v55, s84, v77
    v_mfma_f32_32x32x16_bf16 v[176:191], v[108:111], v[100:103], v[176:191]
    v_add_f32 v53, v53, v54
    v_add_f32 v53, v53, v55
    v_mfma_f32_32x32x16_bf16 v[192:207], v[112:115], v[96:99], v[192:207]
    v_lshlrev_b32 v54, 16, v78
    v_and_b32 v55, s84, v78
    v_mfma_f32_32x32x16_bf16 v[208:223], v[112:115], v[100:103], v[208:223]
    v_add_f32 v53, v53, v54
    v_add_f32 v53, v53, v55
    buffer_load_dwordx4 v25, s[4:7], s72 offen offset:1024 lds
    v_mfma_f32_32x32x16_bf16 v[224:239], v[116:119], v[96:99], v[224:239]
    v_lshlrev_b32 v54, 16, v79
    v_and_b32 v55, s84, v79
    buffer_load_dwordx4 v26, s[4:7], s72 offen offset:2048 lds
    v_mfma_f32_32x32x16_bf16 v[240:255], v[116:119], v[100:103], v[240:255]
    v_add_f32 v53, v53, v54
    v_add_f32 v53, v53, v55
    buffer_load_dwordx4 v27, s[4:7], s72 offen offset:3072 lds
    s_waitcnt lgkmcnt(0)
    v_mfma_f32_32x32x16_bf16 v[128:143], v[80:83], v[120:123], v[128:143]
    ds_read_b128 v[72:75], v51 offset:0
    ds_read_b128 v[104:107], v43 offset:0
    v_lshlrev_b32 v54, 16, v120
    v_and_b32 v55, s84, v120
    v_mfma_f32_32x32x16_bf16 v[144:159], v[80:83], v[124:127], v[144:159]
    ds_read_b128 v[76:79], v51 offset:8192
    ds_read_b128 v[108:111], v43 offset:2048
    v_add_f32 v52, v52, v54
    v_add_f32 v52, v52, v55
    v_mfma_f32_32x32x16_bf16 v[160:175], v[84:87], v[120:123], v[160:175]
    ds_read_b128 v[112:115], v43 offset:4096
    ds_read_b128 v[116:119], v43 offset:6144
    v_lshlrev_b32 v54, 16, v121
    v_and_b32 v55, s84, v121
    v_mfma_f32_32x32x16_bf16 v[176:191], v[84:87], v[124:127], v[176:191]
    v_add_f32 v52, v52, v54
    v_add_f32 v52, v52, v55
    v_mfma_f32_32x32x16_bf16 v[192:207], v[88:91], v[120:123], v[192:207]
    v_lshlrev_b32 v54, 16, v122
    v_and_b32 v55, s84, v122
    s_add_u32 m0, s75, 53248
    v_mfma_f32_32x32x16_bf16 v[208:223], v[88:91], v[124:127], v[208:223]
    v_add_f32 v52, v52, v54
    v_add_f32 v52, v52, v55
    buffer_load_dwordx4 v28, s[4:7], s72 offen offset:0 lds
    v_mfma_f32_32x32x16_bf16 v[224:239], v[92:95], v[120:123], v[224:239]
    v_lshlrev_b32 v54, 16, v123
    v_and_b32 v55, s84, v123
    buffer_load_dwordx4 v29, s[4:7], s72 offen offset:1024 lds
    v_mfma_f32_32x32x16_bf16 v[240:255], v[92:95], v[124:127], v[240:255]
    v_add_f32 v52, v52, v54
    v_add_f32 v52, v52, v55
    buffer_load_dwordx4 v30, s[4:7], s72 offen offset:2048 lds
    s_lshl_b32 s81, s2, 2
    s_add_u32 s81, s81, s64
    s_mul_i32 s82, s81, 1408
    s_lshl_b32 s81, s81, 9
    v_lshlrev_b32 v2, 7, v1
    s_waitcnt lgkmcnt(0)
    v_mfma_f32_32x32x16_bf16 v[128:143], v[104:107], v[72:75], v[128:143]
    s_waitcnt vmcnt(11)
    s_barrier
    ds_read_b128 v[96:99], v44 offset:0
    ds_read_b128 v[80:83], v36 offset:0
    v_lshlrev_b32 v54, 16, v124
    v_and_b32 v55, s84, v124
    v_mfma_f32_32x32x16_bf16 v[144:159], v[104:107], v[76:79], v[144:159]
    ds_read_b128 v[100:103], v44 offset:8192
    ds_read_b128 v[84:87], v36 offset:2048
    v_add_f32 v53, v53, v54
    v_add_f32 v53, v53, v55
    v_mfma_f32_32x32x16_bf16 v[160:175], v[108:111], v[72:75], v[160:175]
    ds_read_b128 v[88:91], v36 offset:4096
    ds_read_b128 v[92:95], v36 offset:6144
    v_lshlrev_b32 v54, 16, v125
    v_and_b32 v55, s84, v125
    v_mfma_f32_32x32x16_bf16 v[176:191], v[108:111], v[76:79], v[176:191]
    v_add_f32 v53, v53, v54
    v_add_f32 v53, v53, v55
    v_mfma_f32_32x32x16_bf16 v[192:207], v[112:115], v[72:75], v[192:207]
    v_lshlrev_b32 v54, 16, v126
    v_and_b32 v55, s84, v126
    v_mfma_f32_32x32x16_bf16 v[208:223], v[112:115], v[76:79], v[208:223]
    v_add_f32 v53, v53, v54
    v_add_f32 v53, v53, v55
    buffer_load_dwordx4 v31, s[4:7], s72 offen offset:3072 lds
    s_add_u32 s72, s72, 128
    s_and_b32 s72, s72, 0x3ff
    s_add_u32 m0, s76, 98304
    v_mfma_f32_32x32x16_bf16 v[224:239], v[116:119], v[72:75], v[224:239]
    v_lshlrev_b32 v54, 16, v127
    v_and_b32 v55, s84, v127
    s_mul_i32 s73, s72, s74
    buffer_load_dwordx4 v32, s[8:11], s73 offen offset:0 lds
    v_mfma_f32_32x32x16_bf16 v[240:255], v[116:119], v[76:79], v[240:255]
    v_add_f32 v53, v53, v54
    v_add_f32 v53, v53, v55
    buffer_load_dwordx4 v33, s[8:11], s73 offen offset:1024 lds
    s_mov_b64 exec, 0x7ff
    buffer_load_dword v0, v2, s[24:27], s82 offen
    s_mov_b64 exec, 15
    buffer_load_dword v0, v2, s[16:19], s81 offen
    buffer_load_dword v0, v2, s[20:23], s81 offen
    s_mov_b64 exec, -1
    s_waitcnt lgkmcnt(0)
    v_mfma_f32_32x32x16_bf16 v[128:143], v[80:83], v[96:99], v[128:143]
    ds_read_b128 v[120:123], v45 offset:0
    ds_read_b128 v[104:107], v37 offset:0
    v_lshlrev_b32 v54, 16, v96
    v_and_b32 v55, s84, v96
    v_mfma_f32_32x32x16_bf16 v[144:159], v[80:83], v[100:103], v[144:159]
    ds_read_b128 v[124:127], v45 offset:8192
    ds_read_b128 v[108:111], v37 offset:2048
    v_add_f32 v52, v52, v54
    v_add_f32 v52, v52, v55
    v_mfma_f32_32x32x16_bf16 v[160:175], v[84:87], v[96:99], v[160:175]
    ds_read_b128 v[112:115], v37 offset:4096
    ds_read_b128 v[116:119], v37 offset:6144
    v_lshlrev_b32 v54, 16, v97
    v_and_b32 v55, s84, v97
    v_mfma_f32_32x32x16_bf16 v[176:191], v[84:87], v[100:103], v[176:191]
    v_add_f32 v52, v52, v54
    v_add_f32 v52, v52, v55
    v_mfma_f32_32x32x16_bf16 v[192:207], v[88:91], v[96:99], v[192:207]
    v_lshlrev_b32 v54, 16, v98
    v_and_b32 v55, s84, v98
    v_mfma_f32_32x32x16_bf16 v[208:223], v[88:91], v[100:103], v[208:223]
    v_add_f32 v52, v52, v54
    v_add_f32 v52, v52, v55
    buffer_load_dwordx4 v34, s[8:11], s73 offen offset:2048 lds
    v_mfma_f32_32x32x16_bf16 v[224:239], v[92:95], v[96:99], v[224:239]
    v_lshlrev_b32 v54, 16, v99
    v_and_b32 v55, s84, v99
    buffer_load_dwordx4 v35, s[8:11], s73 offen offset:3072 lds
    s_add_u32 m0, s75, 98304
    v_mfma_f32_32x32x16_bf16 v[240:255], v[92:95], v[100:103], v[240:255]
    v_add_f32 v52, v52, v54
    v_add_f32 v52, v52, v55
    buffer_load_dwordx4 v24, s[4:7], s72 offen offset:0 lds
    s_waitcnt lgkmcnt(0)
    v_mfma_f32_32x32x16_bf16 v[128:143], v[104:107], v[120:123], v[128:143]
    ds_read_b128 v[72:75], v46 offset:0
    ds_read_b128 v[80:83], v38 offset:0
    v_lshlrev_b32 v54, 16, v100
    v_and_b32 v55, s84, v100
    v_mfma_f32_32x32x16_bf16 v[144:159], v[104:107], v[124:127], v[144:159]
    ds_read_b128 v[76:79], v46 offset:8192
    ds_read_b128 v[84:87], v38 offset:2048
    v_add_f32 v53, v53, v54
    v_add_f32 v53, v53, v55
    v_mfma_f32_32x32x16_bf16 v[160:175], v[108:111], v[120:123], v[160:175]
    ds_read_b128 v[88:91], v38 offset:4096
    ds_read_b128 v[92:95], v38 offset:6144
    v_lshlrev_b32 v54, 16, v101
    v_and_b32 v55, s84, v101
    v_mfma_f32_32x32x16_bf16 v[176:191], v[108:111], v[124:127], v[176:191]
    v_add_f32 v53, v53, v54
    v_add_f32 v53, v53, v55
    v_mfma_f32_32x32x16_bf16 v[192:207], v[112:115], v[120:123], v[192:207]
    v_lshlrev_b32 v54, 16, v102
    v_and_b32 v55, s84, v102
    v_mfma_f32_32x32x16_bf16 v[208:223], v[112:115], v[124:127], v[208:223]
    v_add_f32 v53, v53, v54
    v_add_f32 v53, v53, v55
    buffer_load_dwordx4 v25, s[4:7], s72 offen offset:1024 lds
    v_mfma_f32_32x32x16_bf16 v[224:239], v[116:119], v[120:123], v[224:239]
    v_lshlrev_b32 v54, 16, v103
    v_and_b32 v55, s84, v103
    buffer_load_dwordx4 v26, s[4:7], s72 offen offset:2048 lds
    v_mfma_f32_32x32x16_bf16 v[240:255], v[116:119], v[124:127], v[240:255]
    v_add_f32 v53, v53, v54
    v_add_f32 v53, v53, v55
    buffer_load_dwordx4 v27, s[4:7], s72 offen offset:3072 lds
    s_waitcnt lgkmcnt(0)
    v_mfma_f32_32x32x16_bf16 v[128:143], v[80:83], v[72:75], v[128:143]
    ds_read_b128 v[96:99], v47 offset:0
    ds_read_b128 v[104:107], v39 offset:0
    v_lshlrev_b32 v54, 16, v72
    v_and_b32 v55, s84, v72
    v_mfma_f32_32x32x16_bf16 v[144:159], v[80:83], v[76:79], v[144:159]
    ds_read_b128 v[100:103], v47 offset:8192
    ds_read_b128 v[108:111], v39 offset:2048
    v_add_f32 v52, v52, v54
    v_add_f32 v52, v52, v55
    v_mfma_f32_32x32x16_bf16 v[160:175], v[84:87], v[72:75], v[160:175]
    ds_read_b128 v[112:115], v39 offset:4096
    ds_read_b128 v[116:119], v39 offset:6144
    v_lshlrev_b32 v54, 16, v73
    v_and_b32 v55, s84, v73
    v_mfma_f32_32x32x16_bf16 v[176:191], v[84:87], v[76:79], v[176:191]
    v_add_f32 v52, v52, v54
    v_add_f32 v52, v52, v55
    v_mfma_f32_32x32x16_bf16 v[192:207], v[88:91], v[72:75], v[192:207]
    v_lshlrev_b32 v54, 16, v74
    v_and_b32 v55, s84, v74
    s_add_u32 m0, s75, 102400
    v_mfma_f32_32x32x16_bf16 v[208:223], v[88:91], v[76:79], v[208:223]
    v_add_f32 v52, v52, v54
    v_add_f32 v52, v52, v55
    buffer_load_dwordx4 v28, s[4:7], s72 offen offset:0 lds
    v_mfma_f32_32x32x16_bf16 v[224:239], v[92:95], v[72:75], v[224:239]
    v_lshlrev_b32 v54, 16, v75
    v_and_b32 v55, s84, v75
    buffer_load_dwordx4 v29, s[4:7], s72 offen offset:1024 lds
    v_mfma_f32_32x32x16_bf16 v[240:255], v[92:95], v[76:79], v[240:255]
    v_add_f32 v52, v52, v54
    v_add_f32 v52, v52, v55
    buffer_load_dwordx4 v30, s[4:7], s72 offen offset:2048 lds
    s_waitcnt lgkmcnt(0)
    v_mfma_f32_32x32x16_bf16 v[128:143], v[104:107], v[96:99], v[128:143]
    s_waitcnt vmcnt(14)
    s_barrier
    ds_read_b128 v[120:123], v44 offset:49152
    ds_read_b128 v[80:83], v36 offset:49152
    v_lshlrev_b32 v54, 16, v76
    v_and_b32 v55, s84, v76
    v_mfma_f32_32x32x16_bf16 v[144:159], v[104:107], v[100:103], v[144:159]
    ds_read_b128 v[124:127], v44 offset:57344
    ds_read_b128 v[84:87], v36 offset:51200
    v_add_f32 v53, v53, v54
    v_add_f32 v53, v53, v55
    v_mfma_f32_32x32x16_bf16 v[160:175], v[108:111], v[96:99], v[160:175]
    ds_read_b128 v[88:91], v36 offset:53248
    ds_read_b128 v[92:95], v36 offset:55296
    v_lshlrev_b32 v54, 16, v77
    v_and_b32 v55, s84, v77
    v_mfma_f32_32x32x16_bf16 v[176:191], v[108:111], v[100:103], v[176:191]
    v_add_f32 v53, v53, v54
    v_add_f32 v53, v53, v55
    v_mfma_f32_32x32x16_bf16 v[192:207], v[112:115], v[96:99], v[192:207]
    v_lshlrev_b32 v54, 16, v78
    v_and_b32 v55, s84, v78
    v_mfma_f32_32x32x16_bf16 v[208:223], v[112:115], v[100:103], v[208:223]
    v_add_f32 v53, v53, v54
    v_add_f32 v53, v53, v55
    buffer_load_dwordx4 v31, s[4:7], s72 offen offset:3072 lds
    s_add_u32 s72, s72, 128
    s_and_b32 s72, s72, 0x3ff
    s_add_u32 m0, s76, 0
    v_mfma_f32_32x32x16_bf16 v[224:239], v[116:119], v[96:99], v[224:239]
    v_lshlrev_b32 v54, 16, v79
    v_and_b32 v55, s84, v79
    s_mul_i32 s73, s72, s74
    buffer_load_dwordx4 v32, s[8:11], s73 offen offset:0 lds
    v_mfma_f32_32x32x16_bf16 v[240:255], v[116:119], v[100:103], v[240:255]
    v_add_f32 v53, v53, v54
    v_add_f32 v53, v53, v55
    buffer_load_dwordx4 v33, s[8:11], s73 offen offset:1024 lds
    s_waitcnt lgkmcnt(0)
    v_mfma_f32_32x32x16_bf16 v[128:143], v[80:83], v[120:123], v[128:143]
    ds_read_b128 v[72:75], v45 offset:49152
    ds_read_b128 v[104:107], v37 offset:49152
    v_lshlrev_b32 v54, 16, v120
    v_and_b32 v55, s84, v120
    v_mfma_f32_32x32x16_bf16 v[144:159], v[80:83], v[124:127], v[144:159]
    ds_read_b128 v[76:79], v45 offset:57344
    ds_read_b128 v[108:111], v37 offset:51200
    v_add_f32 v52, v52, v54
    v_add_f32 v52, v52, v55
    v_mfma_f32_32x32x16_bf16 v[160:175], v[84:87], v[120:123], v[160:175]
    ds_read_b128 v[112:115], v37 offset:53248
    ds_read_b128 v[116:119], v37 offset:55296
    v_lshlrev_b32 v54, 16, v121
    v_and_b32 v55, s84, v121
    v_mfma_f32_32x32x16_bf16 v[176:191], v[84:87], v[124:127], v[176:191]
    v_add_f32 v52, v52, v54
    v_add_f32 v52, v52, v55
    v_mfma_f32_32x32x16_bf16 v[192:207], v[88:91], v[120:123], v[192:207]
    v_lshlrev_b32 v54, 16, v122
    v_and_b32 v55, s84, v122
    v_mfma_f32_32x32x16_bf16 v[208:223], v[88:91], v[124:127], v[208:223]
    v_add_f32 v52, v52, v54
    v_add_f32 v52, v52, v55
    buffer_load_dwordx4 v34, s[8:11], s73 offen offset:2048 lds
    v_mfma_f32_32x32x16_bf16 v[224:239], v[92:95], v[120:123], v[224:239]
    v_lshlrev_b32 v54, 16, v123
    v_and_b32 v55, s84, v123
    buffer_load_dwordx4 v35, s[8:11], s73 offen offset:3072 lds
    s_add_u32 m0, s75, 0
    v_mfma_f32_32x32x16_bf16 v[240:255], v[92:95], v[124:127], v[240:255]
    v_add_f32 v52, v52, v54
    v_add_f32 v52, v52, v55
    buffer_load_dwordx4 v24, s[4:7], s72 offen offset:0 lds
    s_waitcnt lgkmcnt(0)
    v_mfma_f32_32x32x16_bf16 v[128:143], v[104:107], v[72:75], v[128:143]
    ds_read_b128 v[96:99], v46 offset:49152
    ds_read_b128 v[80:83], v38 offset:49152
    v_lshlrev_b32 v54, 16, v124
    v_and_b32 v55, s84, v124
    v_mfma_f32_32x32x16_bf16 v[144:159], v[104:107], v[76:79], v[144:159]
    ds_read_b128 v[100:103], v46 offset:57344
    ds_read_b128 v[84:87], v38 offset:51200
    v_add_f32 v53, v53, v54
    v_add_f32 v53, v53, v55
    v_mfma_f32_32x32x16_bf16 v[160:175], v[108:111], v[72:75], v[160:175]
    ds_read_b128 v[88:91], v38 offset:53248
    ds_read_b128 v[92:95], v38 offset:55296
    v_lshlrev_b32 v54, 16, v125
    v_and_b32 v55, s84, v125
    v_mfma_f32_32x32x16_bf16 v[176:191], v[108:111], v[76:79], v[176:191]
    v_add_f32 v53, v53, v54
    v_add_f32 v53, v53, v55
    v_mfma_f32_32x32x16_bf16 v[192:207], v[112:115], v[72:75], v[192:207]
    v_lshlrev_b32 v54, 16, v126
    v_and_b32 v55, s84, v126
    v_mfma_f32_32x32x16_bf16 v[208:223], v[112:115], v[76:79], v[208:223]
    v_add_f32 v53, v53, v54
    v_add_f32 v53, v53, v55
    buffer_load_dwordx4 v25, s[4:7], s72 offen offset:1024 lds
    v_mfma_f32_32x32x16_bf16 v[224:239], v[116:119], v[72:75], v[224:239]
    v_lshlrev_b32 v54, 16, v127
    v_and_b32 v55, s84, v127
    buffer_load_dwordx4 v26, s[4:7], s72 offen offset:2048 lds
    v_mfma_f32_32x32x16_bf16 v[240:255], v[116:119], v[76:79], v[240:255]
    v_add_f32 v53, v53, v54
    v_add_f32 v53, v53, v55
    buffer_load_dwordx4 v27, s[4:7], s72 offen offset:3072 lds
    s_waitcnt lgkmcnt(0)
    v_mfma_f32_32x32x16_bf16 v[128:143], v[80:83], v[96:99], v[128:143]
    ds_read_b128 v[120:123], v47 offset:49152
    ds_read_b128 v[104:107], v39 offset:49152
    v_lshlrev_b32 v54, 16, v96
    v_and_b32 v55, s84, v96
    v_mfma_f32_32x32x16_bf16 v[144:159], v[80:83], v[100:103], v[144:159]
    ds_read_b128 v[124:127], v47 offset:57344
    ds_read_b128 v[108:111], v39 offset:51200
    v_add_f32 v52, v52, v54
    v_add_f32 v52, v52, v55
    v_mfma_f32_32x32x16_bf16 v[160:175], v[84:87], v[96:99], v[160:175]
    ds_read_b128 v[112:115], v39 offset:53248
    ds_read_b128 v[116:119], v39 offset:55296
    v_lshlrev_b32 v54, 16, v97
    v_and_b32 v55, s84, v97
    v_mfma_f32_32x32x16_bf16 v[176:191], v[84:87], v[100:103], v[176:191]
    v_add_f32 v52, v52, v54
    v_add_f32 v52, v52, v55
    v_mfma_f32_32x32x16_bf16 v[192:207], v[88:91], v[96:99], v[192:207]
    v_lshlrev_b32 v54, 16, v98
    v_and_b32 v55, s84, v98
    s_add_u32 m0, s75, 4096
    v_mfma_f32_32x32x16_bf16 v[208:223], v[88:91], v[100:103], v[208:223]
    v_add_f32 v52, v52, v54
    v_add_f32 v52, v52, v55
    buffer_load_dwordx4 v28, s[4:7], s72 offen offset:0 lds
    v_mfma_f32_32x32x16_bf16 v[224:239], v[92:95], v[96:99], v[224:239]
    v_lshlrev_b32 v54, 16, v99
    v_and_b32 v55, s84, v99
    buffer_load_dwordx4 v29, s[4:7], s72 offen offset:1024 lds
    v_mfma_f32_32x32x16_bf16 v[240:255], v[92:95], v[100:103], v[240:255]
    v_add_f32 v52, v52, v54
    v_add_f32 v52, v52, v55
    buffer_load_dwordx4 v30, s[4:7], s72 offen offset:2048 lds
    s_waitcnt lgkmcnt(0)
    v_mfma_f32_32x32x16_bf16 v[128:143], v[104:107], v[120:123], v[128:143]
    s_waitcnt vmcnt(11)
    s_barrier
    ds_read_b128 v[72:75], v48 offset:0
    ds_read_b128 v[80:83], v40 offset:0
    v_lshlrev_b32 v54, 16, v100
    v_and_b32 v55, s84, v100
    v_mfma_f32_32x32x16_bf16 v[144:159], v[104:107], v[124:127], v[144:159]
    ds_read_b128 v[76:79], v48 offset:8192
    ds_read_b128 v[84:87], v40 offset:2048
    v_add_f32 v53, v53, v54
    v_add_f32 v53, v53, v55
    v_mfma_f32_32x32x16_bf16 v[160:175], v[108:111], v[120:123], v[160:175]
    ds_read_b128 v[88:91], v40 offset:4096
    ds_read_b128 v[92:95], v40 offset:6144
    v_lshlrev_b32 v54, 16, v101
    v_and_b32 v55, s84, v101
    v_mfma_f32_32x32x16_bf16 v[176:191], v[108:111], v[124:127], v[176:191]
    v_add_f32 v53, v53, v54
    v_add_f32 v53, v53, v55
    v_mfma_f32_32x32x16_bf16 v[192:207], v[112:115], v[120:123], v[192:207]
    v_lshlrev_b32 v54, 16, v102
    v_and_b32 v55, s84, v102
    v_mfma_f32_32x32x16_bf16 v[208:223], v[112:115], v[124:127], v[208:223]
    v_add_f32 v53, v53, v54
    v_add_f32 v53, v53, v55
    buffer_load_dwordx4 v31, s[4:7], s72 offen offset:3072 lds
    s_add_u32 s72, s72, 128
    s_and_b32 s72, s72, 0x3ff
    s_add_u32 m0, s76, 49152
    v_mfma_f32_32x32x16_bf16 v[224:239], v[116:119], v[120:123], v[224:239]
    v_lshlrev_b32 v54, 16, v103
    v_and_b32 v55, s84, v103
    s_mul_i32 s73, s72, s74
    buffer_load_dwordx4 v32, s[8:11], s73 offen offset:0 lds
    v_mfma_f32_32x32x16_bf16 v[240:255], v[116:119], v[124:127], v[240:255]
    v_add_f32 v53, v53, v54
    v_add_f32 v53, v53, v55
    buffer_load_dwordx4 v33, s[8:11], s73 offen offset:1024 lds
    s_waitcnt lgkmcnt(0)
    v_mfma_f32_32x32x16_bf16 v[128:143], v[80:83], v[72:75], v[128:143]
    ds_read_b128 v[96:99], v49 offset:0
    ds_read_b128 v[104:107], v41 offset:0
    v_lshlrev_b32 v54, 16, v72
    v_and_b32 v55, s84, v72
    v_mfma_f32_32x32x16_bf16 v[144:159], v[80:83], v[76:79], v[144:159]
    ds_read_b128 v[100:103], v49 offset:8192
    ds_read_b128 v[108:111], v41 offset:2048
    v_add_f32 v52, v52, v54
    v_add_f32 v52, v52, v55
    v_mfma_f32_32x32x16_bf16 v[160:175], v[84:87], v[72:75], v[160:175]
    ds_read_b128 v[112:115], v41 offset:4096
    ds_read_b128 v[116:119], v41 offset:6144
    v_lshlrev_b32 v54, 16, v73
    v_and_b32 v55, s84, v73
    v_mfma_f32_32x32x16_bf16 v[176:191], v[84:87], v[76:79], v[176:191]
    v_add_f32 v52, v52, v54
    v_add_f32 v52, v52, v55
    v_mfma_f32_32x32x16_bf16 v[192:207], v[88:91], v[72:75], v[192:207]
    v_lshlrev_b32 v54, 16, v74
    v_and_b32 v55, s84, v74
    v_mfma_f32_32x32x16_bf16 v[208:223], v[88:91], v[76:79], v[208:223]
    v_add_f32 v52, v52, v54
    v_add_f32 v52, v52, v55
    buffer_load_dwordx4 v34, s[8:11], s73 offen offset:2048 lds
    v_mfma_f32_32x32x16_bf16 v[224:239], v[92:95], v[72:75], v[224:239]
    v_lshlrev_b32 v54, 16, v75
    v_and_b32 v55, s84, v75
    buffer_load_dwordx4 v35, s[8:11], s73 offen offset:3072 lds
    s_add_u32 m0, s75, 49152
    v_mfma_f32_32x32x16_bf16 v[240:255], v[92:95], v[76:79], v[240:255]
    v_add_f32 v52, v52, v54
    v_add_f32 v52, v52, v55
    buffer_load_dwordx4 v24, s[4:7], s72 offen offset:0 lds
    s_waitcnt lgkmcnt(0)
    v_mfma_f32_32x32x16_bf16 v[128:143], v[104:107], v[96:99], v[128:143]
    ds_read_b128 v[120:123], v50 offset:0
    ds_read_b128 v[80:83], v42 offset:0
    v_lshlrev_b32 v54, 16, v76
    v_and_b32 v55, s84, v76
    v_mfma_f32_32x32x16_bf16 v[144:159], v[104:107], v[100:103], v[144:159]
    ds_read_b128 v[124:127], v50 offset:8192
    ds_read_b128 v[84:87], v42 offset:2048
    v_add_f32 v53, v53, v54
    v_add_f32 v53, v53, v55
    v_mfma_f32_32x32x16_bf16 v[160:175], v[108:111], v[96:99], v[160:175]
    ds_read_b128 v[88:91], v42 offset:4096
    ds_read_b128 v[92:95], v42 offset:6144
    v_lshlrev_b32 v54, 16, v77
    v_and_b32 v55, s84, v77
    v_mfma_f32_32x32x16_bf16 v[176:191], v[108:111], v[100:103], v[176:191]
    v_add_f32 v53, v53, v54
    v_add_f32 v53, v53, v55
    v_mfma_f32_32x32x16_bf16 v[192:207], v[112:115], v[96:99], v[192:207]
    v_lshlrev_b32 v54, 16, v78
    v_and_b32 v55, s84, v78
    v_mfma_f32_32x32x16_bf16 v[208:223], v[112:115], v[100:103], v[208:223]
    v_add_f32 v53, v53, v54
    v_add_f32 v53, v53, v55
    buffer_load_dwordx4 v25, s[4:7], s72 offen offset:1024 lds
    v_mfma_f32_32x32x16_bf16 v[224:239], v[116:119], v[96:99], v[224:239]
    v_lshlrev_b32 v54, 16, v79
    v_and_b32 v55, s84, v79
    buffer_load_dwordx4 v26, s[4:7], s72 offen offset:2048 lds
    v_mfma_f32_32x32x16_bf16 v[240:255], v[116:119], v[100:103], v[240:255]
    v_add_f32 v53, v53, v54
    v_add_f32 v53, v53, v55
    buffer_load_dwordx4 v27, s[4:7], s72 offen offset:3072 lds
    s_waitcnt lgkmcnt(0)
    v_mfma_f32_32x32x16_bf16 v[128:143], v[80:83], v[120:123], v[128:143]
    ds_read_b128 v[72:75], v51 offset:0
    ds_read_b128 v[104:107], v43 offset:0
    v_lshlrev_b32 v54, 16, v120
    v_and_b32 v55, s84, v120
    v_mfma_f32_32x32x16_bf16 v[144:159], v[80:83], v[124:127], v[144:159]
    ds_read_b128 v[76:79], v51 offset:8192
    ds_read_b128 v[108:111], v43 offset:2048
    v_add_f32 v52, v52, v54
    v_add_f32 v52, v52, v55
    v_mfma_f32_32x32x16_bf16 v[160:175], v[84:87], v[120:123], v[160:175]
    ds_read_b128 v[112:115], v43 offset:4096
    ds_read_b128 v[116:119], v43 offset:6144
    v_lshlrev_b32 v54, 16, v121
    v_and_b32 v55, s84, v121
    v_mfma_f32_32x32x16_bf16 v[176:191], v[84:87], v[124:127], v[176:191]
    v_add_f32 v52, v52, v54
    v_add_f32 v52, v52, v55
    v_mfma_f32_32x32x16_bf16 v[192:207], v[88:91], v[120:123], v[192:207]
    v_lshlrev_b32 v54, 16, v122
    v_and_b32 v55, s84, v122
    s_add_u32 m0, s75, 53248
    v_mfma_f32_32x32x16_bf16 v[208:223], v[88:91], v[124:127], v[208:223]
    v_add_f32 v52, v52, v54
    v_add_f32 v52, v52, v55
    buffer_load_dwordx4 v28, s[4:7], s72 offen offset:0 lds
    v_mfma_f32_32x32x16_bf16 v[224:239], v[92:95], v[120:123], v[224:239]
    v_lshlrev_b32 v54, 16, v123
    v_and_b32 v55, s84, v123
    buffer_load_dwordx4 v29, s[4:7], s72 offen offset:1024 lds
    v_mfma_f32_32x32x16_bf16 v[240:255], v[92:95], v[124:127], v[240:255]
    v_add_f32 v52, v52, v54
    v_add_f32 v52, v52, v55
    buffer_load_dwordx4 v30, s[4:7], s72 offen offset:2048 lds
    s_waitcnt lgkmcnt(0)
    v_mfma_f32_32x32x16_bf16 v[128:143], v[104:107], v[72:75], v[128:143]
    s_waitcnt vmcnt(11)
    s_barrier
    ds_read_b128 v[96:99], v44 offset:0
    ds_read_b128 v[80:83], v36 offset:0
    v_lshlrev_b32 v54, 16, v124
    v_and_b32 v55, s84, v124
    v_mfma_f32_32x32x16_bf16 v[144:159], v[104:107], v[76:79], v[144:159]
    ds_read_b128 v[100:103], v44 offset:8192
    ds_read_b128 v[84:87], v36 offset:2048
    v_add_f32 v53, v53, v54
    v_add_f32 v53, v53, v55
    v_mfma_f32_32x32x16_bf16 v[160:175], v[108:111], v[72:75], v[160:175]
    ds_read_b128 v[88:91], v36 offset:4096
    ds_read_b128 v[92:95], v36 offset:6144
    v_lshlrev_b32 v54, 16, v125
    v_and_b32 v55, s84, v125
    v_mfma_f32_32x32x16_bf16 v[176:191], v[108:111], v[76:79], v[176:191]
    s_mov_b32 s28, s60
    s_mov_b32 s29, s61
    s_mov_b32 s30, 256
    s_mov_b32 s31, 0x00020000
    v_min_u32 v2, 15, v1
    v_lshlrev_b32 v2, 2, v2
    buffer_load_dword v3, v2, s[28:31], 0 offen sc1
    v_add_f32 v53, v53, v54
    v_add_f32 v53, v53, v55
    v_mfma_f32_32x32x16_bf16 v[192:207], v[112:115], v[72:75], v[192:207]
    v_lshlrev_b32 v54, 16, v126
    v_and_b32 v55, s84, v126
    v_mfma_f32_32x32x16_bf16 v[208:223], v[112:115], v[76:79], v[208:223]
    v_add_f32 v53, v53, v54
    v_add_f32 v53, v53, v55
    buffer_load_dwordx4 v31, s[4:7], s72 offen offset:3072 lds
    s_add_u32 s72, s72, 128
    s_and_b32 s72, s72, 0x3ff
    s_add_u32 m0, s77, 0
    v_mfma_f32_32x32x16_bf16 v[224:239], v[116:119], v[72:75], v[224:239]
    v_lshlrev_b32 v54, 16, v127
    v_and_b32 v55, s84, v127
    s_add_u32 s89, s85, 0
    buffer_load_dwordx4 v16, s[16:19], s89 offen offset:0 lds
    v_mfma_f32_32x32x16_bf16 v[240:255], v[116:119], v[76:79], v[240:255]
    v_add_f32 v53, v53, v54
    v_add_f32 v53, v53, v55
    buffer_load_dwordx4 v17, s[16:19], s89 offen offset:1024 lds
    s_waitcnt lgkmcnt(0)
    v_mfma_f32_32x32x16_bf16 v[128:143], v[80:83], v[96:99], v[128:143]
    ds_read_b128 v[120:123], v45 offset:0
    ds_read_b128 v[104:107], v37 offset:0
    v_lshlrev_b32 v54, 16, v96
    v_and_b32 v55, s84, v96
    v_mfma_f32_32x32x16_bf16 v[144:159], v[80:83], v[100:103], v[144:159]
    ds_read_b128 v[124:127], v45 offset:8192
    ds_read_b128 v[108:111], v37 offset:2048
    v_add_f32 v52, v52, v54
    v_add_f32 v52, v52, v55
    v_mfma_f32_32x32x16_bf16 v[160:175], v[84:87], v[96:99], v[160:175]
    ds_read_b128 v[112:115], v37 offset:4096
    ds_read_b128 v[116:119], v37 offset:6144
    v_lshlrev_b32 v54, 16, v97
    v_and_b32 v55, s84, v97
    v_mfma_f32_32x32x16_bf16 v[176:191], v[84:87], v[100:103], v[176:191]
    v_add_f32 v52, v52, v54
    v_add_f32 v52, v52, v55
    v_mfma_f32_32x32x16_bf16 v[192:207], v[88:91], v[96:99], v[192:207]
    v_lshlrev_b32 v54, 16, v98
    v_and_b32 v55, s84, v98
    v_mfma_f32_32x32x16_bf16 v[208:223], v[88:91], v[100:103], v[208:223]
    v_add_f32 v52, v52, v54
    v_add_f32 v52, v52, v55
    buffer_load_dwordx4 v18, s[16:19], s89 offen offset:2048 lds
    v_mfma_f32_32x32x16_bf16 v[224:239], v[92:95], v[96:99], v[224:239]
    v_lshlrev_b32 v54, 16, v99
    v_and_b32 v55, s84, v99
    buffer_load_dwordx4 v19, s[16:19], s89 offen offset:3072 lds
    s_add_u32 m0, s77, 4096
    v_mfma_f32_32x32x16_bf16 v[240:255], v[92:95], v[100:103], v[240:255]
    v_add_f32 v52, v52, v54
    v_add_f32 v52, v52, v55
    s_add_u32 s89, s86, 0
    buffer_load_dwordx4 v16, s[16:19], s89 offen offset:0 lds
    s_waitcnt lgkmcnt(0)
    v_mfma_f32_32x32x16_bf16 v[128:143], v[104:107], v[120:123], v[128:143]
    ds_read_b128 v[72:75], v46 offset:0
    ds_read_b128 v[80:83], v38 offset:0
    v_lshlrev_b32 v54, 16, v100
    v_and_b32 v55, s84, v100
    v_mfma_f32_32x32x16_bf16 v[144:159], v[104:107], v[124:127], v[144:159]
    ds_read_b128 v[76:79], v46 offset:8192
    ds_read_b128 v[84:87], v38 offset:2048
    v_add_f32 v53, v53, v54
    v_add_f32 v53, v53, v55
    v_mfma_f32_32x32x16_bf16 v[160:175], v[108:111], v[120:123], v[160:175]
    ds_read_b128 v[88:91], v38 offset:4096
    ds_read_b128 v[92:95], v38 offset:6144
    v_lshlrev_b32 v54, 16, v101
    v_and_b32 v55, s84, v101
    v_mfma_f32_32x32x16_bf16 v[176:191], v[108:111], v[124:127], v[176:191]
    v_add_f32 v53, v53, v54
    v_add_f32 v53, v53, v55
    v_mfma_f32_32x32x16_bf16 v[192:207], v[112:115], v[120:123], v[192:207]
    v_lshlrev_b32 v54, 16, v102
    v_and_b32 v55, s84, v102
    v_mfma_f32_32x32x16_bf16 v[208:223], v[112:115], v[124:127], v[208:223]
    v_add_f32 v53, v53, v54
    v_add_f32 v53, v53, v55
    buffer_load_dwordx4 v17, s[16:19], s89 offen offset:1024 lds
    v_mfma_f32_32x32x16_bf16 v[224:239], v[116:119], v[120:123], v[224:239]
    v_lshlrev_b32 v54, 16, v103
    v_and_b32 v55, s84, v103
    buffer_load_dwordx4 v18, s[16:19], s89 offen offset:2048 lds
    v_mfma_f32_32x32x16_bf16 v[240:255], v[116:119], v[124:127], v[240:255]
    v_add_f32 v53, v53, v54
    v_add_f32 v53, v53, v55
    buffer_load_dwordx4 v19, s[16:19], s89 offen offset:3072 lds
    s_waitcnt lgkmcnt(0)
    v_mfma_f32_32x32x16_bf16 v[128:143], v[80:83], v[72:75], v[128:143]
    ds_read_b128 v[96:99], v47 offset:0
    ds_read_b128 v[104:107], v39 offset:0
    v_lshlrev_b32 v54, 16, v72
    v_and_b32 v55, s84, v72
    v_mfma_f32_32x32x16_bf16 v[144:159], v[80:83], v[76:79], v[144:159]
    ds_read_b128 v[100:103], v47 offset:8192
    ds_read_b128 v[108:111], v39 offset:2048
    v_add_f32 v52, v52, v54
    v_add_f32 v52, v52, v55
    v_mfma_f32_32x32x16_bf16 v[160:175], v[84:87], v[72:75], v[160:175]
    ds_read_b128 v[112:115], v39 offset:4096
    ds_read_b128 v[116:119], v39 offset:6144
    v_lshlrev_b32 v54, 16, v73
    v_and_b32 v55, s84, v73
    v_mfma_f32_32x32x16_bf16 v[176:191], v[84:87], v[76:79], v[176:191]
    v_add_f32 v52, v52, v54
    v_add_f32 v52, v52, v55
    v_mfma_f32_32x32x16_bf16 v[192:207], v[88:91], v[72:75], v[192:207]
    v_lshlrev_b32 v54, 16, v74
    v_and_b32 v55, s84, v74
    s_add_u32 m0, s77, 8192
    v_mfma_f32_32x32x16_bf16 v[208:223], v[88:91], v[76:79], v[208:223]
    v_add_f32 v52, v52, v54
    v_add_f32 v52, v52, v55
    s_add_u32 s89, s85, 0
    buffer_load_dwordx4 v16, s[20:23], s89 offen offset:0 lds
    v_mfma_f32_32x32x16_bf16 v[224:239], v[92:95], v[72:75], v[224:239]
    v_lshlrev_b32 v54, 16, v75
    v_and_b32 v55, s84, v75
    buffer_load_dwordx4 v17, s[20:23], s89 offen offset:1024 lds
    v_mfma_f32_32x32x16_bf16 v[240:255], v[92:95], v[76:79], v[240:255]
    v_add_f32 v52, v52, v54
    v_add_f32 v52, v52, v55
    buffer_load_dwordx4 v18, s[20:23], s89 offen offset:2048 lds
    s_waitcnt lgkmcnt(0)
    v_mfma_f32_32x32x16_bf16 v[128:143], v[104:107], v[96:99], v[128:143]
    s_waitcnt vmcnt(11)
    s_barrier
    ds_read_b128 v[120:123], v44 offset:49152
    ds_read_b128 v[80:83], v36 offset:49152
    v_lshlrev_b32 v54, 16, v76
    v_and_b32 v55, s84, v76
    v_mfma_f32_32x32x16_bf16 v[144:159], v[104:107], v[100:103], v[144:159]
    ds_read_b128 v[124:127], v44 offset:57344
    ds_read_b128 v[84:87], v36 offset:51200
    v_add_f32 v53, v53, v54
    v_add_f32 v53, v53, v55
    v_mfma_f32_32x32x16_bf16 v[160:175], v[108:111], v[96:99], v[160:175]
    ds_read_b128 v[88:91], v36 offset:53248
    ds_read_b128 v[92:95], v36 offset:55296
    v_lshlrev_b32 v54, 16, v77
    v_and_b32 v55, s84, v77
    v_mfma_f32_32x32x16_bf16 v[176:191], v[108:111], v[100:103], v[176:191]
    s_mov_b32 s83, 200000
    s_branch Lpchk_9
Lpoll_7:
    buffer_load_dword v3, v2, s[28:31], 0 offen sc1
    s_waitcnt vmcnt(0)
Lpchk_9:
    v_cmp_ne_u32 vcc, 0, v3
    s_nop 1
    s_cmp_eq_u64 vcc, -1
    s_cbranch_scc1 Lpdone_8
    s_sub_u32 s83, s83, 1
    s_cbranch_scc1 Lpdone_8
    s_sleep 1
    s_branch Lpoll_7
Lpdone_8:
    s_lshl_b32 s81, s65, 1
    s_add_u32 s81, s81, s70
    s_lshl_b32 s82, s81, 9
    s_add_u32 s82, s82, 10551296
    s_lshl_b32 s81, s81, 11
    s_add_u32 s81, s81, 10485760
    v_bfe_u32 v4, v1, 2, 1
    v_and_b32 v5, 3, v1
    v_lshl_add_u32 v4, v4, 6, v5
    v_bfe_u32 v5, v1, 3, 2
    v_lshl_add_u32 v4, v5, 2, v4
    v_lshlrev_b32 v4, 4, v4
    buffer_load_dword v56, v4, s[12:15], s81 offen offset:0 sc1
    buffer_load_dword v60, v4, s[12:15], s81 offen offset:256 sc1
    buffer_load_dword v64, v4, s[12:15], s81 offen offset:512 sc1
    buffer_load_dword v68, v4, s[12:15], s81 offen offset:768 sc1
    v_lshlrev_b32 v4, 3, v1
    buffer_load_dwordx2 v[2:3], v4, s[12:15], s82 offen sc1
    v_add_f32 v53, v53, v54
    v_add_f32 v53, v53, v55
    v_mfma_f32_32x32x16_bf16 v[192:207], v[112:115], v[96:99], v[192:207]
    ds_read_b128 v[24:27], v46 offset:49152
    ds_read_b128 v[28:31], v46 offset:57344
    v_lshlrev_b32 v54, 16, v78
    v_and_b32 v55, s84, v78
    v_mfma_f32_32x32x16_bf16 v[208:223], v[112:115], v[100:103], v[208:223]
    v_add_f32 v53, v53, v54
    v_add_f32 v53, v53, v55
    buffer_load_dwordx4 v19, s[20:23], s89 offen offset:3072 lds
    s_add_u32 m0, s78, 0
    v_mfma_f32_32x32x16_bf16 v[224:239], v[116:119], v[96:99], v[224:239]
    v_lshlrev_b32 v54, 16, v79
    v_and_b32 v55, s84, v79
    s_add_u32 s89, s86, 0
    buffer_load_dwordx4 v16, s[20:23], s89 offen offset:0 lds
    v_mfma_f32_32x32x16_bf16 v[240:255], v[116:119], v[100:103], v[240:255]
    v_add_f32 v53, v53, v54
    v_add_f32 v53, v53, v55
    buffer_load_dwordx4 v17, s[20:23], s89 offen offset:1024 lds
    s_waitcnt lgkmcnt(0)
    v_mfma_f32_32x32x16_bf16 v[128:143], v[80:83], v[120:123], v[128:143]
    ds_read_b128 v[72:75], v45 offset:49152
    ds_read_b128 v[104:107], v37 offset:49152
    v_lshlrev_b32 v54, 16, v120
    v_and_b32 v55, s84, v120
    v_add_f32 v52, v52, v54
    v_add_f32 v52, v52, v55
    v_mfma_f32_32x32x16_bf16 v[144:159], v[80:83], v[124:127], v[144:159]
    ds_read_b128 v[76:79], v45 offset:57344
    ds_read_b128 v[108:111], v37 offset:51200
    v_lshlrev_b32 v54, 16, v121
    v_and_b32 v55, s84, v121
    v_add_f32 v52, v52, v54
    v_add_f32 v52, v52, v55
    v_mfma_f32_32x32x16_bf16 v[160:175], v[84:87], v[120:123], v[160:175]
    ds_read_b128 v[112:115], v37 offset:53248
    ds_read_b128 v[116:119], v37 offset:55296
    v_lshlrev_b32 v54, 16, v122
    v_and_b32 v55, s84, v122
    v_add_f32 v52, v52, v54
    v_add_f32 v52, v52, v55
    v_mfma_f32_32x32x16_bf16 v[176:191], v[84:87], v[124:127], v[176:191]
    v_lshlrev_b32 v54, 16, v123
    v_and_b32 v55, s84, v123
    v_add_f32 v52, v52, v54
    v_add_f32 v52, v52, v55
    v_mfma_f32_32x32x16_bf16 v[192:207], v[88:91], v[120:123], v[192:207]
    v_lshlrev_b32 v54, 16, v24
    v_and_b32 v55, s84, v24
    v_add_f32 v52, v52, v54
    v_add_f32 v52, v52, v55
    v_mfma_f32_32x32x16_bf16 v[208:223], v[88:91], v[124:127], v[208:223]
    v_lshlrev_b32 v54, 16, v25
    v_and_b32 v55, s84, v25
    v_add_f32 v52, v52, v54
    v_add_f32 v52, v52, v55
    buffer_load_dwordx4 v18, s[20:23], s89 offen offset:2048 lds
    v_mfma_f32_32x32x16_bf16 v[224:239], v[92:95], v[120:123], v[224:239]
    v_lshlrev_b32 v54, 16, v26
    v_and_b32 v55, s84, v26
    v_add_f32 v52, v52, v54
    v_add_f32 v52, v52, v55
    buffer_load_dwordx4 v19, s[20:23], s89 offen offset:3072 lds
    s_add_u32 m0, s78, 4096
    v_mfma_f32_32x32x16_bf16 v[240:255], v[92:95], v[124:127], v[240:255]
    v_lshlrev_b32 v54, 16, v27
    v_and_b32 v55, s84, v27
    v_add_f32 v52, v52, v54
    v_add_f32 v52, v52, v55
    s_add_u32 s89, s85, 128
    buffer_load_dwordx4 v16, s[16:19], s89 offen offset:0 lds
    s_waitcnt lgkmcnt(0)
    v_mfma_f32_32x32x16_bf16 v[128:143], v[104:107], v[72:75], v[128:143]
    ds_read_b128 v[96:99], v46 offset:49152
    ds_read_b128 v[80:83], v38 offset:49152
    v_lshlrev_b32 v54, 16, v124
    v_and_b32 v55, s84, v124
    v_add_f32 v53, v53, v54
    v_add_f32 v53, v53, v55
    v_mfma_f32_32x32x16_bf16 v[144:159], v[104:107], v[76:79], v[144:159]
    ds_read_b128 v[100:103], v46 offset:57344
    ds_read_b128 v[84:87], v38 offset:51200
    v_lshlrev_b32 v54, 16, v125
    v_and_b32 v55, s84, v125
    v_add_f32 v53, v53, v54
    v_add_f32 v53, v53, v55
    v_mfma_f32_32x32x16_bf16 v[160:175], v[108:111], v[72:75], v[160:175]
    ds_read_b128 v[88:91], v38 offset:53248
    ds_read_b128 v[92:95], v38 offset:55296
    v_lshlrev_b32 v54, 16, v126
    v_and_b32 v55, s84, v126
    v_add_f32 v53, v53, v54
    v_add_f32 v53, v53, v55
    v_mfma_f32_32x32x16_bf16 v[176:191], v[108:111], v[76:79], v[176:191]
    v_lshlrev_b32 v54, 16, v127
    v_and_b32 v55, s84, v127
    v_add_f32 v53, v53, v54
    v_add_f32 v53, v53, v55
    v_mfma_f32_32x32x16_bf16 v[192:207], v[112:115], v[72:75], v[192:207]
    v_lshlrev_b32 v54, 16, v28
    v_and_b32 v55, s84, v28
    v_add_f32 v53, v53, v54
    v_add_f32 v53, v53, v55
    v_mfma_f32_32x32x16_bf16 v[208:223], v[112:115], v[76:79], v[208:223]
    v_lshlrev_b32 v54, 16, v29
    v_and_b32 v55, s84, v29
    v_add_f32 v53, v53, v54
    v_add_f32 v53, v53, v55
    buffer_load_dwordx4 v17, s[16:19], s89 offen offset:1024 lds
    v_mfma_f32_32x32x16_bf16 v[224:239], v[116:119], v[72:75], v[224:239]
    v_lshlrev_b32 v54, 16, v30
    v_and_b32 v55, s84, v30
    v_add_f32 v53, v53, v54
    v_add_f32 v53, v53, v55
    buffer_load_dwordx4 v18, s[16:19], s89 offen offset:2048 lds
    v_mfma_f32_32x32x16_bf16 v[240:255], v[116:119], v[76:79], v[240:255]
    v_lshlrev_b32 v54, 16, v31
    v_and_b32 v55, s84, v31
    v_add_f32 v53, v53, v54
    v_add_f32 v53, v53, v55
    buffer_load_dwordx4 v19, s[16:19], s89 offen offset:3072 lds
    s_waitcnt lgkmcnt(0)
    v_mfma_f32_32x32x16_bf16 v[128:143], v[80:83], v[96:99], v[128:143]
    ds_read_b128 v[120:123], v47 offset:49152
    ds_read_b128 v[104:107], v39 offset:49152
    v_mfma_f32_32x32x16_bf16 v[144:159], v[80:83], v[100:103], v[144:159]
    ds_read_b128 v[124:127], v47 offset:57344
    ds_read_b128 v[108:111], v39 offset:51200
    v_mfma_f32_32x32x16_bf16 v[160:175], v[84:87], v[96:99], v[160:175]
    ds_read_b128 v[112:115], v39 offset:53248
    ds_read_b128 v[116:119], v39 offset:55296
    s_waitcnt vmcnt(9)
    s_lshl_b32 s79, s64, 9
    s_add_u32 s79, s79, 148480
    v_mfma_f32_32x32x16_bf16 v[176:191], v[84:87], v[100:103], v[176:191]
    v_lshl_add_u32 v4, v1, 3, s79
    v_lshrrev_b32 v5, 5, v1
    v_mfma_f32_32x32x16_bf16 v[192:207], v[88:91], v[96:99], v[192:207]
    v_permlane32_swap_b32 v52, v53
    s_lshl_b32 s81, s64, 8
    s_add_u32 s81, s81, 147456
    v_add_f32 v52, v52, v53
    ds_write_b64 v4, v[2:3]
    s_add_u32 m0, s78, 8192
    v_mfma_f32_32x32x16_bf16 v[208:223], v[88:91], v[100:103], v[208:223]
    v_lshl_add_u32 v54, v1, 2, s81
    v_xor_b32 v55, 256, v54
    ds_write_b32 v54, v52
    v_lshl_add_u32 v4, v5, 8, s79
    s_add_u32 s89, s86, 128
    buffer_load_dwordx4 v16, s[16:19], s89 offen offset:0 lds
    v_mfma_f32_32x32x16_bf16 v[224:239], v[92:95], v[96:99], v[224:239]
    v_mov_b32 v57, v56
    v_mov_b32 v58, 0
    v_mov_b32 v59, 0
    buffer_load_dwordx4 v17, s[16:19], s89 offen offset:1024 lds
    v_mfma_f32_32x32x16_bf16 v[240:255], v[92:95], v[100:103], v[240:255]
    v_mov_b32 v61, v60
    v_mov_b32 v62, 0
    v_mov_b32 v63, 0
    buffer_load_dwordx4 v18, s[16:19], s89 offen offset:2048 lds
    s_waitcnt lgkmcnt(0)
    v_mfma_f32_32x32x16_bf16 v[128:143], v[104:107], v[120:123], v[128:143]
    s_barrier
    ds_read_b32 v53, v55
    v_cmp_gt_u32 vcc, 32, v1
    v_mfma_f32_32x32x16_bf16 v[144:159], v[104:107], v[124:127], v[144:159]
    v_mov_b32 v65, v64
    v_mov_b32 v66, 0
    v_mov_b32 v67, 0
    v_mov_b32 v69, v68
    v_mov_b32 v70, 0
    v_mfma_f32_32x32x16_bf16 v[160:175], v[108:111], v[120:123], v[160:175]
    v_mov_b32 v71, 0
    v_mfma_f32_32x32x16_bf16 v[176:191], v[108:111], v[124:127], v[176:191]
    s_waitcnt lgkmcnt(0)
    v_add_f32 v52, v52, v53
    v_mov_b32 v74, 0
    v_mfma_f32_32x32x16_bf16 v[192:207], v[112:115], v[120:123], v[192:207]
    v_cvt_pk_bf16_f32 v54, v52, v52
    v_mov_b32 v75, 0
    v_and_b32 v55, s84, v54
    v_mfma_f32_32x32x16_bf16 v[208:223], v[112:115], v[124:127], v[208:223]
    v_sub_f32 v55, v52, v55
    v_cndmask_b32 v72, 0, v54, vcc
    v_cvt_pk_bf16_f32 v55, v55, v55
    v_mfma_f32_32x32x16_bf16 v[224:239], v[116:119], v[120:123], v[224:239]
    v_cndmask_b32 v76, v54, 0, vcc
    v_mov_b32 v78, 0
    v_mov_b32 v79, 0
    v_mfma_f32_32x32x16_bf16 v[240:255], v[116:119], v[124:127], v[240:255]
    v_cndmask_b32 v73, 0, v55, vcc
    v_cndmask_b32 v77, v55, 0, vcc
    s_nop 0
    v_mfma_f32_32x32x16_bf16 v[128:143], v[56:59], v[72:75], v[128:143]
    v_and_b32 v98, 31, v1
    v_lshrrev_b32 v99, 5, v1
    v_bfe_u32 v100, v1, 1, 3
    v_xor_b32 v100, v100, v99
    v_lshlrev_b32 v98, 7, v98
    v_mfma_f32_32x32x16_bf16 v[144:159], v[56:59], v[76:79], v[144:159]
    v_add_u32 v98, s77, v98
    v_xor_b32 v101, 0, v100
    v_lshl_add_u32 v24, v101, 4, v98
    v_xor_b32 v101, 2, v100
    v_mfma_f32_32x32x16_bf16 v[160:175], v[60:63], v[72:75], v[160:175]
    v_lshl_add_u32 v25, v101, 4, v98
    v_xor_b32 v101, 4, v100
    v_lshl_add_u32 v26, v101, 4, v98
    v_xor_b32 v101, 6, v100
    v_mfma_f32_32x32x16_bf16 v[176:191], v[60:63], v[76:79], v[176:191]
    v_lshl_add_u32 v27, v101, 4, v98
    v_bfe_u32 v98, v1, 2, 2
    v_lshl_add_u32 v98, v99, 2, v98
    v_lshlrev_b32 v98, 7, v98
    v_mfma_f32_32x32x16_bf16 v[192:207], v[64:67], v[72:75], v[192:207]
    v_add_u32 v98, s78, v98
    v_bfe_u32 v100, v1, 4, 1
    v_lshl_add_u32 v98, v100, 5, v98
    v_and_b32 v100, 3, v1
    v_lshl_add_u32 v98, v100, 3, v98
    v_mfma_f32_32x32x16_bf16 v[208:223], v[64:67], v[76:79], v[208:223]
    v_bfe_u32 v100, v1, 3, 1
    v_xor_b32 v100, s70, v100
    v_lshl_add_u32 v28, v100, 6, v98
    v_xor_b32 v29, 64, v28
    v_mfma_f32_32x32x16_bf16 v[224:239], v[68:71], v[72:75], v[224:239]
    v_add_u32 v30, 98304, v28
    v_add_u32 v31, 98304, v29
    ds_read_b128 v[32:35], v4 offset:0
    ds_read_b128 v[36:39], v4 offset:16
    v_mfma_f32_32x32x16_bf16 v[240:255], v[68:71], v[76:79], v[240:255]
    ds_read_b128 v[40:43], v4 offset:32
    ds_read_b128 v[44:47], v4 offset:48
    ds_read_b128 v[48:51], v4 offset:64
    ds_read_b128 v[52:55], v4 offset:80
    ds_read_b128 v[56:59], v4 offset:96
    ds_read_b128 v[60:63], v4 offset:112
    ds_read_b128 v[64:67], v4 offset:128
    ds_read_b128 v[68:71], v4 offset:144
    ds_read_b128 v[72:75], v4 offset:160
    ds_read_b128 v[76:79], v4 offset:176
    ds_read_b128 v[80:83], v4 offset:192
    ds_read_b128 v[84:87], v4 offset:208
    ds_read_b128 v[88:91], v4 offset:224
    ds_read_b128 v[92:95], v4 offset:240
    v_pk_mul_f32 v[96:97], v[128:129], v[10:11] op_sel:[0,0] op_sel_hi:[0,1]
    s_waitcnt vmcnt(11)
    v_pk_mul_f32 v[98:99], v[128:129], v[10:11] op_sel:[1,0] op_sel_hi:[1,1]
    v_pk_mul_f32 v[100:101], v[130:131], v[10:11] op_sel:[0,0] op_sel_hi:[0,1]
    v_pk_mul_f32 v[102:103], v[130:131], v[10:11] op_sel:[1,0] op_sel_hi:[1,1]
    ds_read_b128 a[0:3], v24 offset:0
    ds_read_b128 a[8:11], v25 offset:0
    v_pk_mul_f32 v[104:105], v[132:133], v[10:11] op_sel:[0,0] op_sel_hi:[0,1]
    v_pk_mul_f32 v[106:107], v[132:133], v[10:11] op_sel:[1,0] op_sel_hi:[1,1]
    v_pk_mul_f32 v[108:109], v[134:135], v[10:11] op_sel:[0,0] op_sel_hi:[0,1]
    v_pk_mul_f32 v[110:111], v[134:135], v[10:11] op_sel:[1,0] op_sel_hi:[1,1]
    ds_read_b128 a[32:35], v26 offset:0
    ds_read_b128 a[40:43], v27 offset:0
    v_pk_mul_f32 v[112:113], v[136:137], v[10:11] op_sel:[0,0] op_sel_hi:[0,1]
    v_pk_mul_f32 v[114:115], v[136:137], v[10:11] op_sel:[1,0] op_sel_hi:[1,1]
    v_pk_mul_f32 v[116:117], v[138:139], v[10:11] op_sel:[0,0] op_sel_hi:[0,1]
    v_pk_mul_f32 v[118:119], v[138:139], v[10:11] op_sel:[1,0] op_sel_hi:[1,1]
    ds_read_b128 a[4:7], v24 offset:4096
    ds_read_b128 a[12:15], v25 offset:4096
    v_pk_mul_f32 v[120:121], v[140:141], v[10:11] op_sel:[0,0] op_sel_hi:[0,1]
    v_pk_mul_f32 v[122:123], v[140:141], v[10:11] op_sel:[1,0] op_sel_hi:[1,1]
    v_pk_mul_f32 v[124:125], v[142:143], v[10:11] op_sel:[0,0] op_sel_hi:[0,1]
    v_pk_mul_f32 v[126:127], v[142:143], v[10:11] op_sel:[1,0] op_sel_hi:[1,1]
    ds_read_b128 a[36:39], v26 offset:4096
    ds_read_b128 a[44:47], v27 offset:4096
    v_pk_fma_f32 v[96:97], v[144:145], v[10:11], v[96:97] op_sel:[0,1,0] op_sel_hi:[0,0,1] neg_lo:[0,1,0]
    v_pk_fma_f32 v[98:99], v[144:145], v[10:11], v[98:99] op_sel:[1,1,0] op_sel_hi:[1,0,1] neg_lo:[0,1,0]
    v_pk_fma_f32 v[100:101], v[146:147], v[10:11], v[100:101] op_sel:[0,1,0] op_sel_hi:[0,0,1] neg_lo:[0,1,0]
    ds_read_b128 a[16:19], v24 offset:8192
    ds_read_b128 a[24:27], v25 offset:8192
    v_pk_fma_f32 v[102:103], v[146:147], v[10:11], v[102:103] op_sel:[1,1,0] op_sel_hi:[1,0,1] neg_lo:[0,1,0]
    buffer_load_dwordx4 v19, s[16:19], s89 offen offset:3072 lds
    v_pk_fma_f32 v[104:105], v[148:149], v[10:11], v[104:105] op_sel:[0,1,0] op_sel_hi:[0,0,1] neg_lo:[0,1,0]
    v_pk_fma_f32 v[106:107], v[148:149], v[10:11], v[106:107] op_sel:[1,1,0] op_sel_hi:[1,0,1] neg_lo:[0,1,0]
    v_pk_fma_f32 v[108:109], v[150:151], v[10:11], v[108:109] op_sel:[0,1,0] op_sel_hi:[0,0,1] neg_lo:[0,1,0]
    ds_read_b128 a[48:51], v26 offset:8192
    ds_read_b128 a[56:59], v27 offset:8192
    v_pk_fma_f32 v[110:111], v[150:151], v[10:11], v[110:111] op_sel:[1,1,0] op_sel_hi:[1,0,1] neg_lo:[0,1,0]
    v_pk_fma_f32 v[112:113], v[152:153], v[10:11], v[112:113] op_sel:[0,1,0] op_sel_hi:[0,0,1] neg_lo:[0,1,0]
    v_pk_fma_f32 v[114:115], v[152:153], v[10:11], v[114:115] op_sel:[1,1,0] op_sel_hi:[1,0,1] neg_lo:[0,1,0]
    v_pk_fma_f32 v[116:117], v[154:155], v[10:11], v[116:117] op_sel:[0,1,0] op_sel_hi:[0,0,1] neg_lo:[0,1,0]
    v_subrev_u32 v24, 98304, v24
    v_subrev_u32 v25, 98304, v25
    v_subrev_u32 v26, 98304, v26
    v_subrev_u32 v27, 98304, v27
    v_pk_fma_f32 v[118:119], v[154:155], v[10:11], v[118:119] op_sel:[1,1,0] op_sel_hi:[1,0,1] neg_lo:[0,1,0]
    v_pk_fma_f32 v[120:121], v[156:157], v[10:11], v[120:121] op_sel:[0,1,0] op_sel_hi:[0,0,1] neg_lo:[0,1,0]
    v_pk_fma_f32 v[122:123], v[156:157], v[10:11], v[122:123] op_sel:[1,1,0] op_sel_hi:[1,0,1] neg_lo:[0,1,0]
    v_pk_fma_f32 v[124:125], v[158:159], v[10:11], v[124:125] op_sel:[0,1,0] op_sel_hi:[0,0,1] neg_lo:[0,1,0]
    v_pk_fma_f32 v[126:127], v[158:159], v[10:11], v[126:127] op_sel:[1,1,0] op_sel_hi:[1,0,1] neg_lo:[0,1,0]
    v_pk_mul_f32 v[128:129], v[160:161], v[10:11] op_sel:[0,0] op_sel_hi:[0,1]
    v_pk_mul_f32 v[130:131], v[160:161], v[10:11] op_sel:[1,0] op_sel_hi:[1,1]
    v_pk_mul_f32 v[132:133], v[162:163], v[10:11] op_sel:[0,0] op_sel_hi:[0,1]
    v_pk_mul_f32 v[134:135], v[162:163], v[10:11] op_sel:[1,0] op_sel_hi:[1,1]
    v_pk_mul_f32 v[136:137], v[164:165], v[10:11] op_sel:[0,0] op_sel_hi:[0,1]
    v_pk_mul_f32 v[138:139], v[164:165], v[10:11] op_sel:[1,0] op_sel_hi:[1,1]
    v_pk_mul_f32 v[140:141], v[166:167], v[10:11] op_sel:[0,0] op_sel_hi:[0,1]
    s_add_u32 m0, s78, 49152
    s_add_u32 s89, s85, 128
    buffer_load_dwordx4 v16, s[20:23], s89 offen offset:0 lds
    v_pk_mul_f32 v[142:143], v[166:167], v[10:11] op_sel:[1,0] op_sel_hi:[1,1]
    v_pk_mul_f32 v[144:145], v[168:169], v[10:11] op_sel:[0,0] op_sel_hi:[0,1]
    v_pk_mul_f32 v[146:147], v[168:169], v[10:11] op_sel:[1,0] op_sel_hi:[1,1]
    v_pk_mul_f32 v[148:149], v[170:171], v[10:11] op_sel:[0,0] op_sel_hi:[0,1]
    v_pk_mul_f32 v[150:151], v[170:171], v[10:11] op_sel:[1,0] op_sel_hi:[1,1]
    v_pk_mul_f32 v[152:153], v[172:173], v[10:11] op_sel:[0,0] op_sel_hi:[0,1]
    v_pk_mul_f32 v[154:155], v[172:173], v[10:11] op_sel:[1,0] op_sel_hi:[1,1]
    v_pk_mul_f32 v[156:157], v[174:175], v[10:11] op_sel:[0,0] op_sel_hi:[0,1]
    v_pk_mul_f32 v[158:159], v[174:175], v[10:11] op_sel:[1,0] op_sel_hi:[1,1]
    v_pk_fma_f32 v[128:129], v[176:177], v[10:11], v[128:129] op_sel:[0,1,0] op_sel_hi:[0,0,1] neg_lo:[0,1,0]
    v_pk_fma_f32 v[130:131], v[176:177], v[10:11], v[130:131] op_sel:[1,1,0] op_sel_hi:[1,0,1] neg_lo:[0,1,0]
    v_pk_fma_f32 v[132:133], v[178:179], v[10:11], v[132:133] op_sel:[0,1,0] op_sel_hi:[0,0,1] neg_lo:[0,1,0]
    v_pk_fma_f32 v[134:135], v[178:179], v[10:11], v[134:135] op_sel:[1,1,0] op_sel_hi:[1,0,1] neg_lo:[0,1,0]
    v_pk_fma_f32 v[136:137], v[180:181], v[10:11], v[136:137] op_sel:[0,1,0] op_sel_hi:[0,0,1] neg_lo:[0,1,0]
    v_pk_fma_f32 v[138:139], v[180:181], v[10:11], v[138:139] op_sel:[1,1,0] op_sel_hi:[1,0,1] neg_lo:[0,1,0]
    v_pk_fma_f32 v[140:141], v[182:183], v[10:11], v[140:141] op_sel:[0,1,0] op_sel_hi:[0,0,1] neg_lo:[0,1,0]
    v_pk_fma_f32 v[142:143], v[182:183], v[10:11], v[142:143] op_sel:[1,1,0] op_sel_hi:[1,0,1] neg_lo:[0,1,0]
    v_pk_fma_f32 v[144:145], v[184:185], v[10:11], v[144:145] op_sel:[0,1,0] op_sel_hi:[0,0,1] neg_lo:[0,1,0]
    v_pk_fma_f32 v[146:147], v[184:185], v[10:11], v[146:147] op_sel:[1,1,0] op_sel_hi:[1,0,1] neg_lo:[0,1,0]
    v_pk_fma_f32 v[148:149], v[186:187], v[10:11], v[148:149] op_sel:[0,1,0] op_sel_hi:[0,0,1] neg_lo:[0,1,0]
    v_pk_fma_f32 v[150:151], v[186:187], v[10:11], v[150:151] op_sel:[1,1,0] op_sel_hi:[1,0,1] neg_lo:[0,1,0]
    v_pk_fma_f32 v[152:153], v[188:189], v[10:11], v[152:153] op_sel:[0,1,0] op_sel_hi:[0,0,1] neg_lo:[0,1,0]
    v_pk_fma_f32 v[154:155], v[188:189], v[10:11], v[154:155] op_sel:[1,1,0] op_sel_hi:[1,0,1] neg_lo:[0,1,0]
    v_pk_fma_f32 v[156:157], v[190:191], v[10:11], v[156:157] op_sel:[0,1,0] op_sel_hi:[0,0,1] neg_lo:[0,1,0]
    v_pk_fma_f32 v[158:159], v[190:191], v[10:11], v[158:159] op_sel:[1,1,0] op_sel_hi:[1,0,1] neg_lo:[0,1,0]
    v_pk_mul_f32 v[160:161], v[192:193], v[10:11] op_sel:[0,0] op_sel_hi:[0,1]
    buffer_load_dwordx4 v17, s[20:23], s89 offen offset:1024 lds
    v_pk_mul_f32 v[162:163], v[192:193], v[10:11] op_sel:[1,0] op_sel_hi:[1,1]
    v_pk_mul_f32 v[164:165], v[194:195], v[10:11] op_sel:[0,0] op_sel_hi:[0,1]
    v_pk_mul_f32 v[166:167], v[194:195], v[10:11] op_sel:[1,0] op_sel_hi:[1,1]
    v_pk_mul_f32 v[168:169], v[196:197], v[10:11] op_sel:[0,0] op_sel_hi:[0,1]
    v_pk_mul_f32 v[170:171], v[196:197], v[10:11] op_sel:[1,0] op_sel_hi:[1,1]
    v_pk_mul_f32 v[172:173], v[198:199], v[10:11] op_sel:[0,0] op_sel_hi:[0,1]
    v_pk_mul_f32 v[174:175], v[198:199], v[10:11] op_sel:[1,0] op_sel_hi:[1,1]
    v_pk_mul_f32 v[176:177], v[200:201], v[10:11] op_sel:[0,0] op_sel_hi:[0,1]
    v_pk_mul_f32 v[178:179], v[200:201], v[10:11] op_sel:[1,0] op_sel_hi:[1,1]
    v_pk_mul_f32 v[180:181], v[202:203], v[10:11] op_sel:[0,0] op_sel_hi:[0,1]
    v_pk_mul_f32 v[182:183], v[202:203], v[10:11] op_sel:[1,0] op_sel_hi:[1,1]
    v_pk_mul_f32 v[184:185], v[204:205], v[10:11] op_sel:[0,0] op_sel_hi:[0,1]
    v_pk_mul_f32 v[186:187], v[204:205], v[10:11] op_sel:[1,0] op_sel_hi:[1,1]
    v_pk_mul_f32 v[188:189], v[206:207], v[10:11] op_sel:[0,0] op_sel_hi:[0,1]
    v_pk_mul_f32 v[190:191], v[206:207], v[10:11] op_sel:[1,0] op_sel_hi:[1,1]
    v_pk_fma_f32 v[160:161], v[208:209], v[10:11], v[160:161] op_sel:[0,1,0] op_sel_hi:[0,0,1] neg_lo:[0,1,0]
    v_pk_fma_f32 v[162:163], v[208:209], v[10:11], v[162:163] op_sel:[1,1,0] op_sel_hi:[1,0,1] neg_lo:[0,1,0]
    v_pk_fma_f32 v[164:165], v[210:211], v[10:11], v[164:165] op_sel:[0,1,0] op_sel_hi:[0,0,1] neg_lo:[0,1,0]
    v_pk_fma_f32 v[166:167], v[210:211], v[10:11], v[166:167] op_sel:[1,1,0] op_sel_hi:[1,0,1] neg_lo:[0,1,0]
    v_pk_fma_f32 v[168:169], v[212:213], v[10:11], v[168:169] op_sel:[0,1,0] op_sel_hi:[0,0,1] neg_lo:[0,1,0]
    v_pk_fma_f32 v[170:171], v[212:213], v[10:11], v[170:171] op_sel:[1,1,0] op_sel_hi:[1,0,1] neg_lo:[0,1,0]
    v_pk_fma_f32 v[172:173], v[214:215], v[10:11], v[172:173] op_sel:[0,1,0] op_sel_hi:[0,0,1] neg_lo:[0,1,0]
    v_pk_fma_f32 v[174:175], v[214:215], v[10:11], v[174:175] op_sel:[1,1,0] op_sel_hi:[1,0,1] neg_lo:[0,1,0]
    v_pk_fma_f32 v[176:177], v[216:217], v[10:11], v[176:177] op_sel:[0,1,0] op_sel_hi:[0,0,1] neg_lo:[0,1,0]
    v_pk_fma_f32 v[178:179], v[216:217], v[10:11], v[178:179] op_sel:[1,1,0] op_sel_hi:[1,0,1] neg_lo:[0,1,0]
    buffer_load_dwordx4 v18, s[20:23], s89 offen offset:2048 lds
    v_pk_fma_f32 v[180:181], v[218:219], v[10:11], v[180:181] op_sel:[0,1,0] op_sel_hi:[0,0,1] neg_lo:[0,1,0]
    v_pk_fma_f32 v[182:183], v[218:219], v[10:11], v[182:183] op_sel:[1,1,0] op_sel_hi:[1,0,1] neg_lo:[0,1,0]
    v_pk_fma_f32 v[184:185], v[220:221], v[10:11], v[184:185] op_sel:[0,1,0] op_sel_hi:[0,0,1] neg_lo:[0,1,0]
    v_pk_fma_f32 v[186:187], v[220:221], v[10:11], v[186:187] op_sel:[1,1,0] op_sel_hi:[1,0,1] neg_lo:[0,1,0]
    v_pk_fma_f32 v[188:189], v[222:223], v[10:11], v[188:189] op_sel:[0,1,0] op_sel_hi:[0,0,1] neg_lo:[0,1,0]
    v_pk_fma_f32 v[190:191], v[222:223], v[10:11], v[190:191] op_sel:[1,1,0] op_sel_hi:[1,0,1] neg_lo:[0,1,0]
    v_pk_mul_f32 v[192:193], v[224:225], v[10:11] op_sel:[0,0] op_sel_hi:[0,1]
    v_pk_mul_f32 v[194:195], v[224:225], v[10:11] op_sel:[1,0] op_sel_hi:[1,1]
    v_pk_mul_f32 v[196:197], v[226:227], v[10:11] op_sel:[0,0] op_sel_hi:[0,1]
    v_pk_mul_f32 v[198:199], v[226:227], v[10:11] op_sel:[1,0] op_sel_hi:[1,1]
    v_pk_mul_f32 v[200:201], v[228:229], v[10:11] op_sel:[0,0] op_sel_hi:[0,1]
    v_pk_mul_f32 v[202:203], v[228:229], v[10:11] op_sel:[1,0] op_sel_hi:[1,1]
    v_pk_mul_f32 v[204:205], v[230:231], v[10:11] op_sel:[0,0] op_sel_hi:[0,1]
    v_pk_mul_f32 v[206:207], v[230:231], v[10:11] op_sel:[1,0] op_sel_hi:[1,1]
    v_pk_mul_f32 v[208:209], v[232:233], v[10:11] op_sel:[0,0] op_sel_hi:[0,1]
    v_pk_mul_f32 v[210:211], v[232:233], v[10:11] op_sel:[1,0] op_sel_hi:[1,1]
    v_pk_mul_f32 v[212:213], v[234:235], v[10:11] op_sel:[0,0] op_sel_hi:[0,1]
    v_pk_mul_f32 v[214:215], v[234:235], v[10:11] op_sel:[1,0] op_sel_hi:[1,1]
    v_pk_mul_f32 v[216:217], v[236:237], v[10:11] op_sel:[0,0] op_sel_hi:[0,1]
    v_pk_mul_f32 v[218:219], v[236:237], v[10:11] op_sel:[1,0] op_sel_hi:[1,1]
    v_pk_mul_f32 v[220:221], v[238:239], v[10:11] op_sel:[0,0] op_sel_hi:[0,1]
    v_pk_mul_f32 v[222:223], v[238:239], v[10:11] op_sel:[1,0] op_sel_hi:[1,1]
    v_pk_fma_f32 v[192:193], v[240:241], v[10:11], v[192:193] op_sel:[0,1,0] op_sel_hi:[0,0,1] neg_lo:[0,1,0]
    v_pk_fma_f32 v[194:195], v[240:241], v[10:11], v[194:195] op_sel:[1,1,0] op_sel_hi:[1,0,1] neg_lo:[0,1,0]
    v_pk_fma_f32 v[196:197], v[242:243], v[10:11], v[196:197] op_sel:[0,1,0] op_sel_hi:[0,0,1] neg_lo:[0,1,0]
    v_pk_fma_f32 v[198:199], v[242:243], v[10:11], v[198:199] op_sel:[1,1,0] op_sel_hi:[1,0,1] neg_lo:[0,1,0]
    buffer_load_dwordx4 v19, s[20:23], s89 offen offset:3072 lds
    v_pk_fma_f32 v[200:201], v[244:245], v[10:11], v[200:201] op_sel:[0,1,0] op_sel_hi:[0,0,1] neg_lo:[0,1,0]
    v_pk_fma_f32 v[202:203], v[244:245], v[10:11], v[202:203] op_sel:[1,1,0] op_sel_hi:[1,0,1] neg_lo:[0,1,0]
    v_pk_fma_f32 v[204:205], v[246:247], v[10:11], v[204:205] op_sel:[0,1,0] op_sel_hi:[0,0,1] neg_lo:[0,1,0]
    v_pk_fma_f32 v[206:207], v[246:247], v[10:11], v[206:207] op_sel:[1,1,0] op_sel_hi:[1,0,1] neg_lo:[0,1,0]
    v_pk_fma_f32 v[208:209], v[248:249], v[10:11], v[208:209] op_sel:[0,1,0] op_sel_hi:[0,0,1] neg_lo:[0,1,0]
    v_pk_fma_f32 v[210:211], v[248:249], v[10:11], v[210:211] op_sel:[1,1,0] op_sel_hi:[1,0,1] neg_lo:[0,1,0]
    v_pk_fma_f32 v[212:213], v[250:251], v[10:11], v[212:213] op_sel:[0,1,0] op_sel_hi:[0,0,1] neg_lo:[0,1,0]
    v_pk_fma_f32 v[214:215], v[250:251], v[10:11], v[214:215] op_sel:[1,1,0] op_sel_hi:[1,0,1] neg_lo:[0,1,0]
    v_pk_fma_f32 v[216:217], v[252:253], v[10:11], v[216:217] op_sel:[0,1,0] op_sel_hi:[0,0,1] neg_lo:[0,1,0]
    v_pk_fma_f32 v[218:219], v[252:253], v[10:11], v[218:219] op_sel:[1,1,0] op_sel_hi:[1,0,1] neg_lo:[0,1,0]
    v_pk_fma_f32 v[220:221], v[254:255], v[10:11], v[220:221] op_sel:[0,1,0] op_sel_hi:[0,0,1] neg_lo:[0,1,0]
    v_pk_fma_f32 v[222:223], v[254:255], v[10:11], v[222:223] op_sel:[1,1,0] op_sel_hi:[1,0,1] neg_lo:[0,1,0]
    s_waitcnt lgkmcnt(0)
    v_pk_mul_f32 v[96:97], v[96:97], v[32:33] op_sel:[0,0] op_sel_hi:[1,0]
    v_pk_mul_f32 v[98:99], v[98:99], v[32:33] op_sel:[0,1] op_sel_hi:[1,1]
    v_pk_fma_f32 v[2:3], v[96:97], v[8:9], v[98:99] op_sel:[1,1,0] op_sel_hi:[0,1,1] neg_lo:[0,1,0]
    v_pk_fma_f32 v[4:5], v[96:97], v[8:9], v[2:3] op_sel:[0,0,0] op_sel_hi:[1,0,1]
    v_pk_mul_f32 v[100:101], v[100:101], v[34:35] op_sel:[0,0] op_sel_hi:[1,0]
    v_pk_fma_f32 v[2:3], v[4:5], v[8:9], v[100:101] op_sel:[1,1,0] op_sel_hi:[0,1,1] neg_lo:[0,1,0]
    v_pk_fma_f32 v[4:5], v[4:5], v[8:9], v[2:3] op_sel:[0,0,0] op_sel_hi:[1,0,1]
    v_pk_mul_f32 v[102:103], v[102:103], v[34:35] op_sel:[0,1] op_sel_hi:[1,1]
    v_pk_fma_f32 v[2:3], v[4:5], v[8:9], v[102:103] op_sel:[1,1,0] op_sel_hi:[0,1,1] neg_lo:[0,1,0]
    v_pk_fma_f32 v[4:5], v[4:5], v[8:9], v[2:3] op_sel:[0,0,0] op_sel_hi:[1,0,1]
    v_pk_mul_f32 v[104:105], v[104:105], v[36:37] op_sel:[0,0] op_sel_hi:[1,0]
    v_pk_fma_f32 v[2:3], v[4:5], v[8:9], v[104:105] op_sel:[1,1,0] op_sel_hi:[0,1,1] neg_lo:[0,1,0]
    s_add_u32 m0, s78, 53248
    s_add_u32 s89, s86, 128
    buffer_load_dwordx4 v16, s[20:23], s89 offen offset:0 lds
    v_pk_fma_f32 v[4:5], v[4:5], v[8:9], v[2:3] op_sel:[0,0,0] op_sel_hi:[1,0,1]
    v_pk_mul_f32 v[106:107], v[106:107], v[36:37] op_sel:[0,1] op_sel_hi:[1,1]
    v_pk_fma_f32 v[2:3], v[4:5], v[8:9], v[106:107] op_sel:[1,1,0] op_sel_hi:[0,1,1] neg_lo:[0,1,0]
    v_pk_fma_f32 v[4:5], v[4:5], v[8:9], v[2:3] op_sel:[0,0,0] op_sel_hi:[1,0,1]
    v_pk_mul_f32 v[108:109], v[108:109], v[38:39] op_sel:[0,0] op_sel_hi:[1,0]
    v_pk_fma_f32 v[2:3], v[4:5], v[8:9], v[108:109] op_sel:[1,1,0] op_sel_hi:[0,1,1] neg_lo:[0,1,0]
    v_pk_fma_f32 v[4:5], v[4:5], v[8:9], v[2:3] op_sel:[0,0,0] op_sel_hi:[1,0,1]
    v_pk_mul_f32 v[110:111], v[110:111], v[38:39] op_sel:[0,1] op_sel_hi:[1,1]
    v_pk_fma_f32 v[2:3], v[4:5], v[8:9], v[110:111] op_sel:[1,1,0] op_sel_hi:[0,1,1] neg_lo:[0,1,0]
    v_pk_fma_f32 v[4:5], v[4:5], v[8:9], v[2:3] op_sel:[0,0,0] op_sel_hi:[1,0,1]
    v_pk_mul_f32 v[112:113], v[112:113], v[40:41] op_sel:[0,0] op_sel_hi:[1,0]
    v_pk_fma_f32 v[2:3], v[4:5], v[8:9], v[112:113] op_sel:[1,1,0] op_sel_hi:[0,1,1] neg_lo:[0,1,0]
    v_pk_fma_f32 v[4:5], v[4:5], v[8:9], v[2:3] op_sel:[0,0,0] op_sel_hi:[1,0,1]
    v_pk_mul_f32 v[114:115], v[114:115], v[40:41] op_sel:[0,1] op_sel_hi:[1,1]
    v_pk_fma_f32 v[2:3], v[4:5], v[8:9], v[114:115] op_sel:[1,1,0] op_sel_hi:[0,1,1] neg_lo:[0,1,0]
    v_pk_fma_f32 v[4:5], v[4:5], v[8:9], v[2:3] op_sel:[0,0,0] op_sel_hi:[1,0,1]
    v_pk_mul_f32 v[116:117], v[116:117], v[42:43] op_sel:[0,0] op_sel_hi:[1,0]
    v_pk_fma_f32 v[2:3], v[4:5], v[8:9], v[116:117] op_sel:[1,1,0] op_sel_hi:[0,1,1] neg_lo:[0,1,0]
    v_pk_fma_f32 v[4:5], v[4:5], v[8:9], v[2:3] op_sel:[0,0,0] op_sel_hi:[1,0,1]
    v_pk_mul_f32 v[118:119], v[118:119], v[42:43] op_sel:[0,1] op_sel_hi:[1,1]
    v_pk_fma_f32 v[2:3], v[4:5], v[8:9], v[118:119] op_sel:[1,1,0] op_sel_hi:[0,1,1] neg_lo:[0,1,0]
    v_pk_fma_f32 v[4:5], v[4:5], v[8:9], v[2:3] op_sel:[0,0,0] op_sel_hi:[1,0,1]
    v_pk_mul_f32 v[120:121], v[120:121], v[44:45] op_sel:[0,0] op_sel_hi:[1,0]
    v_pk_fma_f32 v[2:3], v[4:5], v[8:9], v[120:121] op_sel:[1,1,0] op_sel_hi:[0,1,1] neg_lo:[0,1,0]
    v_pk_fma_f32 v[4:5], v[4:5], v[8:9], v[2:3] op_sel:[0,0,0] op_sel_hi:[1,0,1]
    v_pk_mul_f32 v[122:123], v[122:123], v[44:45] op_sel:[0,1] op_sel_hi:[1,1]
    buffer_load_dwordx4 v17, s[20:23], s89 offen offset:1024 lds
    v_pk_fma_f32 v[2:3], v[4:5], v[8:9], v[122:123] op_sel:[1,1,0] op_sel_hi:[0,1,1] neg_lo:[0,1,0]
    v_pk_fma_f32 v[4:5], v[4:5], v[8:9], v[2:3] op_sel:[0,0,0] op_sel_hi:[1,0,1]
    v_pk_mul_f32 v[124:125], v[124:125], v[46:47] op_sel:[0,0] op_sel_hi:[1,0]
    v_pk_fma_f32 v[2:3], v[4:5], v[8:9], v[124:125] op_sel:[1,1,0] op_sel_hi:[0,1,1] neg_lo:[0,1,0]
    v_pk_fma_f32 v[4:5], v[4:5], v[8:9], v[2:3] op_sel:[0,0,0] op_sel_hi:[1,0,1]
    v_pk_mul_f32 v[126:127], v[126:127], v[46:47] op_sel:[0,1] op_sel_hi:[1,1]
    v_pk_fma_f32 v[2:3], v[4:5], v[8:9], v[126:127] op_sel:[1,1,0] op_sel_hi:[0,1,1] neg_lo:[0,1,0]
    v_pk_fma_f32 v[4:5], v[4:5], v[8:9], v[2:3] op_sel:[0,0,0] op_sel_hi:[1,0,1]
    v_pk_mul_f32 v[128:129], v[128:129], v[48:49] op_sel:[0,0] op_sel_hi:[1,0]
    v_pk_fma_f32 v[2:3], v[4:5], v[8:9], v[128:129] op_sel:[1,1,0] op_sel_hi:[0,1,1] neg_lo:[0,1,0]
    v_pk_fma_f32 v[4:5], v[4:5], v[8:9], v[2:3] op_sel:[0,0,0] op_sel_hi:[1,0,1]
    v_pk_mul_f32 v[130:131], v[130:131], v[48:49] op_sel:[0,1] op_sel_hi:[1,1]
    v_pk_fma_f32 v[2:3], v[4:5], v[8:9], v[130:131] op_sel:[1,1,0] op_sel_hi:[0,1,1] neg_lo:[0,1,0]
    v_pk_fma_f32 v[4:5], v[4:5], v[8:9], v[2:3] op_sel:[0,0,0] op_sel_hi:[1,0,1]
    v_pk_mul_f32 v[132:133], v[132:133], v[50:51] op_sel:[0,0] op_sel_hi:[1,0]
    v_pk_fma_f32 v[2:3], v[4:5], v[8:9], v[132:133] op_sel:[1,1,0] op_sel_hi:[0,1,1] neg_lo:[0,1,0]
    v_pk_fma_f32 v[4:5], v[4:5], v[8:9], v[2:3] op_sel:[0,0,0] op_sel_hi:[1,0,1]
    v_pk_mul_f32 v[134:135], v[134:135], v[50:51] op_sel:[0,1] op_sel_hi:[1,1]
    v_pk_fma_f32 v[2:3], v[4:5], v[8:9], v[134:135] op_sel:[1,1,0] op_sel_hi:[0,1,1] neg_lo:[0,1,0]
    v_pk_fma_f32 v[4:5], v[4:5], v[8:9], v[2:3] op_sel:[0,0,0] op_sel_hi:[1,0,1]
    v_pk_mul_f32 v[136:137], v[136:137], v[52:53] op_sel:[0,0] op_sel_hi:[1,0]
    v_pk_fma_f32 v[2:3], v[4:5], v[8:9], v[136:137] op_sel:[1,1,0] op_sel_hi:[0,1,1] neg_lo:[0,1,0]
    v_pk_fma_f32 v[4:5], v[4:5], v[8:9], v[2:3] op_sel:[0,0,0] op_sel_hi:[1,0,1]
    v_pk_mul_f32 v[138:139], v[138:139], v[52:53] op_sel:[0,1] op_sel_hi:[1,1]
    v_pk_fma_f32 v[2:3], v[4:5], v[8:9], v[138:139] op_sel:[1,1,0] op_sel_hi:[0,1,1] neg_lo:[0,1,0]
    buffer_load_dwordx4 v18, s[20:23], s89 offen offset:2048 lds
    v_pk_fma_f32 v[4:5], v[4:5], v[8:9], v[2:3] op_sel:[0,0,0] op_sel_hi:[1,0,1]
    v_pk_mul_f32 v[140:141], v[140:141], v[54:55] op_sel:[0,0] op_sel_hi:[1,0]
    v_pk_fma_f32 v[2:3], v[4:5], v[8:9], v[140:141] op_sel:[1,1,0] op_sel_hi:[0,1,1] neg_lo:[0,1,0]
    v_pk_fma_f32 v[4:5], v[4:5], v[8:9], v[2:3] op_sel:[0,0,0] op_sel_hi:[1,0,1]
    v_pk_mul_f32 v[142:143], v[142:143], v[54:55] op_sel:[0,1] op_sel_hi:[1,1]
    v_pk_fma_f32 v[2:3], v[4:5], v[8:9], v[142:143] op_sel:[1,1,0] op_sel_hi:[0,1,1] neg_lo:[0,1,0]
    v_pk_fma_f32 v[4:5], v[4:5], v[8:9], v[2:3] op_sel:[0,0,0] op_sel_hi:[1,0,1]
    v_pk_mul_f32 v[144:145], v[144:145], v[56:57] op_sel:[0,0] op_sel_hi:[1,0]
    v_pk_fma_f32 v[2:3], v[4:5], v[8:9], v[144:145] op_sel:[1,1,0] op_sel_hi:[0,1,1] neg_lo:[0,1,0]
    v_pk_fma_f32 v[4:5], v[4:5], v[8:9], v[2:3] op_sel:[0,0,0] op_sel_hi:[1,0,1]
    v_pk_mul_f32 v[146:147], v[146:147], v[56:57] op_sel:[0,1] op_sel_hi:[1,1]
    v_pk_fma_f32 v[2:3], v[4:5], v[8:9], v[146:147] op_sel:[1,1,0] op_sel_hi:[0,1,1] neg_lo:[0,1,0]
    v_pk_fma_f32 v[4:5], v[4:5], v[8:9], v[2:3] op_sel:[0,0,0] op_sel_hi:[1,0,1]
    v_pk_mul_f32 v[148:149], v[148:149], v[58:59] op_sel:[0,0] op_sel_hi:[1,0]
    v_pk_fma_f32 v[2:3], v[4:5], v[8:9], v[148:149] op_sel:[1,1,0] op_sel_hi:[0,1,1] neg_lo:[0,1,0]
    v_pk_fma_f32 v[4:5], v[4:5], v[8:9], v[2:3] op_sel:[0,0,0] op_sel_hi:[1,0,1]
    v_pk_mul_f32 v[150:151], v[150:151], v[58:59] op_sel:[0,1] op_sel_hi:[1,1]
    v_pk_fma_f32 v[2:3], v[4:5], v[8:9], v[150:151] op_sel:[1,1,0] op_sel_hi:[0,1,1] neg_lo:[0,1,0]
    v_pk_fma_f32 v[4:5], v[4:5], v[8:9], v[2:3] op_sel:[0,0,0] op_sel_hi:[1,0,1]
    v_pk_mul_f32 v[152:153], v[152:153], v[60:61] op_sel:[0,0] op_sel_hi:[1,0]
    v_pk_fma_f32 v[2:3], v[4:5], v[8:9], v[152:153] op_sel:[1,1,0] op_sel_hi:[0,1,1] neg_lo:[0,1,0]
    v_pk_fma_f32 v[4:5], v[4:5], v[8:9], v[2:3] op_sel:[0,0,0] op_sel_hi:[1,0,1]
    v_pk_mul_f32 v[154:155], v[154:155], v[60:61] op_sel:[0,1] op_sel_hi:[1,1]
    v_pk_fma_f32 v[2:3], v[4:5], v[8:9], v[154:155] op_sel:[1,1,0] op_sel_hi:[0,1,1] neg_lo:[0,1,0]
    v_pk_fma_f32 v[4:5], v[4:5], v[8:9], v[2:3] op_sel:[0,0,0] op_sel_hi:[1,0,1]
    v_pk_mul_f32 v[156:157], v[156:157], v[62:63] op_sel:[0,0] op_sel_hi:[1,0]
    buffer_load_dwordx4 v19, s[20:23], s89 offen offset:3072 lds
    v_pk_fma_f32 v[2:3], v[4:5], v[8:9], v[156:157] op_sel:[1,1,0] op_sel_hi:[0,1,1] neg_lo:[0,1,0]
    s_lshl_b32 s92, s65, 1
    s_add_u32 s92, s92, s70
    s_lshl_b32 s79, s66, 1
    s_add_u32 s79, s79, s71
    s_lshl_b32 s79, s79, 9
    s_lshl_b32 s80, s92, 13
    s_add_u32 s79, s79, s80
    s_add_u32 s79, s79, 10616832
    v_and_b32 v226, 31, v1
    v_lshl_add_u32 v226, v226, 4, s79
    v_pk_fma_f32 v[4:5], v[4:5], v[8:9], v[2:3] op_sel:[0,0,0] op_sel_hi:[1,0,1]
    v_pk_mul_f32 v[158:159], v[158:159], v[62:63] op_sel:[0,1] op_sel_hi:[1,1]
    v_pk_fma_f32 v[2:3], v[4:5], v[8:9], v[158:159] op_sel:[1,1,0] op_sel_hi:[0,1,1] neg_lo:[0,1,0]
    v_pk_fma_f32 v[4:5], v[4:5], v[8:9], v[2:3] op_sel:[0,0,0] op_sel_hi:[1,0,1]
    v_pk_mul_f32 v[160:161], v[160:161], v[64:65] op_sel:[0,0] op_sel_hi:[1,0]
    v_pk_fma_f32 v[2:3], v[4:5], v[8:9], v[160:161] op_sel:[1,1,0] op_sel_hi:[0,1,1] neg_lo:[0,1,0]
    v_pk_fma_f32 v[4:5], v[4:5], v[8:9], v[2:3] op_sel:[0,0,0] op_sel_hi:[1,0,1]
    v_pk_mul_f32 v[162:163], v[162:163], v[64:65] op_sel:[0,1] op_sel_hi:[1,1]
    v_pk_fma_f32 v[2:3], v[4:5], v[8:9], v[162:163] op_sel:[1,1,0] op_sel_hi:[0,1,1] neg_lo:[0,1,0]
    v_pk_fma_f32 v[4:5], v[4:5], v[8:9], v[2:3] op_sel:[0,0,0] op_sel_hi:[1,0,1]
    v_pk_mul_f32 v[164:165], v[164:165], v[66:67] op_sel:[0,0] op_sel_hi:[1,0]
    v_pk_fma_f32 v[2:3], v[4:5], v[8:9], v[164:165] op_sel:[1,1,0] op_sel_hi:[0,1,1] neg_lo:[0,1,0]
    v_pk_fma_f32 v[4:5], v[4:5], v[8:9], v[2:3] op_sel:[0,0,0] op_sel_hi:[1,0,1]
    v_pk_mul_f32 v[166:167], v[166:167], v[66:67] op_sel:[0,1] op_sel_hi:[1,1]
    s_add_u32 m0, s78, 57344
    s_add_u32 s89, s87, 0
    buffer_load_dwordx4 v20, s[24:27], s89 offen offset:0 lds
    v_pk_fma_f32 v[2:3], v[4:5], v[8:9], v[166:167] op_sel:[1,1,0] op_sel_hi:[0,1,1] neg_lo:[0,1,0]
    v_pk_fma_f32 v[4:5], v[4:5], v[8:9], v[2:3] op_sel:[0,0,0] op_sel_hi:[1,0,1]
    v_pk_mul_f32 v[168:169], v[168:169], v[68:69] op_sel:[0,0] op_sel_hi:[1,0]
    v_pk_fma_f32 v[2:3], v[4:5], v[8:9], v[168:169] op_sel:[1,1,0] op_sel_hi:[0,1,1] neg_lo:[0,1,0]
    v_pk_fma_f32 v[4:5], v[4:5], v[8:9], v[2:3] op_sel:[0,0,0] op_sel_hi:[1,0,1]
    v_pk_mul_f32 v[170:171], v[170:171], v[68:69] op_sel:[0,1] op_sel_hi:[1,1]
    v_pk_fma_f32 v[2:3], v[4:5], v[8:9], v[170:171] op_sel:[1,1,0] op_sel_hi:[0,1,1] neg_lo:[0,1,0]
    v_pk_fma_f32 v[4:5], v[4:5], v[8:9], v[2:3] op_sel:[0,0,0] op_sel_hi:[1,0,1]
    v_pk_mul_f32 v[172:173], v[172:173], v[70:71] op_sel:[0,0] op_sel_hi:[1,0]
    v_pk_fma_f32 v[2:3], v[4:5], v[8:9], v[172:173] op_sel:[1,1,0] op_sel_hi:[0,1,1] neg_lo:[0,1,0]
    v_pk_fma_f32 v[4:5], v[4:5], v[8:9], v[2:3] op_sel:[0,0,0] op_sel_hi:[1,0,1]
    v_pk_mul_f32 v[174:175], v[174:175], v[70:71] op_sel:[0,1] op_sel_hi:[1,1]
    v_pk_fma_f32 v[2:3], v[4:5], v[8:9], v[174:175] op_sel:[1,1,0] op_sel_hi:[0,1,1] neg_lo:[0,1,0]
    v_pk_fma_f32 v[4:5], v[4:5], v[8:9], v[2:3] op_sel:[0,0,0] op_sel_hi:[1,0,1]
    v_pk_mul_f32 v[176:177], v[176:177], v[72:73] op_sel:[0,0] op_sel_hi:[1,0]
    v_pk_fma_f32 v[2:3], v[4:5], v[8:9], v[176:177] op_sel:[1,1,0] op_sel_hi:[0,1,1] neg_lo:[0,1,0]
    v_pk_fma_f32 v[4:5], v[4:5], v[8:9], v[2:3] op_sel:[0,0,0] op_sel_hi:[1,0,1]
    v_pk_mul_f32 v[178:179], v[178:179], v[72:73] op_sel:[0,1] op_sel_hi:[1,1]
    v_pk_fma_f32 v[2:3], v[4:5], v[8:9], v[178:179] op_sel:[1,1,0] op_sel_hi:[0,1,1] neg_lo:[0,1,0]
    v_pk_fma_f32 v[4:5], v[4:5], v[8:9], v[2:3] op_sel:[0,0,0] op_sel_hi:[1,0,1]
    v_pk_mul_f32 v[180:181], v[180:181], v[74:75] op_sel:[0,0] op_sel_hi:[1,0]
    v_pk_fma_f32 v[2:3], v[4:5], v[8:9], v[180:181] op_sel:[1,1,0] op_sel_hi:[0,1,1] neg_lo:[0,1,0]
    v_pk_fma_f32 v[4:5], v[4:5], v[8:9], v[2:3] op_sel:[0,0,0] op_sel_hi:[1,0,1]
    v_pk_mul_f32 v[182:183], v[182:183], v[74:75] op_sel:[0,1] op_sel_hi:[1,1]
    v_pk_fma_f32 v[2:3], v[4:5], v[8:9], v[182:183] op_sel:[1,1,0] op_sel_hi:[0,1,1] neg_lo:[0,1,0]
    v_pk_fma_f32 v[4:5], v[4:5], v[8:9], v[2:3] op_sel:[0,0,0] op_sel_hi:[1,0,1]
    buffer_load_dwordx4 v21, s[24:27], s89 offen offset:1024 lds
    v_pk_mul_f32 v[184:185], v[184:185], v[76:77] op_sel:[0,0] op_sel_hi:[1,0]
    v_pk_fma_f32 v[2:3], v[4:5], v[8:9], v[184:185] op_sel:[1,1,0] op_sel_hi:[0,1,1] neg_lo:[0,1,0]
    v_pk_fma_f32 v[4:5], v[4:5], v[8:9], v[2:3] op_sel:[0,0,0] op_sel_hi:[1,0,1]
    v_pk_mul_f32 v[186:187], v[186:187], v[76:77] op_sel:[0,1] op_sel_hi:[1,1]
    v_pk_fma_f32 v[2:3], v[4:5], v[8:9], v[186:187] op_sel:[1,1,0] op_sel_hi:[0,1,1] neg_lo:[0,1,0]
    v_pk_fma_f32 v[4:5], v[4:5], v[8:9], v[2:3] op_sel:[0,0,0] op_sel_hi:[1,0,1]
    v_pk_mul_f32 v[188:189], v[188:189], v[78:79] op_sel:[0,0] op_sel_hi:[1,0]
    v_pk_fma_f32 v[2:3], v[4:5], v[8:9], v[188:189] op_sel:[1,1,0] op_sel_hi:[0,1,1] neg_lo:[0,1,0]
    v_pk_fma_f32 v[4:5], v[4:5], v[8:9], v[2:3] op_sel:[0,0,0] op_sel_hi:[1,0,1]
    v_pk_mul_f32 v[190:191], v[190:191], v[78:79] op_sel:[0,1] op_sel_hi:[1,1]
    v_pk_fma_f32 v[2:3], v[4:5], v[8:9], v[190:191] op_sel:[1,1,0] op_sel_hi:[0,1,1] neg_lo:[0,1,0]
    v_pk_fma_f32 v[4:5], v[4:5], v[8:9], v[2:3] op_sel:[0,0,0] op_sel_hi:[1,0,1]
    v_pk_mul_f32 v[192:193], v[192:193], v[80:81] op_sel:[0,0] op_sel_hi:[1,0]
    v_pk_fma_f32 v[2:3], v[4:5], v[8:9], v[192:193] op_sel:[1,1,0] op_sel_hi:[0,1,1] neg_lo:[0,1,0]
    v_pk_fma_f32 v[4:5], v[4:5], v[8:9], v[2:3] op_sel:[0,0,0] op_sel_hi:[1,0,1]
    v_pk_mul_f32 v[194:195], v[194:195], v[80:81] op_sel:[0,1] op_sel_hi:[1,1]
    v_pk_fma_f32 v[2:3], v[4:5], v[8:9], v[194:195] op_sel:[1,1,0] op_sel_hi:[0,1,1] neg_lo:[0,1,0]
    v_pk_fma_f32 v[4:5], v[4:5], v[8:9], v[2:3] op_sel:[0,0,0] op_sel_hi:[1,0,1]
    v_pk_mul_f32 v[196:197], v[196:197], v[82:83] op_sel:[0,0] op_sel_hi:[1,0]
    v_pk_fma_f32 v[2:3], v[4:5], v[8:9], v[196:197] op_sel:[1,1,0] op_sel_hi:[0,1,1] neg_lo:[0,1,0]
    v_pk_fma_f32 v[4:5], v[4:5], v[8:9], v[2:3] op_sel:[0,0,0] op_sel_hi:[1,0,1]
    v_pk_mul_f32 v[198:199], v[198:199], v[82:83] op_sel:[0,1] op_sel_hi:[1,1]
    v_pk_fma_f32 v[2:3], v[4:5], v[8:9], v[198:199] op_sel:[1,1,0] op_sel_hi:[0,1,1] neg_lo:[0,1,0]
    v_pk_fma_f32 v[4:5], v[4:5], v[8:9], v[2:3] op_sel:[0,0,0] op_sel_hi:[1,0,1]
    v_pk_mul_f32 v[200:201], v[200:201], v[84:85] op_sel:[0,0] op_sel_hi:[1,0]
    buffer_load_dwordx4 v22, s[24:27], s89 offen offset:2048 lds
    v_pk_fma_f32 v[2:3], v[4:5], v[8:9], v[200:201] op_sel:[1,1,0] op_sel_hi:[0,1,1] neg_lo:[0,1,0]
    v_pk_fma_f32 v[4:5], v[4:5], v[8:9], v[2:3] op_sel:[0,0,0] op_sel_hi:[1,0,1]
    v_pk_mul_f32 v[202:203], v[202:203], v[84:85] op_sel:[0,1] op_sel_hi:[1,1]
    v_pk_fma_f32 v[2:3], v[4:5], v[8:9], v[202:203] op_sel:[1,1,0] op_sel_hi:[0,1,1] neg_lo:[0,1,0]
    v_pk_fma_f32 v[4:5], v[4:5], v[8:9], v[2:3] op_sel:[0,0,0] op_sel_hi:[1,0,1]
    v_pk_mul_f32 v[204:205], v[204:205], v[86:87] op_sel:[0,0] op_sel_hi:[1,0]
    v_pk_fma_f32 v[2:3], v[4:5], v[8:9], v[204:205] op_sel:[1,1,0] op_sel_hi:[0,1,1] neg_lo:[0,1,0]
    v_pk_fma_f32 v[4:5], v[4:5], v[8:9], v[2:3] op_sel:[0,0,0] op_sel_hi:[1,0,1]
    v_pk_mul_f32 v[206:207], v[206:207], v[86:87] op_sel:[0,1] op_sel_hi:[1,1]
    v_pk_fma_f32 v[2:3], v[4:5], v[8:9], v[206:207] op_sel:[1,1,0] op_sel_hi:[0,1,1] neg_lo:[0,1,0]
    v_pk_fma_f32 v[4:5], v[4:5], v[8:9], v[2:3] op_sel:[0,0,0] op_sel_hi:[1,0,1]
    v_pk_mul_f32 v[208:209], v[208:209], v[88:89] op_sel:[0,0] op_sel_hi:[1,0]
    v_pk_fma_f32 v[2:3], v[4:5], v[8:9], v[208:209] op_sel:[1,1,0] op_sel_hi:[0,1,1] neg_lo:[0,1,0]
    v_pk_fma_f32 v[4:5], v[4:5], v[8:9], v[2:3] op_sel:[0,0,0] op_sel_hi:[1,0,1]
    v_pk_mul_f32 v[210:211], v[210:211], v[88:89] op_sel:[0,1] op_sel_hi:[1,1]
    v_pk_fma_f32 v[2:3], v[4:5], v[8:9], v[210:211] op_sel:[1,1,0] op_sel_hi:[0,1,1] neg_lo:[0,1,0]
    v_pk_fma_f32 v[4:5], v[4:5], v[8:9], v[2:3] op_sel:[0,0,0] op_sel_hi:[1,0,1]
    v_pk_mul_f32 v[212:213], v[212:213], v[90:91] op_sel:[0,0] op_sel_hi:[1,0]
    v_pk_fma_f32 v[2:3], v[4:5], v[8:9], v[212:213] op_sel:[1,1,0] op_sel_hi:[0,1,1] neg_lo:[0,1,0]
    v_pk_fma_f32 v[4:5], v[4:5], v[8:9], v[2:3] op_sel:[0,0,0] op_sel_hi:[1,0,1]
    v_pk_mul_f32 v[214:215], v[214:215], v[90:91] op_sel:[0,1] op_sel_hi:[1,1]
    v_pk_fma_f32 v[2:3], v[4:5], v[8:9], v[214:215] op_sel:[1,1,0] op_sel_hi:[0,1,1] neg_lo:[0,1,0]
    v_pk_fma_f32 v[4:5], v[4:5], v[8:9], v[2:3] op_sel:[0,0,0] op_sel_hi:[1,0,1]
    v_pk_mul_f32 v[216:217], v[216:217], v[92:93] op_sel:[0,0] op_sel_hi:[1,0]
    v_pk_fma_f32 v[2:3], v[4:5], v[8:9], v[216:217] op_sel:[1,1,0] op_sel_hi:[0,1,1] neg_lo:[0,1,0]
    v_pk_fma_f32 v[4:5], v[4:5], v[8:9], v[2:3] op_sel:[0,0,0] op_sel_hi:[1,0,1]
    v_pk_mul_f32 v[218:219], v[218:219], v[92:93] op_sel:[0,1] op_sel_hi:[1,1]
    v_pk_fma_f32 v[2:3], v[4:5], v[8:9], v[218:219] op_sel:[1,1,0] op_sel_hi:[0,1,1] neg_lo:[0,1,0]
    v_pk_fma_f32 v[4:5], v[4:5], v[8:9], v[2:3] op_sel:[0,0,0] op_sel_hi:[1,0,1]
    v_pk_mul_f32 v[220:221], v[220:221], v[94:95] op_sel:[0,0] op_sel_hi:[1,0]
    v_pk_fma_f32 v[2:3], v[4:5], v[8:9], v[220:221] op_sel:[1,1,0] op_sel_hi:[0,1,1] neg_lo:[0,1,0]
    v_pk_fma_f32 v[4:5], v[4:5], v[8:9], v[2:3] op_sel:[0,0,0] op_sel_hi:[1,0,1]
    v_pk_mul_f32 v[222:223], v[222:223], v[94:95] op_sel:[0,1] op_sel_hi:[1,1]
    v_pk_fma_f32 v[2:3], v[4:5], v[8:9], v[222:223] op_sel:[1,1,0] op_sel_hi:[0,1,1] neg_lo:[0,1,0]
    v_pk_fma_f32 v[4:5], v[4:5], v[8:9], v[2:3] op_sel:[0,0,0] op_sel_hi:[1,0,1]
    v_mov_b32 v32, v4
    v_mov_b32 v33, v5
    v_mov_b32 v37, 1
    v_mov_b32 v39, 1
    v_permlane32_swap_b32 v32, v4
    v_permlane32_swap_b32 v33, v5
    v_pk_fma_f32 v[2:3], v[32:33], v[12:13], v[4:5] op_sel:[1,1,0] op_sel_hi:[0,1,1] neg_lo:[0,1,0]
    v_pk_fma_f32 v[34:35], v[32:33], v[12:13], v[2:3] op_sel:[0,0,0] op_sel_hi:[1,0,1]
    v_mov_b32 v36, v34
    v_mov_b32 v38, v35
    s_mov_b32 exec_hi, 0
    buffer_store_dwordx4 v[36:39], v226, s[12:15], 0 offen sc1
    s_mov_b64 exec, -1
    v_pk_mul_f32 v[2:3], v[12:13], v[12:13] op_sel:[1,1] op_sel_hi:[0,1] neg_lo:[0,1]
    buffer_load_dwordx4 v23, s[24:27], s89 offen offset:3072 lds
    v_pk_fma_f32 v[48:49], v[12:13], v[12:13], v[2:3] op_sel:[0,0,0] op_sel_hi:[1,0,1]
    v_lshrrev_b32 v54, 5, v1
    v_sub_u32 v55, s92, v54
    v_lshlrev_b32 v54, 13, v54
    v_sub_u32 v54, v226, v54
    v_mov_b32 v56, 10584064
    s_waitcnt lgkmcnt(0)
    v_cmp_lt_i32 vcc, 0, v55
    v_subrev_u32 v40, 8192, v54
    s_nop 0
    v_cndmask_b32 v40, v56, v40, vcc
    v_cmp_lt_i32 vcc, 2, v55
    v_subrev_u32 v41, 24576, v54
    s_nop 0
    s_add_u32 m0, s77, 0
    s_add_u32 s89, s87, 32768
    buffer_load_dwordx4 v20, s[24:27], s89 offen offset:0 lds
    v_cndmask_b32 v41, v56, v41, vcc
    v_cmp_lt_i32 vcc, 4, v55
    v_subrev_u32 v42, 40960, v54
    s_nop 0
    v_cndmask_b32 v42, v56, v42, vcc
    v_cmp_lt_i32 vcc, 6, v55
    buffer_load_dwordx4 v21, s[24:27], s89 offen offset:1024 lds
    v_subrev_u32 v43, 57344, v54
    s_nop 0
    v_cndmask_b32 v43, v56, v43, vcc
    v_cmp_lt_i32 vcc, 8, v55
    v_subrev_u32 v44, 73728, v54
    s_nop 0
    v_cndmask_b32 v44, v56, v44, vcc
    s_waitcnt vmcnt(15)
    v_cmp_lt_i32 vcc, 10, v55
    v_subrev_u32 v45, 90112, v54
    s_nop 0
    v_cndmask_b32 v45, v56, v45, vcc
    v_cmp_lt_i32 vcc, 12, v55
    v_subrev_u32 v46, 106496, v54
    s_nop 0
    buffer_load_dwordx4 v22, s[24:27], s89 offen offset:2048 lds
    v_cndmask_b32 v46, v56, v46, vcc
    v_cmp_lt_i32 vcc, 14, v55
    v_subrev_u32 v47, 122880, v54
    s_nop 0
    v_cndmask_b32 v47, v56, v47, vcc
    v_cmp_lt_u32 vcc, 31, v1
    ds_read_b128 a[20:23], v24 offset:0
    ds_read_b128 a[28:31], v25 offset:0
    v_bfe_u32 v54, v1, 4, 1
    v_lshrrev_b32 v55, 5, v1
    v_cndmask_b32 v50, 1.0, v12, vcc
    v_cndmask_b32 v51, 0, v13, vcc
    v_cndmask_b32 v52, 0, v32, vcc
    v_cndmask_b32 v53, 0, v33, vcc
    v_cmp_eq_u32 vcc, v54, v55
    buffer_load_dwordx4 v23, s[24:27], s89 offen offset:3072 lds
    v_and_b32 v54, 1, v1
    v_lshlrev_b32 v54, 4, v54
    v_mov_b32 v55, 0x3f80
    v_lshlrev_b32 v54, v54, v55
    v_bfe_u32 v55, v1, 1, 3
    v_cndmask_b32 v54, 0, v54, vcc
    v_cmp_eq_u32 vcc, 0, v55
    ds_read_b128 a[52:55], v26 offset:0
    ds_read_b128 a[60:63], v27 offset:0
    s_nop 1
    v_cndmask_b32 v60, 0, v54, vcc
    v_cmp_eq_u32 vcc, 1, v55
    s_nop 1
    v_cndmask_b32 v61, 0, v54, vcc
    v_cmp_eq_u32 vcc, 2, v55
    s_add_u32 m0, s77, 4096
    s_add_u32 s89, s87, 65536
    buffer_load_dwordx4 v20, s[24:27], s89 offen offset:0 lds
    s_nop 1
    v_cndmask_b32 v62, 0, v54, vcc
    v_cmp_eq_u32 vcc, 3, v55
    s_nop 1
    v_cndmask_b32 v63, 0, v54, vcc
    v_cmp_eq_u32 vcc, 4, v55
    s_nop 1
    buffer_load_dwordx4 v21, s[24:27], s89 offen offset:1024 lds
    v_cndmask_b32 v64, 0, v54, vcc
    v_cmp_eq_u32 vcc, 5, v55
    s_nop 1
    v_cndmask_b32 v65, 0, v54, vcc
    v_cmp_eq_u32 vcc, 6, v55
    s_nop 1
    v_cndmask_b32 v66, 0, v54, vcc
    ds_read_b128 a[64:67], v24 offset:4096
    ds_read_b128 a[72:75], v25 offset:4096
    v_cmp_eq_u32 vcc, 7, v55
    s_nop 1
    v_cndmask_b32 v67, 0, v54, vcc
    s_lshl_b32 s79, s66, 1
    s_add_u32 s79, s79, s71
    s_lshl_b32 s79, s79, 13
    buffer_load_dwordx4 v22, s[24:27], s89 offen offset:2048 lds
    s_lshl_b32 s80, s92, 18
    s_add_u32 s79, s79, s80
    s_add_u32 s88, s79, 6291456
    v_lshlrev_b32 v54, 4, v1
    s_lshl_b32 s79, s66, 1
    s_add_u32 s79, s79, s71
    s_lshl_b32 s80, s65, 1
    ds_read_b128 a[96:99], v26 offset:4096
    ds_read_b128 a[104:107], v27 offset:4096
    s_add_u32 s80, s80, s70
    s_lshl_b32 s80, s80, 6
    s_add_u32 s79, s79, s80
    s_lshl_b32 s79, s79, 7
    s_add_u32 s75, s79, 10754048
    v_mov_b32 v91, 0
    s_lshl_b32 s79, s71, 10
    buffer_load_dwordx4 v23, s[24:27], s89 offen offset:3072 lds
    v_lshl_add_u32 v84, v1, 4, s79
    v_xor_b32 v85, 1024, v84
    s_lshl_b32 s79, s67, 2
    s_add_u32 s79, s79, s68
    s_mul_i32 s76, s79, 176128
    s_mul_i32 s80, s64, 45056
    s_add_u32 m0, s77, 8192
    s_add_u32 s89, s87, 98304
    buffer_load_dwordx4 v20, s[24:27], s89 offen offset:0 lds
    s_add_u32 s76, s76, s80
    s_lshl_b32 s73, s79, 17
    s_lshl_b32 s80, s64, 15
    s_add_u32 s73, s73, s80
    s_add_u32 s73, s73, 6291456
    s_lshr_b32 s79, s79, 1
    s_lshl_b32 s79, s79, 13
    ds_read_b128 a[68:71], v24 offset:8192
    ds_read_b128 a[76:79], v25 offset:8192
    s_add_u32 s74, s79, 10747904
    s_mul_i32 s80, s64, 11
    v_min_u32 v89, 10, v1
    v_add_u32 v89, s80, v89
    v_min_u32 v89, 42, v89
    v_lshlrev_b32 v89, 7, v89
    s_lshl_b32 s80, s64, 2
    buffer_load_dwordx4 v21, s[24:27], s89 offen offset:1024 lds
    s_add_u32 s80, s80, 48
    v_min_u32 v90, 3, v1
    v_add_u32 v90, s80, v90
    v_lshlrev_b32 v90, 7, v90
    s_lshl_b32 s79, s67, 8
    s_lshr_b32 s80, s68, 1
    ds_read_b128 a[100:103], v26 offset:8192
    ds_read_b128 a[108:111], v27 offset:8192
    s_lshl_b32 s80, s80, 7
    s_add_u32 s79, s79, s80
    s_and_b32 s80, s68, 1
    s_lshl_b32 s80, s80, 5
    s_add_u32 s79, s79, s80
    s_lshl_b32 s80, s71, 4
    s_add_u32 s79, s79, s80
    buffer_load_dwordx4 v22, s[24:27], s89 offen offset:2048 lds
    v_bfe_u32 v56, v1, 4, 1
    v_and_b32 v57, 15, v1
    v_lshl_add_u32 v56, v56, 6, v57
    v_add_u32 v56, s79, v56
    v_lshrrev_b32 v88, 3, v1
    v_add_u32 v88, s79, v88
    s_lshl_b32 s79, s69, 7
    buffer_load_dwordx4 v23, s[24:27], s89 offen offset:3072 lds
    s_lshl_b32 s80, s70, 6
    s_add_u32 s79, s79, s80
    v_and_b32 v57, 32, v1
    v_add_u32 v94, s79, v57
    v_lshl_add_u32 v93, v56, 10, v94
    v_lshlrev_b32 v95, 4, v56
    s_waitcnt lgkmcnt(0)
    v_add_u32 v95, 10485760, v95
    s_lshl_b32 s79, s79, 1
    v_and_b32 v57, 7, v1
    v_lshl_add_u32 v57, v57, 4, s79
    v_lshl_add_u32 v88, v88, 11, v57
    s_and_b32 s79, s70, s71
    s_mul_i32 s79, s79, 2130706432
    s_add_u32 m0, s78, 0
    s_add_u32 s89, s87, 131072
    buffer_load_dwordx4 v20, s[24:27], s89 offen offset:0 lds
    v_add_u32 v86, s79, v84
    v_add_u32 v87, s79, v85
    s_mov_b32 s28, s48
    s_mov_b32 s29, s49
    s_mov_b32 s30, 1024
    s_mov_b32 s31, 0x00020000
    s_mov_b32 s83, 200000
Lagg_10:
    buffer_load_dwordx4 v[224:227], v40, s[12:15], 0 offen sc1
    buffer_load_dwordx4 v[228:231], v41, s[12:15], 0 offen sc1
    buffer_load_dwordx4 v[232:235], v42, s[12:15], 0 offen sc1
    buffer_load_dwordx4 v[236:239], v43, s[12:15], 0 offen sc1
    buffer_load_dwordx4 v[240:243], v44, s[12:15], 0 offen sc1
    buffer_load_dwordx4 v[244:247], v45, s[12:15], 0 offen sc1
    buffer_load_dwordx4 v[248:251], v46, s[12:15], 0 offen sc1
    buffer_load_dwordx4 v[252:255], v47, s[12:15], 0 offen sc1
    s_waitcnt vmcnt(0)
    v_and_b32 v56, v225, v227
    v_and_b32 v57, v229, v231
    v_and_b32 v56, v56, v57
    v_and_b32 v57, v233, v235
    v_and_b32 v56, v56, v57
    v_and_b32 v57, v237, v239
    v_and_b32 v56, v56, v57
    v_and_b32 v57, v241, v243
    v_and_b32 v56, v56, v57
    v_and_b32 v57, v245, v247
    v_and_b32 v56, v56, v57
    v_and_b32 v57, v249, v251
    v_and_b32 v56, v56, v57
    v_and_b32 v57, v253, v255
    v_and_b32 v56, v56, v57
    v_cmp_ne_u32 vcc, 0, v56
    s_nop 1
    s_cmp_eq_u64 vcc, -1
    s_cbranch_scc1 Laggd_11
    s_sub_u32 s83, s83, 1
    s_cbranch_scc0 Lagg_10
Laggd_11:
    buffer_load_dwordx4 a[128:131], v93, s[4:7], 0 offen offset:0
    buffer_load_dwordx4 a[136:139], v94, s[28:31], 0 offen offset:0
    buffer_load_dwordx4 a[132:135], v93, s[4:7], 0 offen offset:16
    buffer_load_dwordx4 a[140:143], v94, s[28:31], 0 offen offset:16
    buffer_load_dwordx4 a[144:147], v95, s[12:15], 0 offen sc1
    v_mov_b32 v225, v226
    v_mov_b32 v229, v230
    v_mov_b32 v233, v234
    v_mov_b32 v237, v238
    v_mov_b32 v241, v242
    v_mov_b32 v245, v246
    v_mov_b32 v249, v250
    v_mov_b32 v253, v254
    v_pk_fma_f32 v[2:3], v[252:253], v[6:7], v[248:249] op_sel:[1,1,0] op_sel_hi:[0,1,1] neg_lo:[0,1,0]
    v_pk_fma_f32 v[4:5], v[252:253], v[6:7], v[2:3] op_sel:[0,0,0] op_sel_hi:[1,0,1]
    v_pk_fma_f32 v[2:3], v[4:5], v[6:7], v[244:245] op_sel:[1,1,0] op_sel_hi:[0,1,1] neg_lo:[0,1,0]
    v_pk_fma_f32 v[4:5], v[4:5], v[6:7], v[2:3] op_sel:[0,0,0] op_sel_hi:[1,0,1]
    v_pk_fma_f32 v[2:3], v[4:5], v[6:7], v[240:241] op_sel:[1,1,0] op_sel_hi:[0,1,1] neg_lo:[0,1,0]
    v_pk_fma_f32 v[4:5], v[4:5], v[6:7], v[2:3] op_sel:[0,0,0] op_sel_hi:[1,0,1]
    v_pk_fma_f32 v[2:3], v[4:5], v[6:7], v[236:237] op_sel:[1,1,0] op_sel_hi:[0,1,1] neg_lo:[0,1,0]
    v_pk_fma_f32 v[4:5], v[4:5], v[6:7], v[2:3] op_sel:[0,0,0] op_sel_hi:[1,0,1]
    v_pk_fma_f32 v[2:3], v[4:5], v[6:7], v[232:233] op_sel:[1,1,0] op_sel_hi:[0,1,1] neg_lo:[0,1,0]
    v_pk_fma_f32 v[4:5], v[4:5], v[6:7], v[2:3] op_sel:[0,0,0] op_sel_hi:[1,0,1]
    v_pk_fma_f32 v[2:3], v[4:5], v[6:7], v[228:229] op_sel:[1,1,0] op_sel_hi:[0,1,1] neg_lo:[0,1,0]
    v_pk_fma_f32 v[4:5], v[4:5], v[6:7], v[2:3] op_sel:[0,0,0] op_sel_hi:[1,0,1]
    v_pk_fma_f32 v[2:3], v[4:5], v[6:7], v[224:225] op_sel:[1,1,0] op_sel_hi:[0,1,1] neg_lo:[0,1,0]
    v_pk_fma_f32 v[4:5], v[4:5], v[6:7], v[2:3] op_sel:[0,0,0] op_sel_hi:[1,0,1]
    v_mov_b32 v32, v4
    v_mov_b32 v33, v5
    s_nop 1
    v_permlane32_swap_b32 v32, v4
    v_permlane32_swap_b32 v33, v5
    v_pk_fma_f32 v[2:3], v[4:5], v[48:49], v[32:33] op_sel:[1,1,0] op_sel_hi:[0,1,1] neg_lo:[0,1,0]
    v_pk_fma_f32 v[4:5], v[4:5], v[48:49], v[2:3] op_sel:[0,0,0] op_sel_hi:[1,0,1]
    v_pk_fma_f32 v[2:3], v[4:5], v[50:51], v[52:53] op_sel:[1,1,0] op_sel_hi:[0,1,1] neg_lo:[0,1,0]
    v_pk_fma_f32 v[4:5], v[4:5], v[50:51], v[2:3] op_sel:[0,0,0] op_sel_hi:[1,0,1]
    v_pk_fma_f32 v[2:3], v[4:5], v[8:9], v[96:97] op_sel:[1,1,0] op_sel_hi:[0,1,1] neg_lo:[0,1,0]
    v_pk_fma_f32 v[96:97], v[4:5], v[8:9], v[2:3] op_sel:[0,0,0] op_sel_hi:[1,0,1]
    v_pk_fma_f32 v[2:3], v[96:97], v[8:9], v[98:99] op_sel:[1,1,0] op_sel_hi:[0,1,1] neg_lo:[0,1,0]
    v_pk_fma_f32 v[98:99], v[96:97], v[8:9], v[2:3] op_sel:[0,0,0] op_sel_hi:[1,0,1]
    v_pk_fma_f32 v[2:3], v[98:99], v[8:9], v[100:101] op_sel:[1,1,0] op_sel_hi:[0,1,1] neg_lo:[0,1,0]
    v_pk_fma_f32 v[100:101], v[98:99], v[8:9], v[2:3] op_sel:[0,0,0] op_sel_hi:[1,0,1]
    v_pk_fma_f32 v[2:3], v[100:101], v[8:9], v[102:103] op_sel:[1,1,0] op_sel_hi:[0,1,1] neg_lo:[0,1,0]
    v_pk_fma_f32 v[102:103], v[100:101], v[8:9], v[2:3] op_sel:[0,0,0] op_sel_hi:[1,0,1]
    v_pk_fma_f32 v[2:3], v[102:103], v[8:9], v[104:105] op_sel:[1,1,0] op_sel_hi:[0,1,1] neg_lo:[0,1,0]
    buffer_load_dwordx4 v21, s[24:27], s89 offen offset:1024 lds
    v_pk_fma_f32 v[104:105], v[102:103], v[8:9], v[2:3] op_sel:[0,0,0] op_sel_hi:[1,0,1]
    v_pk_fma_f32 v[2:3], v[104:105], v[8:9], v[106:107] op_sel:[1,1,0] op_sel_hi:[0,1,1] neg_lo:[0,1,0]
    v_pk_fma_f32 v[106:107], v[104:105], v[8:9], v[2:3] op_sel:[0,0,0] op_sel_hi:[1,0,1]
    v_pk_fma_f32 v[2:3], v[106:107], v[8:9], v[108:109] op_sel:[1,1,0] op_sel_hi:[0,1,1] neg_lo:[0,1,0]
    v_pk_fma_f32 v[108:109], v[106:107], v[8:9], v[2:3] op_sel:[0,0,0] op_sel_hi:[1,0,1]
    v_pk_fma_f32 v[2:3], v[108:109], v[8:9], v[110:111] op_sel:[1,1,0] op_sel_hi:[0,1,1] neg_lo:[0,1,0]
    v_pk_fma_f32 v[110:111], v[108:109], v[8:9], v[2:3] op_sel:[0,0,0] op_sel_hi:[1,0,1]
    v_pk_fma_f32 v[2:3], v[110:111], v[8:9], v[112:113] op_sel:[1,1,0] op_sel_hi:[0,1,1] neg_lo:[0,1,0]
    ds_read_b128 a[80:83], v24 offset:49152
    ds_read_b128 a[88:91], v25 offset:49152
    v_pk_fma_f32 v[112:113], v[110:111], v[8:9], v[2:3] op_sel:[0,0,0] op_sel_hi:[1,0,1]
    v_pk_fma_f32 v[2:3], v[112:113], v[8:9], v[114:115] op_sel:[1,1,0] op_sel_hi:[0,1,1] neg_lo:[0,1,0]
    v_pk_fma_f32 v[114:115], v[112:113], v[8:9], v[2:3] op_sel:[0,0,0] op_sel_hi:[1,0,1]
    v_pk_fma_f32 v[2:3], v[114:115], v[8:9], v[116:117] op_sel:[1,1,0] op_sel_hi:[0,1,1] neg_lo:[0,1,0]
    v_pk_fma_f32 v[116:117], v[114:115], v[8:9], v[2:3] op_sel:[0,0,0] op_sel_hi:[1,0,1]
    v_pk_fma_f32 v[2:3], v[116:117], v[8:9], v[118:119] op_sel:[1,1,0] op_sel_hi:[0,1,1] neg_lo:[0,1,0]
    v_pk_fma_f32 v[118:119], v[116:117], v[8:9], v[2:3] op_sel:[0,0,0] op_sel_hi:[1,0,1]
    v_pk_fma_f32 v[2:3], v[118:119], v[8:9], v[120:121] op_sel:[1,1,0] op_sel_hi:[0,1,1] neg_lo:[0,1,0]
    buffer_load_dwordx4 v22, s[24:27], s89 offen offset:2048 lds
    v_pk_fma_f32 v[120:121], v[118:119], v[8:9], v[2:3] op_sel:[0,0,0] op_sel_hi:[1,0,1]
    v_pk_fma_f32 v[2:3], v[120:121], v[8:9], v[122:123] op_sel:[1,1,0] op_sel_hi:[0,1,1] neg_lo:[0,1,0]
    v_pk_fma_f32 v[122:123], v[120:121], v[8:9], v[2:3] op_sel:[0,0,0] op_sel_hi:[1,0,1]
    v_pk_fma_f32 v[2:3], v[122:123], v[8:9], v[124:125] op_sel:[1,1,0] op_sel_hi:[0,1,1] neg_lo:[0,1,0]
    v_pk_fma_f32 v[124:125], v[122:123], v[8:9], v[2:3] op_sel:[0,0,0] op_sel_hi:[1,0,1]
    v_pk_fma_f32 v[2:3], v[124:125], v[8:9], v[126:127] op_sel:[1,1,0] op_sel_hi:[0,1,1] neg_lo:[0,1,0]
    v_pk_fma_f32 v[126:127], v[124:125], v[8:9], v[2:3] op_sel:[0,0,0] op_sel_hi:[1,0,1]
    v_cvt_pk_bf16_f32 v68, v96, v98
    v_cvt_pk_bf16_f32 v69, v100, v102
    v_cvt_pk_bf16_f32 v70, v104, v106
    v_cvt_pk_bf16_f32 v71, v108, v110
    v_cvt_pk_bf16_f32 v72, v112, v114
    v_cvt_pk_bf16_f32 v73, v116, v118
    v_cvt_pk_bf16_f32 v74, v120, v122
    v_cvt_pk_bf16_f32 v75, v124, v126
    v_cvt_pk_bf16_f32 v76, -v97, -v99
    v_cvt_pk_bf16_f32 v77, -v101, -v103
    v_cvt_pk_bf16_f32 v78, -v105, -v107
    v_cvt_pk_bf16_f32 v79, -v109, -v111
    v_cvt_pk_bf16_f32 v80, -v113, -v115
    v_cvt_pk_bf16_f32 v81, -v117, -v119
    v_cvt_pk_bf16_f32 v82, -v121, -v123
    v_cvt_pk_bf16_f32 v83, -v125, -v127
    v_mov_b32 v4, v126
    v_mov_b32 v5, v127
    v_mfma_f32_32x32x16_bf16 v[96:111], v[68:71], v[60:63], 0
    v_mfma_f32_32x32x16_bf16 v[112:127], v[76:79], v[60:63], 0
    v_mfma_f32_32x32x16_bf16 v[96:111], v[72:75], v[64:67], v[96:111]
    v_mfma_f32_32x32x16_bf16 v[112:127], v[80:83], v[64:67], v[112:127]
    v_pk_fma_f32 v[2:3], v[4:5], v[8:9], v[128:129] op_sel:[1,1,0] op_sel_hi:[0,1,1] neg_lo:[0,1,0]
    ds_read_b128 a[112:115], v26 offset:49152
    ds_read_b128 a[120:123], v27 offset:49152
    v_pk_fma_f32 v[128:129], v[4:5], v[8:9], v[2:3] op_sel:[0,0,0] op_sel_hi:[1,0,1]
    v_pk_fma_f32 v[2:3], v[128:129], v[8:9], v[130:131] op_sel:[1,1,0] op_sel_hi:[0,1,1] neg_lo:[0,1,0]
    v_pk_fma_f32 v[130:131], v[128:129], v[8:9], v[2:3] op_sel:[0,0,0] op_sel_hi:[1,0,1]
    v_pk_fma_f32 v[2:3], v[130:131], v[8:9], v[132:133] op_sel:[1,1,0] op_sel_hi:[0,1,1] neg_lo:[0,1,0]
    v_pk_fma_f32 v[132:133], v[130:131], v[8:9], v[2:3] op_sel:[0,0,0] op_sel_hi:[1,0,1]
    v_pk_fma_f32 v[2:3], v[132:133], v[8:9], v[134:135] op_sel:[1,1,0] op_sel_hi:[0,1,1] neg_lo:[0,1,0]
    v_pk_fma_f32 v[134:135], v[132:133], v[8:9], v[2:3] op_sel:[0,0,0] op_sel_hi:[1,0,1]
    v_pk_fma_f32 v[2:3], v[134:135], v[8:9], v[136:137] op_sel:[1,1,0] op_sel_hi:[0,1,1] neg_lo:[0,1,0]
    buffer_load_dwordx4 v23, s[24:27], s89 offen offset:3072 lds
    v_pk_fma_f32 v[136:137], v[134:135], v[8:9], v[2:3] op_sel:[0,0,0] op_sel_hi:[1,0,1]
    v_pk_fma_f32 v[2:3], v[136:137], v[8:9], v[138:139] op_sel:[1,1,0] op_sel_hi:[0,1,1] neg_lo:[0,1,0]
    v_pk_fma_f32 v[138:139], v[136:137], v[8:9], v[2:3] op_sel:[0,0,0] op_sel_hi:[1,0,1]
    v_pk_fma_f32 v[2:3], v[138:139], v[8:9], v[140:141] op_sel:[1,1,0] op_sel_hi:[0,1,1] neg_lo:[0,1,0]
    v_pk_fma_f32 v[140:141], v[138:139], v[8:9], v[2:3] op_sel:[0,0,0] op_sel_hi:[1,0,1]
    v_pk_fma_f32 v[2:3], v[140:141], v[8:9], v[142:143] op_sel:[1,1,0] op_sel_hi:[0,1,1] neg_lo:[0,1,0]
    v_pk_fma_f32 v[142:143], v[140:141], v[8:9], v[2:3] op_sel:[0,0,0] op_sel_hi:[1,0,1]
    v_pk_fma_f32 v[2:3], v[142:143], v[8:9], v[144:145] op_sel:[1,1,0] op_sel_hi:[0,1,1] neg_lo:[0,1,0]
    ds_read_b128 a[84:87], v24 offset:53248
    ds_read_b128 a[92:95], v25 offset:53248
    v_pk_fma_f32 v[144:145], v[142:143], v[8:9], v[2:3] op_sel:[0,0,0] op_sel_hi:[1,0,1]
    v_pk_fma_f32 v[2:3], v[144:145], v[8:9], v[146:147] op_sel:[1,1,0] op_sel_hi:[0,1,1] neg_lo:[0,1,0]
    v_pk_fma_f32 v[146:147], v[144:145], v[8:9], v[2:3] op_sel:[0,0,0] op_sel_hi:[1,0,1]
    v_pk_fma_f32 v[2:3], v[146:147], v[8:9], v[148:149] op_sel:[1,1,0] op_sel_hi:[0,1,1] neg_lo:[0,1,0]
    v_pk_fma_f32 v[148:149], v[146:147], v[8:9], v[2:3] op_sel:[0,0,0] op_sel_hi:[1,0,1]
    v_pk_fma_f32 v[2:3], v[148:149], v[8:9], v[150:151] op_sel:[1,1,0] op_sel_hi:[0,1,1] neg_lo:[0,1,0]
    v_pk_fma_f32 v[150:151], v[148:149], v[8:9], v[2:3] op_sel:[0,0,0] op_sel_hi:[1,0,1]
    v_pk_fma_f32 v[2:3], v[150:151], v[8:9], v[152:153] op_sel:[1,1,0] op_sel_hi:[0,1,1] neg_lo:[0,1,0]
    s_add_u32 m0, s78, 4096
    s_add_u32 s89, s87, 163840
    buffer_load_dwordx4 v20, s[24:27], s89 offen offset:0 lds
    v_pk_fma_f32 v[152:153], v[150:151], v[8:9], v[2:3] op_sel:[0,0,0] op_sel_hi:[1,0,1]
    v_pk_fma_f32 v[2:3], v[152:153], v[8:9], v[154:155] op_sel:[1,1,0] op_sel_hi:[0,1,1] neg_lo:[0,1,0]
    v_pk_fma_f32 v[154:155], v[152:153], v[8:9], v[2:3] op_sel:[0,0,0] op_sel_hi:[1,0,1]
    v_pk_fma_f32 v[2:3], v[154:155], v[8:9], v[156:157] op_sel:[1,1,0] op_sel_hi:[0,1,1] neg_lo:[0,1,0]
    v_pk_fma_f32 v[156:157], v[154:155], v[8:9], v[2:3] op_sel:[0,0,0] op_sel_hi:[1,0,1]
    v_pk_fma_f32 v[2:3], v[156:157], v[8:9], v[158:159] op_sel:[1,1,0] op_sel_hi:[0,1,1] neg_lo:[0,1,0]
    v_pk_fma_f32 v[158:159], v[156:157], v[8:9], v[2:3] op_sel:[0,0,0] op_sel_hi:[1,0,1]
    v_cvt_pk_bf16_f32 v68, v128, v130
    v_cvt_pk_bf16_f32 v69, v132, v134
    v_cvt_pk_bf16_f32 v70, v136, v138
    v_cvt_pk_bf16_f32 v71, v140, v142
    v_cvt_pk_bf16_f32 v72, v144, v146
    v_cvt_pk_bf16_f32 v73, v148, v150
    v_cvt_pk_bf16_f32 v74, v152, v154
    v_cvt_pk_bf16_f32 v75, v156, v158
    v_cvt_pk_bf16_f32 v76, -v129, -v131
    v_cvt_pk_bf16_f32 v77, -v133, -v135
    v_cvt_pk_bf16_f32 v78, -v137, -v139
    v_cvt_pk_bf16_f32 v79, -v141, -v143
    v_cvt_pk_bf16_f32 v80, -v145, -v147
    v_cvt_pk_bf16_f32 v81, -v149, -v151
    v_cvt_pk_bf16_f32 v82, -v153, -v155
    v_cvt_pk_bf16_f32 v83, -v157, -v159
    v_mov_b32 v4, v158
    v_mov_b32 v5, v159
    v_mfma_f32_32x32x16_bf16 v[128:143], v[68:71], v[60:63], 0
    s_add_u32 s79, s88, 0
    v_cvt_pk_bf16_f32 v36, v96, v97
    v_cvt_pk_bf16_f32 v37, v98, v99
    v_cvt_pk_bf16_f32 v38, v100, v101
    v_cvt_pk_bf16_f32 v39, v102, v103
    buffer_store_dwordx4 v[36:39], v54, s[12:15], s79 offen offset:0 sc1
    v_mfma_f32_32x32x16_bf16 v[144:159], v[76:79], v[60:63], 0
    v_cvt_pk_bf16_f32 v40, v104, v105
    v_cvt_pk_bf16_f32 v41, v106, v107
    v_cvt_pk_bf16_f32 v42, v108, v109
    v_cvt_pk_bf16_f32 v43, v110, v111
    buffer_store_dwordx4 v[40:43], v54, s[12:15], s79 offen offset:2048 sc1
    v_mfma_f32_32x32x16_bf16 v[128:143], v[72:75], v[64:67], v[128:143]
    s_add_u32 s79, s88, 4096
    v_cvt_pk_bf16_f32 v44, v112, v113
    v_cvt_pk_bf16_f32 v45, v114, v115
    v_cvt_pk_bf16_f32 v46, v116, v117
    v_cvt_pk_bf16_f32 v47, v118, v119
    buffer_store_dwordx4 v[44:47], v54, s[12:15], s79 offen offset:0 sc1
    v_mfma_f32_32x32x16_bf16 v[144:159], v[80:83], v[64:67], v[144:159]
    v_cvt_pk_bf16_f32 v48, v120, v121
    v_cvt_pk_bf16_f32 v49, v122, v123
    v_cvt_pk_bf16_f32 v50, v124, v125
    v_cvt_pk_bf16_f32 v51, v126, v127
    buffer_store_dwordx4 v[48:51], v54, s[12:15], s79 offen offset:2048 sc1
    v_pk_fma_f32 v[2:3], v[4:5], v[8:9], v[160:161] op_sel:[1,1,0] op_sel_hi:[0,1,1] neg_lo:[0,1,0]
    ds_read_b128 a[116:119], v26 offset:53248
    ds_read_b128 a[124:127], v27 offset:53248
    v_pk_fma_f32 v[160:161], v[4:5], v[8:9], v[2:3] op_sel:[0,0,0] op_sel_hi:[1,0,1]
    v_pk_fma_f32 v[2:3], v[160:161], v[8:9], v[162:163] op_sel:[1,1,0] op_sel_hi:[0,1,1] neg_lo:[0,1,0]
    v_pk_fma_f32 v[162:163], v[160:161], v[8:9], v[2:3] op_sel:[0,0,0] op_sel_hi:[1,0,1]
    v_pk_fma_f32 v[2:3], v[162:163], v[8:9], v[164:165] op_sel:[1,1,0] op_sel_hi:[0,1,1] neg_lo:[0,1,0]
    v_pk_fma_f32 v[164:165], v[162:163], v[8:9], v[2:3] op_sel:[0,0,0] op_sel_hi:[1,0,1]
    v_pk_fma_f32 v[2:3], v[164:165], v[8:9], v[166:167] op_sel:[1,1,0] op_sel_hi:[0,1,1] neg_lo:[0,1,0]
    v_pk_fma_f32 v[166:167], v[164:165], v[8:9], v[2:3] op_sel:[0,0,0] op_sel_hi:[1,0,1]
    v_pk_fma_f32 v[2:3], v[166:167], v[8:9], v[168:169] op_sel:[1,1,0] op_sel_hi:[0,1,1] neg_lo:[0,1,0]
    v_pk_fma_f32 v[168:169], v[166:167], v[8:9], v[2:3] op_sel:[0,0,0] op_sel_hi:[1,0,1]
    v_pk_fma_f32 v[2:3], v[168:169], v[8:9], v[170:171] op_sel:[1,1,0] op_sel_hi:[0,1,1] neg_lo:[0,1,0]
    buffer_load_dwordx4 v21, s[24:27], s89 offen offset:1024 lds
    v_pk_fma_f32 v[170:171], v[168:169], v[8:9], v[2:3] op_sel:[0,0,0] op_sel_hi:[1,0,1]
    v_pk_fma_f32 v[2:3], v[170:171], v[8:9], v[172:173] op_sel:[1,1,0] op_sel_hi:[0,1,1] neg_lo:[0,1,0]
    v_pk_fma_f32 v[172:173], v[170:171], v[8:9], v[2:3] op_sel:[0,0,0] op_sel_hi:[1,0,1]
    v_pk_fma_f32 v[2:3], v[172:173], v[8:9], v[174:175] op_sel:[1,1,0] op_sel_hi:[0,1,1] neg_lo:[0,1,0]
    v_pk_fma_f32 v[174:175], v[172:173], v[8:9], v[2:3] op_sel:[0,0,0] op_sel_hi:[1,0,1]
    v_pk_fma_f32 v[2:3], v[174:175], v[8:9], v[176:177] op_sel:[1,1,0] op_sel_hi:[0,1,1] neg_lo:[0,1,0]
    v_pk_fma_f32 v[176:177], v[174:175], v[8:9], v[2:3] op_sel:[0,0,0] op_sel_hi:[1,0,1]
    v_pk_fma_f32 v[2:3], v[176:177], v[8:9], v[178:179] op_sel:[1,1,0] op_sel_hi:[0,1,1] neg_lo:[0,1,0]
    v_pk_fma_f32 v[178:179], v[176:177], v[8:9], v[2:3] op_sel:[0,0,0] op_sel_hi:[1,0,1]
    v_pk_fma_f32 v[2:3], v[178:179], v[8:9], v[180:181] op_sel:[1,1,0] op_sel_hi:[0,1,1] neg_lo:[0,1,0]
    v_pk_fma_f32 v[180:181], v[178:179], v[8:9], v[2:3] op_sel:[0,0,0] op_sel_hi:[1,0,1]
    buffer_load_dwordx4 v22, s[24:27], s89 offen offset:2048 lds
    v_pk_fma_f32 v[2:3], v[180:181], v[8:9], v[182:183] op_sel:[1,1,0] op_sel_hi:[0,1,1] neg_lo:[0,1,0]
    v_pk_fma_f32 v[182:183], v[180:181], v[8:9], v[2:3] op_sel:[0,0,0] op_sel_hi:[1,0,1]
    v_pk_fma_f32 v[2:3], v[182:183], v[8:9], v[184:185] op_sel:[1,1,0] op_sel_hi:[0,1,1] neg_lo:[0,1,0]
    v_pk_fma_f32 v[184:185], v[182:183], v[8:9], v[2:3] op_sel:[0,0,0] op_sel_hi:[1,0,1]
    v_pk_fma_f32 v[2:3], v[184:185], v[8:9], v[186:187] op_sel:[1,1,0] op_sel_hi:[0,1,1] neg_lo:[0,1,0]
    v_pk_fma_f32 v[186:187], v[184:185], v[8:9], v[2:3] op_sel:[0,0,0] op_sel_hi:[1,0,1]
    v_pk_fma_f32 v[2:3], v[186:187], v[8:9], v[188:189] op_sel:[1,1,0] op_sel_hi:[0,1,1] neg_lo:[0,1,0]
    v_pk_fma_f32 v[188:189], v[186:187], v[8:9], v[2:3] op_sel:[0,0,0] op_sel_hi:[1,0,1]
    v_pk_fma_f32 v[2:3], v[188:189], v[8:9], v[190:191] op_sel:[1,1,0] op_sel_hi:[0,1,1] neg_lo:[0,1,0]
    v_pk_fma_f32 v[190:191], v[188:189], v[8:9], v[2:3] op_sel:[0,0,0] op_sel_hi:[1,0,1]
    v_cvt_pk_bf16_f32 v68, v160, v162
    v_cvt_pk_bf16_f32 v69, v164, v166
    v_cvt_pk_bf16_f32 v70, v168, v170
    v_cvt_pk_bf16_f32 v71, v172, v174
    v_cvt_pk_bf16_f32 v72, v176, v178
    v_cvt_pk_bf16_f32 v73, v180, v182
    v_cvt_pk_bf16_f32 v74, v184, v186
    v_cvt_pk_bf16_f32 v75, v188, v190
    v_cvt_pk_bf16_f32 v76, -v161, -v163
    v_cvt_pk_bf16_f32 v77, -v165, -v167
    v_cvt_pk_bf16_f32 v78, -v169, -v171
    v_cvt_pk_bf16_f32 v79, -v173, -v175
    v_cvt_pk_bf16_f32 v80, -v177, -v179
    v_cvt_pk_bf16_f32 v81, -v181, -v183
    v_cvt_pk_bf16_f32 v82, -v185, -v187
    v_cvt_pk_bf16_f32 v83, -v189, -v191
    v_mov_b32 v4, v190
    v_mov_b32 v5, v191
    v_mfma_f32_32x32x16_bf16 v[160:175], v[68:71], v[60:63], 0
    s_add_u32 s79, s88, 0
    v_cvt_pk_bf16_f32 v36, v128, v129
    v_cvt_pk_bf16_f32 v37, v130, v131
    v_cvt_pk_bf16_f32 v38, v132, v133
    v_cvt_pk_bf16_f32 v39, v134, v135
    buffer_store_dwordx4 v[36:39], v54, s[12:15], s79 offen offset:1024 sc1
    v_mfma_f32_32x32x16_bf16 v[176:191], v[76:79], v[60:63], 0
    v_cvt_pk_bf16_f32 v40, v136, v137
    v_cvt_pk_bf16_f32 v41, v138, v139
    v_cvt_pk_bf16_f32 v42, v140, v141
    v_cvt_pk_bf16_f32 v43, v142, v143
    buffer_store_dwordx4 v[40:43], v54, s[12:15], s79 offen offset:3072 sc1
    v_mfma_f32_32x32x16_bf16 v[160:175], v[72:75], v[64:67], v[160:175]
    s_add_u32 s79, s88, 4096
    v_cvt_pk_bf16_f32 v44, v144, v145
    v_cvt_pk_bf16_f32 v45, v146, v147
    v_cvt_pk_bf16_f32 v46, v148, v149
    v_cvt_pk_bf16_f32 v47, v150, v151
    buffer_store_dwordx4 v[44:47], v54, s[12:15], s79 offen offset:1024 sc1
    v_mfma_f32_32x32x16_bf16 v[176:191], v[80:83], v[64:67], v[176:191]
    v_cvt_pk_bf16_f32 v48, v152, v153
    v_cvt_pk_bf16_f32 v49, v154, v155
    v_cvt_pk_bf16_f32 v50, v156, v157
    v_cvt_pk_bf16_f32 v51, v158, v159
    buffer_store_dwordx4 v[48:51], v54, s[12:15], s79 offen offset:3072 sc1
    v_pk_fma_f32 v[2:3], v[4:5], v[8:9], v[192:193] op_sel:[1,1,0] op_sel_hi:[0,1,1] neg_lo:[0,1,0]
    ds_read_b64_tr_b16 a[192:193], v28 offset:57344
    ds_read_b64_tr_b16 a[194:195], v28 offset:58368
    v_pk_fma_f32 v[192:193], v[4:5], v[8:9], v[2:3] op_sel:[0,0,0] op_sel_hi:[1,0,1]
    v_pk_fma_f32 v[2:3], v[192:193], v[8:9], v[194:195] op_sel:[1,1,0] op_sel_hi:[0,1,1] neg_lo:[0,1,0]
    v_pk_fma_f32 v[194:195], v[192:193], v[8:9], v[2:3] op_sel:[0,0,0] op_sel_hi:[1,0,1]
    v_pk_fma_f32 v[2:3], v[194:195], v[8:9], v[196:197] op_sel:[1,1,0] op_sel_hi:[0,1,1] neg_lo:[0,1,0]
    v_pk_fma_f32 v[196:197], v[194:195], v[8:9], v[2:3] op_sel:[0,0,0] op_sel_hi:[1,0,1]
    v_pk_fma_f32 v[2:3], v[196:197], v[8:9], v[198:199] op_sel:[1,1,0] op_sel_hi:[0,1,1] neg_lo:[0,1,0]
    v_pk_fma_f32 v[198:199], v[196:197], v[8:9], v[2:3] op_sel:[0,0,0] op_sel_hi:[1,0,1]
    v_pk_fma_f32 v[2:3], v[198:199], v[8:9], v[200:201] op_sel:[1,1,0] op_sel_hi:[0,1,1] neg_lo:[0,1,0]
    buffer_load_dwordx4 v23, s[24:27], s89 offen offset:3072 lds
    v_pk_fma_f32 v[200:201], v[198:199], v[8:9], v[2:3] op_sel:[0,0,0] op_sel_hi:[1,0,1]
    v_pk_fma_f32 v[2:3], v[200:201], v[8:9], v[202:203] op_sel:[1,1,0] op_sel_hi:[0,1,1] neg_lo:[0,1,0]
    v_pk_fma_f32 v[202:203], v[200:201], v[8:9], v[2:3] op_sel:[0,0,0] op_sel_hi:[1,0,1]
    v_pk_fma_f32 v[2:3], v[202:203], v[8:9], v[204:205] op_sel:[1,1,0] op_sel_hi:[0,1,1] neg_lo:[0,1,0]
    v_pk_fma_f32 v[204:205], v[202:203], v[8:9], v[2:3] op_sel:[0,0,0] op_sel_hi:[1,0,1]
    v_pk_fma_f32 v[2:3], v[204:205], v[8:9], v[206:207] op_sel:[1,1,0] op_sel_hi:[0,1,1] neg_lo:[0,1,0]
    v_pk_fma_f32 v[206:207], v[204:205], v[8:9], v[2:3] op_sel:[0,0,0] op_sel_hi:[1,0,1]
    v_pk_fma_f32 v[2:3], v[206:207], v[8:9], v[208:209] op_sel:[1,1,0] op_sel_hi:[0,1,1] neg_lo:[0,1,0]
    ds_read_b64_tr_b16 a[196:197], v29 offset:57344
    ds_read_b64_tr_b16 a[198:199], v29 offset:58368
    v_pk_fma_f32 v[208:209], v[206:207], v[8:9], v[2:3] op_sel:[0,0,0] op_sel_hi:[1,0,1]
    v_pk_fma_f32 v[2:3], v[208:209], v[8:9], v[210:211] op_sel:[1,1,0] op_sel_hi:[0,1,1] neg_lo:[0,1,0]
    v_pk_fma_f32 v[210:211], v[208:209], v[8:9], v[2:3] op_sel:[0,0,0] op_sel_hi:[1,0,1]
    v_pk_fma_f32 v[2:3], v[210:211], v[8:9], v[212:213] op_sel:[1,1,0] op_sel_hi:[0,1,1] neg_lo:[0,1,0]
    v_pk_fma_f32 v[212:213], v[210:211], v[8:9], v[2:3] op_sel:[0,0,0] op_sel_hi:[1,0,1]
    v_pk_fma_f32 v[2:3], v[212:213], v[8:9], v[214:215] op_sel:[1,1,0] op_sel_hi:[0,1,1] neg_lo:[0,1,0]
    v_pk_fma_f32 v[214:215], v[212:213], v[8:9], v[2:3] op_sel:[0,0,0] op_sel_hi:[1,0,1]
    v_pk_fma_f32 v[2:3], v[214:215], v[8:9], v[216:217] op_sel:[1,1,0] op_sel_hi:[0,1,1] neg_lo:[0,1,0]
    s_add_u32 m0, s78, 8192
    s_add_u32 s89, s87, 196608
    buffer_load_dwordx4 v20, s[24:27], s89 offen offset:0 lds
    v_pk_fma_f32 v[216:217], v[214:215], v[8:9], v[2:3] op_sel:[0,0,0] op_sel_hi:[1,0,1]
    v_pk_fma_f32 v[2:3], v[216:217], v[8:9], v[218:219] op_sel:[1,1,0] op_sel_hi:[0,1,1] neg_lo:[0,1,0]
    v_pk_fma_f32 v[218:219], v[216:217], v[8:9], v[2:3] op_sel:[0,0,0] op_sel_hi:[1,0,1]
    v_pk_fma_f32 v[2:3], v[218:219], v[8:9], v[220:221] op_sel:[1,1,0] op_sel_hi:[0,1,1] neg_lo:[0,1,0]
    v_pk_fma_f32 v[220:221], v[218:219], v[8:9], v[2:3] op_sel:[0,0,0] op_sel_hi:[1,0,1]
    v_pk_fma_f32 v[2:3], v[220:221], v[8:9], v[222:223] op_sel:[1,1,0] op_sel_hi:[0,1,1] neg_lo:[0,1,0]
    v_pk_fma_f32 v[222:223], v[220:221], v[8:9], v[2:3] op_sel:[0,0,0] op_sel_hi:[1,0,1]
    v_cvt_pk_bf16_f32 v68, v192, v194
    v_cvt_pk_bf16_f32 v69, v196, v198
    v_cvt_pk_bf16_f32 v70, v200, v202
    v_cvt_pk_bf16_f32 v71, v204, v206
    v_cvt_pk_bf16_f32 v72, v208, v210
    v_cvt_pk_bf16_f32 v73, v212, v214
    v_cvt_pk_bf16_f32 v74, v216, v218
    v_cvt_pk_bf16_f32 v75, v220, v222
    v_cvt_pk_bf16_f32 v76, -v193, -v195
    v_cvt_pk_bf16_f32 v77, -v197, -v199
    v_cvt_pk_bf16_f32 v78, -v201, -v203
    v_cvt_pk_bf16_f32 v79, -v205, -v207
    v_cvt_pk_bf16_f32 v80, -v209, -v211
    v_cvt_pk_bf16_f32 v81, -v213, -v215
    v_cvt_pk_bf16_f32 v82, -v217, -v219
    v_cvt_pk_bf16_f32 v83, -v221, -v223
    v_mov_b32 v4, v222
    v_mov_b32 v5, v223
    v_mfma_f32_32x32x16_bf16 v[192:207], v[68:71], v[60:63], 0
    s_add_u32 s79, s88, 131072
    v_cvt_pk_bf16_f32 v36, v160, v161
    v_cvt_pk_bf16_f32 v37, v162, v163
    v_cvt_pk_bf16_f32 v38, v164, v165
    v_cvt_pk_bf16_f32 v39, v166, v167
    buffer_store_dwordx4 v[36:39], v54, s[12:15], s79 offen offset:0 sc1
    v_mfma_f32_32x32x16_bf16 v[208:223], v[76:79], v[60:63], 0
    v_cvt_pk_bf16_f32 v40, v168, v169
    v_cvt_pk_bf16_f32 v41, v170, v171
    v_cvt_pk_bf16_f32 v42, v172, v173
    v_cvt_pk_bf16_f32 v43, v174, v175
    buffer_store_dwordx4 v[40:43], v54, s[12:15], s79 offen offset:2048 sc1
    v_mfma_f32_32x32x16_bf16 v[192:207], v[72:75], v[64:67], v[192:207]
    s_add_u32 s79, s88, 135168
    v_cvt_pk_bf16_f32 v44, v176, v177
    v_cvt_pk_bf16_f32 v45, v178, v179
    v_cvt_pk_bf16_f32 v46, v180, v181
    v_cvt_pk_bf16_f32 v47, v182, v183
    buffer_store_dwordx4 v[44:47], v54, s[12:15], s79 offen offset:0 sc1
    v_mfma_f32_32x32x16_bf16 v[208:223], v[80:83], v[64:67], v[208:223]
    v_cvt_pk_bf16_f32 v48, v184, v185
    v_cvt_pk_bf16_f32 v49, v186, v187
    v_cvt_pk_bf16_f32 v50, v188, v189
    v_cvt_pk_bf16_f32 v51, v190, v191
    buffer_store_dwordx4 v[48:51], v54, s[12:15], s79 offen offset:2048 sc1
    s_nop 11
    s_add_u32 s79, s88, 131072
    v_cvt_pk_bf16_f32 v36, v192, v193
    v_cvt_pk_bf16_f32 v37, v194, v195
    v_cvt_pk_bf16_f32 v38, v196, v197
    v_cvt_pk_bf16_f32 v39, v198, v199
    buffer_store_dwordx4 v[36:39], v54, s[12:15], s79 offen offset:1024 sc1
    v_cvt_pk_bf16_f32 v40, v200, v201
    v_cvt_pk_bf16_f32 v41, v202, v203
    v_cvt_pk_bf16_f32 v42, v204, v205
    v_cvt_pk_bf16_f32 v43, v206, v207
    buffer_store_dwordx4 v[40:43], v54, s[12:15], s79 offen offset:3072 sc1
    s_add_u32 s79, s88, 135168
    v_cvt_pk_bf16_f32 v44, v208, v209
    v_cvt_pk_bf16_f32 v45, v210, v211
    v_cvt_pk_bf16_f32 v46, v212, v213
    v_cvt_pk_bf16_f32 v47, v214, v215
    buffer_store_dwordx4 v[44:47], v54, s[12:15], s79 offen offset:1024 sc1
    v_cvt_pk_bf16_f32 v48, v216, v217
    v_cvt_pk_bf16_f32 v49, v218, v219
    v_cvt_pk_bf16_f32 v50, v220, v221
    v_cvt_pk_bf16_f32 v51, v222, v223
    buffer_store_dwordx4 v[48:51], v54, s[12:15], s79 offen offset:3072 sc1
    buffer_load_dword v92, v89, s[12:15], s74 offen sc1
    ds_read_b64_tr_b16 a[200:201], v28 offset:59392
    ds_read_b64_tr_b16 a[202:203], v28 offset:60416
    buffer_load_dwordx4 v21, s[24:27], s89 offen offset:1024 lds
    ds_read_b64_tr_b16 a[204:205], v29 offset:59392
    ds_read_b64_tr_b16 a[206:207], v29 offset:60416
    buffer_load_dwordx4 v22, s[24:27], s89 offen offset:2048 lds
    buffer_load_dwordx4 v23, s[24:27], s89 offen offset:3072 lds
    s_waitcnt lgkmcnt(0)
    s_add_u32 m0, s78, 49152
    s_add_u32 s89, s87, 229376
    buffer_load_dwordx4 v20, s[24:27], s89 offen offset:0 lds
    ds_read_b64_tr_b16 a[208:209], v30 offset:0
    ds_read_b64_tr_b16 a[210:211], v30 offset:1024
    buffer_load_dwordx4 v21, s[24:27], s89 offen offset:1024 lds
    ds_read_b64_tr_b16 a[212:213], v31 offset:0
    ds_read_b64_tr_b16 a[214:215], v31 offset:1024
    buffer_load_dwordx4 v22, s[24:27], s89 offen offset:2048 lds
    ds_read_b64_tr_b16 a[216:217], v30 offset:2048
    ds_read_b64_tr_b16 a[218:219], v30 offset:3072
    buffer_load_dwordx4 v23, s[24:27], s89 offen offset:3072 lds
    ds_read_b64_tr_b16 a[220:221], v31 offset:2048
    ds_read_b64_tr_b16 a[222:223], v31 offset:3072
    s_add_u32 m0, s78, 53248
    s_add_u32 s89, s87, 262144
    buffer_load_dwordx4 v20, s[24:27], s89 offen offset:0 lds
    ds_read_b64_tr_b16 a[224:225], v30 offset:4096
    ds_read_b64_tr_b16 a[226:227], v30 offset:5120
    buffer_load_dwordx4 v21, s[24:27], s89 offen offset:1024 lds
    ds_read_b64_tr_b16 a[228:229], v31 offset:4096
    ds_read_b64_tr_b16 a[230:231], v31 offset:5120
    ds_read_b64_tr_b16 a[232:233], v30 offset:6144
    ds_read_b64_tr_b16 a[234:235], v30 offset:7168
    buffer_load_dwordx4 v22, s[24:27], s89 offen offset:2048 lds
    ds_read_b64_tr_b16 a[236:237], v31 offset:6144
    ds_read_b64_tr_b16 a[238:239], v31 offset:7168
    buffer_load_dwordx4 v23, s[24:27], s89 offen offset:3072 lds
    ds_read_b64_tr_b16 a[240:241], v30 offset:8192
    ds_read_b64_tr_b16 a[242:243], v30 offset:9216
    s_add_u32 m0, s78, 57344
    s_add_u32 s89, s87, 294912
    buffer_load_dwordx4 v20, s[24:27], s89 offen offset:0 lds
    ds_read_b64_tr_b16 a[244:245], v31 offset:8192
    ds_read_b64_tr_b16 a[246:247], v31 offset:9216
    buffer_load_dwordx4 v21, s[24:27], s89 offen offset:1024 lds
    ds_read_b64_tr_b16 a[248:249], v30 offset:10240
    ds_read_b64_tr_b16 a[250:251], v30 offset:11264
    buffer_load_dwordx4 v22, s[24:27], s89 offen offset:2048 lds
    ds_read_b64_tr_b16 a[252:253], v31 offset:10240
    ds_read_b64_tr_b16 a[254:255], v31 offset:11264
    buffer_load_dwordx4 v23, s[24:27], s89 offen offset:3072 lds
    s_waitcnt lgkmcnt(0)
    s_add_u32 m0, s77, 0
    s_add_u32 s89, s87, 327680
    buffer_load_dwordx4 v20, s[24:27], s89 offen offset:0 lds
    buffer_load_dwordx4 v21, s[24:27], s89 offen offset:1024 lds
    buffer_load_dwordx4 v22, s[24:27], s89 offen offset:2048 lds
    buffer_load_dwordx4 v23, s[24:27], s89 offen offset:3072 lds
    s_waitcnt vmcnt(20)
    v_mov_b32 v2, 1
    s_mov_b64 exec, 1
    buffer_store_dword v2, v91, s[12:15], s75 offen sc1
    s_mov_b64 exec, -1
    s_waitcnt vmcnt(20)
    s_mov_b32 s83, 200000
    s_branch Lpchk_14
Lpoll_12:
    buffer_load_dword v92, v89, s[12:15], s74 offen sc1
    s_waitcnt vmcnt(0)
Lpchk_14:
    v_cmp_ne_u32 vcc, 0, v92
    s_nop 1
    s_cmp_eq_u64 vcc, -1
    s_cbranch_scc1 Lpdone_13
    s_sub_u32 s83, s83, 1
    s_cbranch_scc1 Lpdone_13
    s_sleep 1
    s_branch Lpoll_12
Lpdone_13:
    s_branch L_phase2
L_stats:
    s_sub_u32 s66, s66, 22
    s_lshl_b32 s79, s65, 1
    s_add_u32 s92, s79, s66
    s_lshl_b32 s79, s92, 7
    s_lshl_b32 s80, s64, 5
    s_add_u32 s93, s79, s80
    v_add_u32 v2, s93, v8
    v_lshlrev_b32 v2, 10, v2
    v_and_b32 v3, 15, v1
    v_lshl_add_u32 v2, v3, 4, v2
    s_waitcnt lgkmcnt(0)
    s_mov_b32 s4, s32
    s_mov_b32 s5, s33
    s_mov_b32 s79, 0
    buffer_load_dwordx4 v[128:131], v2, s[4:7], s79 offen offset:0
    buffer_load_dwordx4 v[132:135], v2, s[4:7], s79 offen offset:256
    buffer_load_dwordx4 v[136:139], v2, s[4:7], s79 offen offset:512
    buffer_load_dwordx4 v[140:143], v2, s[4:7], s79 offen offset:768
    s_mov_b32 s79, 4096
    buffer_load_dwordx4 v[144:147], v2, s[4:7], s79 offen offset:0
    buffer_load_dwordx4 v[148:151], v2, s[4:7], s79 offen offset:256
    buffer_load_dwordx4 v[152:155], v2, s[4:7], s79 offen offset:512
    buffer_load_dwordx4 v[156:159], v2, s[4:7], s79 offen offset:768
    s_mov_b32 s79, 8192
    buffer_load_dwordx4 v[160:163], v2, s[4:7], s79 offen offset:0
    buffer_load_dwordx4 v[164:167], v2, s[4:7], s79 offen offset:256
    buffer_load_dwordx4 v[168:171], v2, s[4:7], s79 offen offset:512
    buffer_load_dwordx4 v[172:175], v2, s[4:7], s79 offen offset:768
    s_mov_b32 s79, 12288
    buffer_load_dwordx4 v[176:179], v2, s[4:7], s79 offen offset:0
    buffer_load_dwordx4 v[180:183], v2, s[4:7], s79 offen offset:256
    buffer_load_dwordx4 v[184:187], v2, s[4:7], s79 offen offset:512
    buffer_load_dwordx4 v[188:191], v2, s[4:7], s79 offen offset:768
    s_mov_b32 s79, 16384
    buffer_load_dwordx4 v[192:195], v2, s[4:7], s79 offen offset:0
    buffer_load_dwordx4 v[196:199], v2, s[4:7], s79 offen offset:256
    buffer_load_dwordx4 v[200:203], v2, s[4:7], s79 offen offset:512
    buffer_load_dwordx4 v[204:207], v2, s[4:7], s79 offen offset:768
    s_mov_b32 s79, 20480
    buffer_load_dwordx4 v[208:211], v2, s[4:7], s79 offen offset:0
    buffer_load_dwordx4 v[212:215], v2, s[4:7], s79 offen offset:256
    buffer_load_dwordx4 v[216:219], v2, s[4:7], s79 offen offset:512
    buffer_load_dwordx4 v[220:223], v2, s[4:7], s79 offen offset:768
    s_mov_b32 s79, 24576
    buffer_load_dwordx4 v[224:227], v2, s[4:7], s79 offen offset:0
    buffer_load_dwordx4 v[228:231], v2, s[4:7], s79 offen offset:256
    buffer_load_dwordx4 v[232:235], v2, s[4:7], s79 offen offset:512
    buffer_load_dwordx4 v[236:239], v2, s[4:7], s79 offen offset:768
    s_mov_b32 s79, 28672
    buffer_load_dwordx4 v[240:243], v2, s[4:7], s79 offen offset:0
    buffer_load_dwordx4 v[244:247], v2, s[4:7], s79 offen offset:256
    buffer_load_dwordx4 v[248:251], v2, s[4:7], s79 offen offset:512
    buffer_load_dwordx4 v[252:255], v2, s[4:7], s79 offen offset:768
    s_mov_b32 s84, 0xffff0000
    s_mov_b32 s12, s62
    s_mov_b32 s13, s63
    s_mov_b32 s14, 11534336
    s_mov_b32 s15, 0x00020000
    s_mov_b32 s16, s42
    s_mov_b32 s17, s43
    s_mov_b32 s18, 524288
    s_mov_b32 s19, 0x00020000
    s_mov_b32 s20, s44
    s_mov_b32 s21, s45
    s_mov_b32 s22, 524288
    s_mov_b32 s23, 0x00020000
    s_mov_b32 s24, s56
    s_mov_b32 s25, s57
    s_mov_b32 s26, 1409024
    s_mov_b32 s27, 0x00020000
    s_bfe_u32 s68, s2, 0x20003
    s_lshr_b32 s69, s2, 6
    s_and_b32 s82, s2, 1
    s_lshl_b32 s82, s82, 2
    s_add_u32 s69, s69, s82
    s_and_b32 s67, s2, 6
    s_bfe_u32 s81, s2, 0x10005
    s_add_u32 s67, s67, s81
    s_mul_i32 s78, s64, 12288
    s_add_u32 s77, s78, 98304
    s_lshl_b32 s85, s64, 8
    s_lshl_b32 s81, s70, 15
    s_add_u32 s86, s85, 32768
    s_sub_u32 s86, s86, s81
    s_add_u32 s85, s85, s81
    s_mul_i32 s87, s64, 360448
    s_lshl_b32 s81, s69, 6
    v_add_u32 v11, s81, v6
    v_lshlrev_b32 v11, 10, v11
    v_add_u32 v12, v11, v9
    v_add_u32 v13, v11, v10
    v_add_u32 v16, 0, v12
    v_add_u32 v17, 7168, v13
    v_add_u32 v18, 14336, v12
    v_add_u32 v19, 21504, v13
    s_lshl_b32 s81, s69, 7
    v_lshl_add_u32 v11, v6, 10, v14
    v_add_u32 v11, s81, v11
    v_add_u32 v20, 0, v11
    v_add_u32 v21, 7168, v11
    v_add_u32 v22, 14336, v11
    v_add_u32 v23, 21504, v11
    v_mov_b32 v4, 0
    v_mov_b32 v5, 0
    v_mov_b32 v6, 0
    v_mov_b32 v7, 0
    s_lshl_b32 s79, s92, 13
    s_add_u32 s79, s79, 10616832
    s_add_u32 s80, s79, 4096
    s_lshl_b32 s81, s64, 10
    v_lshl_add_u32 v9, v1, 4, s81
    buffer_store_dwordx4 v[4:7], v9, s[12:15], s79 offen sc1
    buffer_store_dwordx4 v[4:7], v9, s[12:15], s80 offen sc1
    s_lshl_b32 s79, s92, 13
    s_lshl_b32 s80, s64, 11
    s_add_u32 s79, s79, s80
    s_add_u32 s79, s79, 10747904
    v_lshlrev_b32 v9, 7, v3
    buffer_store_dword v4, v9, s[12:15], s79 offen sc1
    s_or_b32 s79, s92, s64
    s_mov_b32 s80, 10584064
    s_cmp_eq_u32 s79, 0
    s_cselect_b32 s79, s80, 2130706432
    v_mov_b32 v9, s79
    v_mov_b32 v80, 0
    v_mov_b32 v81, 1
    v_mov_b32 v82, 0
    v_mov_b32 v83, 1
    s_mov_b64 exec, 1
    buffer_store_dwordx4 v[80:83], v9, s[12:15], 0 offen sc1
    s_mov_b64 exec, -1
    s_lshl_b32 s81, s2, 2
    s_add_u32 s81, s81, s64
    s_mul_i32 s82, s81, 1408
    s_lshl_b32 s81, s81, 9
    v_lshlrev_b32 v2, 7, v1
    s_mov_b64 exec, 0x7ff
    buffer_load_dword v0, v2, s[24:27], s82 offen
    s_mov_b64 exec, 15
    buffer_load_dword v0, v2, s[16:19], s81 offen
    buffer_load_dword v0, v2, s[20:23], s81 offen
    s_mov_b64 exec, -1
    v_mov_b32 v10, 0x3f803f80
    s_waitcnt vmcnt(35)
    v_dot2_f32_bf16 v64, v128, v10, 0
    v_dot2_f32_bf16 v72, v128, v128, 0
    s_nop 1
    v_dot2_f32_bf16 v64, v129, v10, v64
    v_dot2_f32_bf16 v72, v129, v129, v72
    v_dot2_f32_bf16 v64, v130, v10, v64
    v_dot2_f32_bf16 v72, v130, v130, v72
    v_dot2_f32_bf16 v64, v131, v10, v64
    v_dot2_f32_bf16 v72, v131, v131, v72
    v_dot2_f32_bf16 v64, v132, v10, v64
    v_dot2_f32_bf16 v72, v132, v132, v72
    v_dot2_f32_bf16 v64, v133, v10, v64
    v_dot2_f32_bf16 v72, v133, v133, v72
    v_dot2_f32_bf16 v64, v134, v10, v64
    v_dot2_f32_bf16 v72, v134, v134, v72
    v_dot2_f32_bf16 v64, v135, v10, v64
    v_dot2_f32_bf16 v72, v135, v135, v72
    v_dot2_f32_bf16 v64, v136, v10, v64
    v_dot2_f32_bf16 v72, v136, v136, v72
    v_dot2_f32_bf16 v64, v137, v10, v64
    v_dot2_f32_bf16 v72, v137, v137, v72
    v_dot2_f32_bf16 v64, v138, v10, v64
    v_dot2_f32_bf16 v72, v138, v138, v72
    v_dot2_f32_bf16 v64, v139, v10, v64
    v_dot2_f32_bf16 v72, v139, v139, v72
    v_dot2_f32_bf16 v64, v140, v10, v64
    v_dot2_f32_bf16 v72, v140, v140, v72
    v_dot2_f32_bf16 v64, v141, v10, v64
    v_dot2_f32_bf16 v72, v141, v141, v72
    v_dot2_f32_bf16 v64, v142, v10, v64
    v_dot2_f32_bf16 v72, v142, v142, v72
    v_dot2_f32_bf16 v64, v143, v10, v64
    v_dot2_f32_bf16 v72, v143, v143, v72
    s_waitcnt vmcnt(31)
    v_dot2_f32_bf16 v65, v144, v10, 0
    v_dot2_f32_bf16 v73, v144, v144, 0
    s_nop 1
    v_dot2_f32_bf16 v65, v145, v10, v65
    v_dot2_f32_bf16 v73, v145, v145, v73
    v_dot2_f32_bf16 v65, v146, v10, v65
    v_dot2_f32_bf16 v73, v146, v146, v73
    v_dot2_f32_bf16 v65, v147, v10, v65
    v_dot2_f32_bf16 v73, v147, v147, v73
    v_dot2_f32_bf16 v65, v148, v10, v65
    v_dot2_f32_bf16 v73, v148, v148, v73
    v_dot2_f32_bf16 v65, v149, v10, v65
    v_dot2_f32_bf16 v73, v149, v149, v73
    v_dot2_f32_bf16 v65, v150, v10, v65
    v_dot2_f32_bf16 v73, v150, v150, v73
    v_dot2_f32_bf16 v65, v151, v10, v65
    v_dot2_f32_bf16 v73, v151, v151, v73
    v_dot2_f32_bf16 v65, v152, v10, v65
    v_dot2_f32_bf16 v73, v152, v152, v73
    v_dot2_f32_bf16 v65, v153, v10, v65
    v_dot2_f32_bf16 v73, v153, v153, v73
    v_dot2_f32_bf16 v65, v154, v10, v65
    v_dot2_f32_bf16 v73, v154, v154, v73
    v_dot2_f32_bf16 v65, v155, v10, v65
    v_dot2_f32_bf16 v73, v155, v155, v73
    v_dot2_f32_bf16 v65, v156, v10, v65
    v_dot2_f32_bf16 v73, v156, v156, v73
    v_dot2_f32_bf16 v65, v157, v10, v65
    v_dot2_f32_bf16 v73, v157, v157, v73
    v_dot2_f32_bf16 v65, v158, v10, v65
    v_dot2_f32_bf16 v73, v158, v158, v73
    v_dot2_f32_bf16 v65, v159, v10, v65
    v_dot2_f32_bf16 v73, v159, v159, v73
    s_waitcnt vmcnt(27)
    v_dot2_f32_bf16 v66, v160, v10, 0
    v_dot2_f32_bf16 v74, v160, v160, 0
    s_nop 1
    v_dot2_f32_bf16 v66, v161, v10, v66
    v_dot2_f32_bf16 v74, v161, v161, v74
    v_dot2_f32_bf16 v66, v162, v10, v66
    v_dot2_f32_bf16 v74, v162, v162, v74
    v_dot2_f32_bf16 v66, v163, v10, v66
    v_dot2_f32_bf16 v74, v163, v163, v74
    v_dot2_f32_bf16 v66, v164, v10, v66
    v_dot2_f32_bf16 v74, v164, v164, v74
    v_dot2_f32_bf16 v66, v165, v10, v66
    v_dot2_f32_bf16 v74, v165, v165, v74
    v_dot2_f32_bf16 v66, v166, v10, v66
    v_dot2_f32_bf16 v74, v166, v166, v74
    v_dot2_f32_bf16 v66, v167, v10, v66
    v_dot2_f32_bf16 v74, v167, v167, v74
    v_dot2_f32_bf16 v66, v168, v10, v66
    v_dot2_f32_bf16 v74, v168, v168, v74
    v_dot2_f32_bf16 v66, v169, v10, v66
    v_dot2_f32_bf16 v74, v169, v169, v74
    v_dot2_f32_bf16 v66, v170, v10, v66
    v_dot2_f32_bf16 v74, v170, v170, v74
    v_dot2_f32_bf16 v66, v171, v10, v66
    v_dot2_f32_bf16 v74, v171, v171, v74
    v_dot2_f32_bf16 v66, v172, v10, v66
    v_dot2_f32_bf16 v74, v172, v172, v74
    v_dot2_f32_bf16 v66, v173, v10, v66
    v_dot2_f32_bf16 v74, v173, v173, v74
    v_dot2_f32_bf16 v66, v174, v10, v66
    v_dot2_f32_bf16 v74, v174, v174, v74
    v_dot2_f32_bf16 v66, v175, v10, v66
    v_dot2_f32_bf16 v74, v175, v175, v74
    s_waitcnt vmcnt(23)
    v_dot2_f32_bf16 v67, v176, v10, 0
    v_dot2_f32_bf16 v75, v176, v176, 0
    s_nop 1
    v_dot2_f32_bf16 v67, v177, v10, v67
    v_dot2_f32_bf16 v75, v177, v177, v75
    v_dot2_f32_bf16 v67, v178, v10, v67
    v_dot2_f32_bf16 v75, v178, v178, v75
    v_dot2_f32_bf16 v67, v179, v10, v67
    v_dot2_f32_bf16 v75, v179, v179, v75
    v_dot2_f32_bf16 v67, v180, v10, v67
    v_dot2_f32_bf16 v75, v180, v180, v75
    v_dot2_f32_bf16 v67, v181, v10, v67
    v_dot2_f32_bf16 v75, v181, v181, v75
    v_dot2_f32_bf16 v67, v182, v10, v67
    v_dot2_f32_bf16 v75, v182, v182, v75
    v_dot2_f32_bf16 v67, v183, v10, v67
    v_dot2_f32_bf16 v75, v183, v183, v75
    v_dot2_f32_bf16 v67, v184, v10, v67
    v_dot2_f32_bf16 v75, v184, v184, v75
    v_dot2_f32_bf16 v67, v185, v10, v67
    v_dot2_f32_bf16 v75, v185, v185, v75
    v_dot2_f32_bf16 v67, v186, v10, v67
    v_dot2_f32_bf16 v75, v186, v186, v75
    v_dot2_f32_bf16 v67, v187, v10, v67
    v_dot2_f32_bf16 v75, v187, v187, v75
    v_dot2_f32_bf16 v67, v188, v10, v67
    v_dot2_f32_bf16 v75, v188, v188, v75
    v_dot2_f32_bf16 v67, v189, v10, v67
    v_dot2_f32_bf16 v75, v189, v189, v75
    v_dot2_f32_bf16 v67, v190, v10, v67
    v_dot2_f32_bf16 v75, v190, v190, v75
    v_dot2_f32_bf16 v67, v191, v10, v67
    v_dot2_f32_bf16 v75, v191, v191, v75
    s_waitcnt vmcnt(19)
    v_dot2_f32_bf16 v68, v192, v10, 0
    v_dot2_f32_bf16 v76, v192, v192, 0
    s_nop 1
    v_dot2_f32_bf16 v68, v193, v10, v68
    v_dot2_f32_bf16 v76, v193, v193, v76
    v_dot2_f32_bf16 v68, v194, v10, v68
    v_dot2_f32_bf16 v76, v194, v194, v76
    v_dot2_f32_bf16 v68, v195, v10, v68
    v_dot2_f32_bf16 v76, v195, v195, v76
    v_dot2_f32_bf16 v68, v196, v10, v68
    v_dot2_f32_bf16 v76, v196, v196, v76
    v_dot2_f32_bf16 v68, v197, v10, v68
    v_dot2_f32_bf16 v76, v197, v197, v76
    v_dot2_f32_bf16 v68, v198, v10, v68
    v_dot2_f32_bf16 v76, v198, v198, v76
    v_dot2_f32_bf16 v68, v199, v10, v68
    v_dot2_f32_bf16 v76, v199, v199, v76
    v_dot2_f32_bf16 v68, v200, v10, v68
    v_dot2_f32_bf16 v76, v200, v200, v76
    v_dot2_f32_bf16 v68, v201, v10, v68
    v_dot2_f32_bf16 v76, v201, v201, v76
    v_dot2_f32_bf16 v68, v202, v10, v68
    v_dot2_f32_bf16 v76, v202, v202, v76
    v_dot2_f32_bf16 v68, v203, v10, v68
    v_dot2_f32_bf16 v76, v203, v203, v76
    v_dot2_f32_bf16 v68, v204, v10, v68
    v_dot2_f32_bf16 v76, v204, v204, v76
    v_dot2_f32_bf16 v68, v205, v10, v68
    v_dot2_f32_bf16 v76, v205, v205, v76
    v_dot2_f32_bf16 v68, v206, v10, v68
    v_dot2_f32_bf16 v76, v206, v206, v76
    v_dot2_f32_bf16 v68, v207, v10, v68
    v_dot2_f32_bf16 v76, v207, v207, v76
    s_waitcnt vmcnt(15)
    v_dot2_f32_bf16 v69, v208, v10, 0
    v_dot2_f32_bf16 v77, v208, v208, 0
    s_nop 1
    v_dot2_f32_bf16 v69, v209, v10, v69
    v_dot2_f32_bf16 v77, v209, v209, v77
    v_dot2_f32_bf16 v69, v210, v10, v69
    v_dot2_f32_bf16 v77, v210, v210, v77
    v_dot2_f32_bf16 v69, v211, v10, v69
    v_dot2_f32_bf16 v77, v211, v211, v77
    v_dot2_f32_bf16 v69, v212, v10, v69
    v_dot2_f32_bf16 v77, v212, v212, v77
    v_dot2_f32_bf16 v69, v213, v10, v69
    v_dot2_f32_bf16 v77, v213, v213, v77
    v_dot2_f32_bf16 v69, v214, v10, v69
    v_dot2_f32_bf16 v77, v214, v214, v77
    v_dot2_f32_bf16 v69, v215, v10, v69
    v_dot2_f32_bf16 v77, v215, v215, v77
    v_dot2_f32_bf16 v69, v216, v10, v69
    v_dot2_f32_bf16 v77, v216, v216, v77
    v_dot2_f32_bf16 v69, v217, v10, v69
    v_dot2_f32_bf16 v77, v217, v217, v77
    v_dot2_f32_bf16 v69, v218, v10, v69
    v_dot2_f32_bf16 v77, v218, v218, v77
    v_dot2_f32_bf16 v69, v219, v10, v69
    v_dot2_f32_bf16 v77, v219, v219, v77
    v_dot2_f32_bf16 v69, v220, v10, v69
    v_dot2_f32_bf16 v77, v220, v220, v77
    v_dot2_f32_bf16 v69, v221, v10, v69
    v_dot2_f32_bf16 v77, v221, v221, v77
    v_dot2_f32_bf16 v69, v222, v10, v69
    v_dot2_f32_bf16 v77, v222, v222, v77
    v_dot2_f32_bf16 v69, v223, v10, v69
    v_dot2_f32_bf16 v77, v223, v223, v77
    s_waitcnt vmcnt(11)
    v_dot2_f32_bf16 v70, v224, v10, 0
    v_dot2_f32_bf16 v78, v224, v224, 0
    s_nop 1
    v_dot2_f32_bf16 v70, v225, v10, v70
    v_dot2_f32_bf16 v78, v225, v225, v78
    v_dot2_f32_bf16 v70, v226, v10, v70
    v_dot2_f32_bf16 v78, v226, v226, v78
    v_dot2_f32_bf16 v70, v227, v10, v70
    v_dot2_f32_bf16 v78, v227, v227, v78
    v_dot2_f32_bf16 v70, v228, v10, v70
    v_dot2_f32_bf16 v78, v228, v228, v78
    v_dot2_f32_bf16 v70, v229, v10, v70
    v_dot2_f32_bf16 v78, v229, v229, v78
    v_dot2_f32_bf16 v70, v230, v10, v70
    v_dot2_f32_bf16 v78, v230, v230, v78
    v_dot2_f32_bf16 v70, v231, v10, v70
    v_dot2_f32_bf16 v78, v231, v231, v78
    v_dot2_f32_bf16 v70, v232, v10, v70
    v_dot2_f32_bf16 v78, v232, v232, v78
    v_dot2_f32_bf16 v70, v233, v10, v70
    v_dot2_f32_bf16 v78, v233, v233, v78
    v_dot2_f32_bf16 v70, v234, v10, v70
    v_dot2_f32_bf16 v78, v234, v234, v78
    v_dot2_f32_bf16 v70, v235, v10, v70
    v_dot2_f32_bf16 v78, v235, v235, v78
    v_dot2_f32_bf16 v70, v236, v10, v70
    v_dot2_f32_bf16 v78, v236, v236, v78
    v_dot2_f32_bf16 v70, v237, v10, v70
    v_dot2_f32_bf16 v78, v237, v237, v78
    v_dot2_f32_bf16 v70, v238, v10, v70
    v_dot2_f32_bf16 v78, v238, v238, v78
    v_dot2_f32_bf16 v70, v239, v10, v70
    v_dot2_f32_bf16 v78, v239, v239, v78
    s_waitcnt vmcnt(7)
    v_dot2_f32_bf16 v71, v240, v10, 0
    v_dot2_f32_bf16 v79, v240, v240, 0
    s_nop 1
    v_dot2_f32_bf16 v71, v241, v10, v71
    v_dot2_f32_bf16 v79, v241, v241, v79
    v_dot2_f32_bf16 v71, v242, v10, v71
    v_dot2_f32_bf16 v79, v242, v242, v79
    v_dot2_f32_bf16 v71, v243, v10, v71
    v_dot2_f32_bf16 v79, v243, v243, v79
    v_dot2_f32_bf16 v71, v244, v10, v71
    v_dot2_f32_bf16 v79, v244, v244, v79
    v_dot2_f32_bf16 v71, v245, v10, v71
    v_dot2_f32_bf16 v79, v245, v245, v79
    v_dot2_f32_bf16 v71, v246, v10, v71
    v_dot2_f32_bf16 v79, v246, v246, v79
    v_dot2_f32_bf16 v71, v247, v10, v71
    v_dot2_f32_bf16 v79, v247, v247, v79
    v_dot2_f32_bf16 v71, v248, v10, v71
    v_dot2_f32_bf16 v79, v248, v248, v79
    v_dot2_f32_bf16 v71, v249, v10, v71
    v_dot2_f32_bf16 v79, v249, v249, v79
    v_dot2_f32_bf16 v71, v250, v10, v71
    v_dot2_f32_bf16 v79, v250, v250, v79
    v_dot2_f32_bf16 v71, v251, v10, v71
    v_dot2_f32_bf16 v79, v251, v251, v79
    v_dot2_f32_bf16 v71, v252, v10, v71
    v_dot2_f32_bf16 v79, v252, v252, v79
    v_dot2_f32_bf16 v71, v253, v10, v71
    v_dot2_f32_bf16 v79, v253, v253, v79
    v_dot2_f32_bf16 v71, v254, v10, v71
    v_dot2_f32_bf16 v79, v254, v254, v79
    v_dot2_f32_bf16 v71, v255, v10, v71
    v_dot2_f32_bf16 v79, v255, v255, v79
    s_nop 2
    v_add_f32_dpp v64, v64, v64 row_ror:8 row_mask:0xf bank_mask:0xf
    v_add_f32_dpp v65, v65, v65 row_ror:8 row_mask:0xf bank_mask:0xf
    v_add_f32_dpp v66, v66, v66 row_ror:8 row_mask:0xf bank_mask:0xf
    v_add_f32_dpp v67, v67, v67 row_ror:8 row_mask:0xf bank_mask:0xf
    v_add_f32_dpp v68, v68, v68 row_ror:8 row_mask:0xf bank_mask:0xf
    v_add_f32_dpp v69, v69, v69 row_ror:8 row_mask:0xf bank_mask:0xf
    v_add_f32_dpp v70, v70, v70 row_ror:8 row_mask:0xf bank_mask:0xf
    v_add_f32_dpp v71, v71, v71 row_ror:8 row_mask:0xf bank_mask:0xf
    v_add_f32_dpp v72, v72, v72 row_ror:8 row_mask:0xf bank_mask:0xf
    v_add_f32_dpp v73, v73, v73 row_ror:8 row_mask:0xf bank_mask:0xf
    v_add_f32_dpp v74, v74, v74 row_ror:8 row_mask:0xf bank_mask:0xf
    v_add_f32_dpp v75, v75, v75 row_ror:8 row_mask:0xf bank_mask:0xf
    v_add_f32_dpp v76, v76, v76 row_ror:8 row_mask:0xf bank_mask:0xf
    v_add_f32_dpp v77, v77, v77 row_ror:8 row_mask:0xf bank_mask:0xf
    v_add_f32_dpp v78, v78, v78 row_ror:8 row_mask:0xf bank_mask:0xf
    v_add_f32_dpp v79, v79, v79 row_ror:8 row_mask:0xf bank_mask:0xf
    v_add_f32_dpp v64, v64, v64 row_ror:4 row_mask:0xf bank_mask:0xf
    v_add_f32_dpp v65, v65, v65 row_ror:4 row_mask:0xf bank_mask:0xf
    v_add_f32_dpp v66, v66, v66 row_ror:4 row_mask:0xf bank_mask:0xf
    v_add_f32_dpp v67, v67, v67 row_ror:4 row_mask:0xf bank_mask:0xf
    v_add_f32_dpp v68, v68, v68 row_ror:4 row_mask:0xf bank_mask:0xf
    v_add_f32_dpp v69, v69, v69 row_ror:4 row_mask:0xf bank_mask:0xf
    v_add_f32_dpp v70, v70, v70 row_ror:4 row_mask:0xf bank_mask:0xf
    v_add_f32_dpp v71, v71, v71 row_ror:4 row_mask:0xf bank_mask:0xf
    v_add_f32_dpp v72, v72, v72 row_ror:4 row_mask:0xf bank_mask:0xf
    v_add_f32_dpp v73, v73, v73 row_ror:4 row_mask:0xf bank_mask:0xf
    v_add_f32_dpp v74, v74, v74 row_ror:4 row_mask:0xf bank_mask:0xf
    v_add_f32_dpp v75, v75, v75 row_ror:4 row_mask:0xf bank_mask:0xf
    v_add_f32_dpp v76, v76, v76 row_ror:4 row_mask:0xf bank_mask:0xf
    v_add_f32_dpp v77, v77, v77 row_ror:4 row_mask:0xf bank_mask:0xf
    v_add_f32_dpp v78, v78, v78 row_ror:4 row_mask:0xf bank_mask:0xf
    v_add_f32_dpp v79, v79, v79 row_ror:4 row_mask:0xf bank_mask:0xf
    v_add_f32_dpp v64, v64, v64 row_ror:2 row_mask:0xf bank_mask:0xf
    v_add_f32_dpp v65, v65, v65 row_ror:2 row_mask:0xf bank_mask:0xf
    v_add_f32_dpp v66, v66, v66 row_ror:2 row_mask:0xf bank_mask:0xf
    v_add_f32_dpp v67, v67, v67 row_ror:2 row_mask:0xf bank_mask:0xf
    v_add_f32_dpp v68, v68, v68 row_ror:2 row_mask:0xf bank_mask:0xf
    v_add_f32_dpp v69, v69, v69 row_ror:2 row_mask:0xf bank_mask:0xf
    v_add_f32_dpp v70, v70, v70 row_ror:2 row_mask:0xf bank_mask:0xf
    v_add_f32_dpp v71, v71, v71 row_ror:2 row_mask:0xf bank_mask:0xf
    v_add_f32_dpp v72, v72, v72 row_ror:2 row_mask:0xf bank_mask:0xf
    v_add_f32_dpp v73, v73, v73 row_ror:2 row_mask:0xf bank_mask:0xf
    v_add_f32_dpp v74, v74, v74 row_ror:2 row_mask:0xf bank_mask:0xf
    v_add_f32_dpp v75, v75, v75 row_ror:2 row_mask:0xf bank_mask:0xf
    v_add_f32_dpp v76, v76, v76 row_ror:2 row_mask:0xf bank_mask:0xf
    v_add_f32_dpp v77, v77, v77 row_ror:2 row_mask:0xf bank_mask:0xf
    v_add_f32_dpp v78, v78, v78 row_ror:2 row_mask:0xf bank_mask:0xf
    v_add_f32_dpp v79, v79, v79 row_ror:2 row_mask:0xf bank_mask:0xf
    v_add_f32_dpp v64, v64, v64 row_ror:1 row_mask:0xf bank_mask:0xf
    v_add_f32_dpp v65, v65, v65 row_ror:1 row_mask:0xf bank_mask:0xf
    v_add_f32_dpp v66, v66, v66 row_ror:1 row_mask:0xf bank_mask:0xf
    v_add_f32_dpp v67, v67, v67 row_ror:1 row_mask:0xf bank_mask:0xf
    v_add_f32_dpp v68, v68, v68 row_ror:1 row_mask:0xf bank_mask:0xf
    v_add_f32_dpp v69, v69, v69 row_ror:1 row_mask:0xf bank_mask:0xf
    v_add_f32_dpp v70, v70, v70 row_ror:1 row_mask:0xf bank_mask:0xf
    v_add_f32_dpp v71, v71, v71 row_ror:1 row_mask:0xf bank_mask:0xf
    v_add_f32_dpp v72, v72, v72 row_ror:1 row_mask:0xf bank_mask:0xf
    v_add_f32_dpp v73, v73, v73 row_ror:1 row_mask:0xf bank_mask:0xf
    v_add_f32_dpp v74, v74, v74 row_ror:1 row_mask:0xf bank_mask:0xf
    v_add_f32_dpp v75, v75, v75 row_ror:1 row_mask:0xf bank_mask:0xf
    v_add_f32_dpp v76, v76, v76 row_ror:1 row_mask:0xf bank_mask:0xf
    v_add_f32_dpp v77, v77, v77 row_ror:1 row_mask:0xf bank_mask:0xf
    v_add_f32_dpp v78, v78, v78 row_ror:1 row_mask:0xf bank_mask:0xf
    v_add_f32_dpp v79, v79, v79 row_ror:1 row_mask:0xf bank_mask:0xf
    v_cmp_eq_u32 vcc, 1, v3
    s_nop 1
    v_cndmask_b32 v64, v64, v65, vcc
    v_cndmask_b32 v72, v72, v73, vcc
    v_cmp_eq_u32 vcc, 2, v3
    s_nop 1
    v_cndmask_b32 v64, v64, v66, vcc
    v_cndmask_b32 v72, v72, v74, vcc
    v_cmp_eq_u32 vcc, 3, v3
    s_nop 1
    v_cndmask_b32 v64, v64, v67, vcc
    v_cndmask_b32 v72, v72, v75, vcc
    v_cmp_eq_u32 vcc, 4, v3
    s_nop 1
    v_cndmask_b32 v64, v64, v68, vcc
    v_cndmask_b32 v72, v72, v76, vcc
    v_cmp_eq_u32 vcc, 5, v3
    s_nop 1
    v_cndmask_b32 v64, v64, v69, vcc
    v_cndmask_b32 v72, v72, v77, vcc
    v_cmp_eq_u32 vcc, 6, v3
    s_nop 1
    v_cndmask_b32 v64, v64, v70, vcc
    v_cndmask_b32 v72, v72, v78, vcc
    v_cmp_eq_u32 vcc, 7, v3
    s_nop 1
    v_cndmask_b32 v64, v64, v71, vcc
    v_cndmask_b32 v72, v72, v79, vcc
    v_mul_f32 v7, 0x3b000000, v64
    v_mul_f32 v6, 0x3b000000, v72
    v_fma_f32 v6, -v7, v7, v6
    v_max_f32 v6, 0, v6
    v_add_f32 v6, 0x3727c5ac, v6
    v_rsq_f32 v5, v6
    v_cvt_pk_bf16_f32 v4, -v7, -v7
    v_and_b32 v9, s84, v4
    v_sub_f32 v9, -v7, v9
    v_cvt_pk_bf16_f32 v9, v9, v9
    v_lshrrev_b32 v4, 16, v4
    v_and_or_b32 v4, v9, s84, v4
    v_lshl_add_u32 v9, v3, 2, v8
    v_add_u32 v9, s93, v9
    v_lshlrev_b32 v11, 4, v9
    v_lshlrev_b32 v12, 2, v9
    v_cmp_gt_u32 vcc, 8, v3
    s_mov_b32 s79, 10485760
    s_mov_b32 s80, 10551296
    s_mov_b64 exec, vcc
    buffer_store_dwordx4 v[4:7], v11, s[12:15], s79 offen sc1
    buffer_store_dword v5, v12, s[12:15], s80 offen sc1
    s_mov_b64 exec, -1
    s_waitcnt vmcnt(0)
    s_barrier
    s_mov_b32 s28, s60
    s_mov_b32 s29, s61
    s_mov_b32 s30, 256
    s_mov_b32 s31, 0x00020000
    s_lshl_b32 s79, s92, 2
    s_cmp_eq_u32 s64, 0
    s_cselect_b32 s79, s79, 2130706432
    v_mov_b32 v2, s79
    v_mov_b32 v3, 1
    s_mov_b64 exec, 1
    buffer_store_dword v3, v2, s[28:31], 0 offen sc1
    s_mov_b64 exec, -1
    v_and_b32 v4, 31, v1
    v_lshrrev_b32 v5, 5, v1
    v_bfe_u32 v6, v1, 1, 3
    v_xor_b32 v6, v6, v5
    v_lshlrev_b32 v4, 7, v4
    v_add_u32 v4, s77, v4
    v_xor_b32 v7, 0, v6
    v_lshl_add_u32 v24, v7, 4, v4
    v_xor_b32 v7, 2, v6
    v_lshl_add_u32 v25, v7, 4, v4
    v_xor_b32 v7, 4, v6
    v_lshl_add_u32 v26, v7, 4, v4
    v_xor_b32 v7, 6, v6
    v_lshl_add_u32 v27, v7, 4, v4
    v_bfe_u32 v4, v1, 2, 2
    v_lshl_add_u32 v4, v5, 2, v4
    v_lshlrev_b32 v4, 7, v4
    v_add_u32 v4, s78, v4
    v_bfe_u32 v6, v1, 4, 1
    v_lshl_add_u32 v4, v6, 5, v4
    v_and_b32 v6, 3, v1
    v_lshl_add_u32 v4, v6, 3, v4
    v_bfe_u32 v6, v1, 3, 1
    v_xor_b32 v6, s70, v6
    v_lshl_add_u32 v28, v6, 6, v4
    v_xor_b32 v29, 64, v28
    v_add_u32 v30, 98304, v28
    v_add_u32 v31, 98304, v29
    s_add_u32 m0, s77, 0
    s_add_u32 s89, s85, 0
    buffer_load_dwordx4 v16, s[16:19], s89 offen offset:0 lds
    buffer_load_dwordx4 v17, s[16:19], s89 offen offset:1024 lds
    buffer_load_dwordx4 v18, s[16:19], s89 offen offset:2048 lds
    buffer_load_dwordx4 v19, s[16:19], s89 offen offset:3072 lds
    s_add_u32 m0, s77, 4096
    s_add_u32 s89, s86, 0
    buffer_load_dwordx4 v16, s[16:19], s89 offen offset:0 lds
    buffer_load_dwordx4 v17, s[16:19], s89 offen offset:1024 lds
    buffer_load_dwordx4 v18, s[16:19], s89 offen offset:2048 lds
    buffer_load_dwordx4 v19, s[16:19], s89 offen offset:3072 lds
    s_add_u32 m0, s77, 8192
    s_add_u32 s89, s85, 0
    buffer_load_dwordx4 v16, s[20:23], s89 offen offset:0 lds
    buffer_load_dwordx4 v17, s[20:23], s89 offen offset:1024 lds
    buffer_load_dwordx4 v18, s[20:23], s89 offen offset:2048 lds
    buffer_load_dwordx4 v19, s[20:23], s89 offen offset:3072 lds
    s_add_u32 m0, s78, 0
    s_add_u32 s89, s86, 0
    buffer_load_dwordx4 v16, s[20:23], s89 offen offset:0 lds
    buffer_load_dwordx4 v17, s[20:23], s89 offen offset:1024 lds
    buffer_load_dwordx4 v18, s[20:23], s89 offen offset:2048 lds
    buffer_load_dwordx4 v19, s[20:23], s89 offen offset:3072 lds
    s_add_u32 m0, s78, 4096
    s_add_u32 s89, s85, 128
    buffer_load_dwordx4 v16, s[16:19], s89 offen offset:0 lds
    buffer_load_dwordx4 v17, s[16:19], s89 offen offset:1024 lds
    buffer_load_dwordx4 v18, s[16:19], s89 offen offset:2048 lds
    buffer_load_dwordx4 v19, s[16:19], s89 offen offset:3072 lds
    s_add_u32 m0, s78, 8192
    s_add_u32 s89, s86, 128
    buffer_load_dwordx4 v16, s[16:19], s89 offen offset:0 lds
    buffer_load_dwordx4 v17, s[16:19], s89 offen offset:1024 lds
    buffer_load_dwordx4 v18, s[16:19], s89 offen offset:2048 lds
    buffer_load_dwordx4 v19, s[16:19], s89 offen offset:3072 lds
    s_add_u32 m0, s78, 49152
    s_add_u32 s89, s85, 128
    buffer_load_dwordx4 v16, s[20:23], s89 offen offset:0 lds
    buffer_load_dwordx4 v17, s[20:23], s89 offen offset:1024 lds
    buffer_load_dwordx4 v18, s[20:23], s89 offen offset:2048 lds
    buffer_load_dwordx4 v19, s[20:23], s89 offen offset:3072 lds
    s_add_u32 m0, s78, 53248
    s_add_u32 s89, s86, 128
    buffer_load_dwordx4 v16, s[20:23], s89 offen offset:0 lds
    buffer_load_dwordx4 v17, s[20:23], s89 offen offset:1024 lds
    buffer_load_dwordx4 v18, s[20:23], s89 offen offset:2048 lds
    buffer_load_dwordx4 v19, s[20:23], s89 offen offset:3072 lds
    s_add_u32 m0, s78, 57344
    s_add_u32 s89, s87, 0
    buffer_load_dwordx4 v20, s[24:27], s89 offen offset:0 lds
    buffer_load_dwordx4 v21, s[24:27], s89 offen offset:1024 lds
    buffer_load_dwordx4 v22, s[24:27], s89 offen offset:2048 lds
    buffer_load_dwordx4 v23, s[24:27], s89 offen offset:3072 lds
    s_waitcnt vmcnt(24)
    ds_read_b128 a[0:3], v24 offset:0
    ds_read_b128 a[8:11], v25 offset:0
    ds_read_b128 a[32:35], v26 offset:0
    ds_read_b128 a[40:43], v27 offset:0
    ds_read_b128 a[4:7], v24 offset:4096
    ds_read_b128 a[12:15], v25 offset:4096
    ds_read_b128 a[36:39], v26 offset:4096
    ds_read_b128 a[44:47], v27 offset:4096
    ds_read_b128 a[16:19], v24 offset:8192
    ds_read_b128 a[24:27], v25 offset:8192
    ds_read_b128 a[48:51], v26 offset:8192
    ds_read_b128 a[56:59], v27 offset:8192
    v_subrev_u32 v24, 98304, v24
    v_subrev_u32 v25, 98304, v25
    v_subrev_u32 v26, 98304, v26
    v_subrev_u32 v27, 98304, v27
    s_waitcnt lgkmcnt(0)
    s_add_u32 m0, s77, 0
    s_add_u32 s89, s87, 32768
    buffer_load_dwordx4 v20, s[24:27], s89 offen offset:0 lds
    buffer_load_dwordx4 v21, s[24:27], s89 offen offset:1024 lds
    s_waitcnt vmcnt(14)
    buffer_load_dwordx4 v22, s[24:27], s89 offen offset:2048 lds
    ds_read_b128 a[20:23], v24 offset:0
    ds_read_b128 a[28:31], v25 offset:0
    buffer_load_dwordx4 v23, s[24:27], s89 offen offset:3072 lds
    ds_read_b128 a[52:55], v26 offset:0
    ds_read_b128 a[60:63], v27 offset:0
    s_add_u32 m0, s77, 4096
    s_add_u32 s89, s87, 65536
    buffer_load_dwordx4 v20, s[24:27], s89 offen offset:0 lds
    buffer_load_dwordx4 v21, s[24:27], s89 offen offset:1024 lds
    ds_read_b128 a[64:67], v24 offset:4096
    ds_read_b128 a[72:75], v25 offset:4096
    buffer_load_dwordx4 v22, s[24:27], s89 offen offset:2048 lds
    ds_read_b128 a[96:99], v26 offset:4096
    ds_read_b128 a[104:107], v27 offset:4096
    buffer_load_dwordx4 v23, s[24:27], s89 offen offset:3072 lds
    s_add_u32 m0, s77, 8192
    s_add_u32 s89, s87, 98304
    buffer_load_dwordx4 v20, s[24:27], s89 offen offset:0 lds
    ds_read_b128 a[68:71], v24 offset:8192
    ds_read_b128 a[76:79], v25 offset:8192
    buffer_load_dwordx4 v21, s[24:27], s89 offen offset:1024 lds
    ds_read_b128 a[100:103], v26 offset:8192
    ds_read_b128 a[108:111], v27 offset:8192
    buffer_load_dwordx4 v22, s[24:27], s89 offen offset:2048 lds
    buffer_load_dwordx4 v23, s[24:27], s89 offen offset:3072 lds
    s_waitcnt lgkmcnt(0)
    s_add_u32 m0, s78, 0
    s_add_u32 s89, s87, 131072
    buffer_load_dwordx4 v20, s[24:27], s89 offen offset:0 lds
    s_waitcnt vmcnt(13)
    buffer_load_dwordx4 v21, s[24:27], s89 offen offset:1024 lds
    ds_read_b128 a[80:83], v24 offset:49152
    ds_read_b128 a[88:91], v25 offset:49152
    buffer_load_dwordx4 v22, s[24:27], s89 offen offset:2048 lds
    ds_read_b128 a[112:115], v26 offset:49152
    ds_read_b128 a[120:123], v27 offset:49152
    buffer_load_dwordx4 v23, s[24:27], s89 offen offset:3072 lds
    ds_read_b128 a[84:87], v24 offset:53248
    ds_read_b128 a[92:95], v25 offset:53248
    s_add_u32 m0, s78, 4096
    s_add_u32 s89, s87, 163840
    buffer_load_dwordx4 v20, s[24:27], s89 offen offset:0 lds
    ds_read_b128 a[116:119], v26 offset:53248
    ds_read_b128 a[124:127], v27 offset:53248
    buffer_load_dwordx4 v21, s[24:27], s89 offen offset:1024 lds
    buffer_load_dwordx4 v22, s[24:27], s89 offen offset:2048 lds
    ds_read_b64_tr_b16 a[192:193], v28 offset:57344
    ds_read_b64_tr_b16 a[194:195], v28 offset:58368
    buffer_load_dwordx4 v23, s[24:27], s89 offen offset:3072 lds
    ds_read_b64_tr_b16 a[196:197], v29 offset:57344
    ds_read_b64_tr_b16 a[198:199], v29 offset:58368
    s_add_u32 m0, s78, 8192
    s_add_u32 s89, s87, 196608
    buffer_load_dwordx4 v20, s[24:27], s89 offen offset:0 lds
    ds_read_b64_tr_b16 a[200:201], v28 offset:59392
    ds_read_b64_tr_b16 a[202:203], v28 offset:60416
    buffer_load_dwordx4 v21, s[24:27], s89 offen offset:1024 lds
    ds_read_b64_tr_b16 a[204:205], v29 offset:59392
    ds_read_b64_tr_b16 a[206:207], v29 offset:60416
    buffer_load_dwordx4 v22, s[24:27], s89 offen offset:2048 lds
    buffer_load_dwordx4 v23, s[24:27], s89 offen offset:3072 lds
    s_waitcnt lgkmcnt(0)
    s_add_u32 m0, s78, 49152
    s_add_u32 s89, s87, 229376
    buffer_load_dwordx4 v20, s[24:27], s89 offen offset:0 lds
    s_waitcnt vmcnt(13)
    ds_read_b64_tr_b16 a[208:209], v30 offset:0
    ds_read_b64_tr_b16 a[210:211], v30 offset:1024
    buffer_load_dwordx4 v21, s[24:27], s89 offen offset:1024 lds
    ds_read_b64_tr_b16 a[212:213], v31 offset:0
    ds_read_b64_tr_b16 a[214:215], v31 offset:1024
    buffer_load_dwordx4 v22, s[24:27], s89 offen offset:2048 lds
    ds_read_b64_tr_b16 a[216:217], v30 offset:2048
    ds_read_b64_tr_b16 a[218:219], v30 offset:3072
    buffer_load_dwordx4 v23, s[24:27], s89 offen offset:3072 lds
    ds_read_b64_tr_b16 a[220:221], v31 offset:2048
    ds_read_b64_tr_b16 a[222:223], v31 offset:3072
    s_add_u32 m0, s78, 53248
    s_add_u32 s89, s87, 262144
    buffer_load_dwordx4 v20, s[24:27], s89 offen offset:0 lds
    ds_read_b64_tr_b16 a[224:225], v30 offset:4096
    ds_read_b64_tr_b16 a[226:227], v30 offset:5120
    buffer_load_dwordx4 v21, s[24:27], s89 offen offset:1024 lds
    ds_read_b64_tr_b16 a[228:229], v31 offset:4096
    ds_read_b64_tr_b16 a[230:231], v31 offset:5120
    ds_read_b64_tr_b16 a[232:233], v30 offset:6144
    ds_read_b64_tr_b16 a[234:235], v30 offset:7168
    buffer_load_dwordx4 v22, s[24:27], s89 offen offset:2048 lds
    ds_read_b64_tr_b16 a[236:237], v31 offset:6144
    ds_read_b64_tr_b16 a[238:239], v31 offset:7168
    buffer_load_dwordx4 v23, s[24:27], s89 offen offset:3072 lds
    ds_read_b64_tr_b16 a[240:241], v30 offset:8192
    ds_read_b64_tr_b16 a[242:243], v30 offset:9216
    s_add_u32 m0, s78, 57344
    s_add_u32 s89, s87, 294912
    buffer_load_dwordx4 v20, s[24:27], s89 offen offset:0 lds
    ds_read_b64_tr_b16 a[244:245], v31 offset:8192
    ds_read_b64_tr_b16 a[246:247], v31 offset:9216
    buffer_load_dwordx4 v21, s[24:27], s89 offen offset:1024 lds
    ds_read_b64_tr_b16 a[248:249], v30 offset:10240
    ds_read_b64_tr_b16 a[250:251], v30 offset:11264
    buffer_load_dwordx4 v22, s[24:27], s89 offen offset:2048 lds
    ds_read_b64_tr_b16 a[252:253], v31 offset:10240
    ds_read_b64_tr_b16 a[254:255], v31 offset:11264
    buffer_load_dwordx4 v23, s[24:27], s89 offen offset:3072 lds
    s_waitcnt lgkmcnt(0)
    s_add_u32 m0, s77, 0
    s_add_u32 s89, s87, 327680
    buffer_load_dwordx4 v20, s[24:27], s89 offen offset:0 lds
    buffer_load_dwordx4 v21, s[24:27], s89 offen offset:1024 lds
    buffer_load_dwordx4 v22, s[24:27], s89 offen offset:2048 lds
    buffer_load_dwordx4 v23, s[24:27], s89 offen offset:3072 lds
    v_min_u32 v2, 15, v1
    v_lshlrev_b32 v2, 2, v2
    s_mov_b32 s83, 200000
Lpoll_15:
    buffer_load_dword v3, v2, s[28:31], 0 offen sc1
    s_waitcnt vmcnt(0)
Lpchk_17:
    v_cmp_ne_u32 vcc, 0, v3
    s_nop 1
    s_cmp_eq_u64 vcc, -1
    s_cbranch_scc1 Lpdone_16
    s_sub_u32 s83, s83, 1
    s_cbranch_scc1 Lpdone_16
    s_sleep 1
    s_branch Lpoll_15
Lpdone_16:
    v_mov_b32 v91, 2130706432
    s_mov_b32 s75, 0
    s_lshl_b32 s79, s71, 10
    v_lshl_add_u32 v84, v1, 4, s79
    v_xor_b32 v85, 1024, v84
    s_lshl_b32 s79, s67, 2
    s_add_u32 s79, s79, s68
    s_mul_i32 s76, s79, 176128
    s_mul_i32 s80, s64, 45056
    s_add_u32 s76, s76, s80
    s_lshl_b32 s73, s79, 17
    s_lshl_b32 s80, s64, 15
    s_add_u32 s73, s73, s80
    s_add_u32 s73, s73, 6291456
    s_lshr_b32 s79, s79, 1
    s_lshl_b32 s79, s79, 13
    s_add_u32 s74, s79, 10747904
    s_mul_i32 s80, s64, 11
    v_min_u32 v89, 10, v1
    v_add_u32 v89, s80, v89
    v_min_u32 v89, 42, v89
    v_lshlrev_b32 v89, 7, v89
    s_lshl_b32 s80, s64, 2
    s_add_u32 s80, s80, 48
    v_min_u32 v90, 3, v1
    v_add_u32 v90, s80, v90
    v_lshlrev_b32 v90, 7, v90
    s_lshl_b32 s79, s67, 8
    s_lshr_b32 s80, s68, 1
    s_lshl_b32 s80, s80, 7
    s_add_u32 s79, s79, s80
    s_and_b32 s80, s68, 1
    s_lshl_b32 s80, s80, 5
    s_add_u32 s79, s79, s80
    s_lshl_b32 s80, s71, 4
    s_add_u32 s79, s79, s80
    v_bfe_u32 v2, v1, 4, 1
    v_and_b32 v3, 15, v1
    v_lshl_add_u32 v2, v2, 6, v3
    v_add_u32 v2, s79, v2
    v_lshrrev_b32 v88, 3, v1
    v_add_u32 v88, s79, v88
    s_lshl_b32 s79, s69, 7
    s_lshl_b32 s80, s70, 6
    s_add_u32 s79, s79, s80
    v_and_b32 v3, 32, v1
    v_add_u32 v94, s79, v3
    v_lshl_add_u32 v93, v2, 10, v94
    v_lshlrev_b32 v95, 4, v2
    v_add_u32 v95, 10485760, v95
    s_lshl_b32 s79, s79, 1
    v_and_b32 v3, 7, v1
    v_lshl_add_u32 v3, v3, 4, s79
    v_lshl_add_u32 v88, v88, 11, v3
    s_and_b32 s79, s70, s71
    s_mul_i32 s79, s79, 2130706432
    v_add_u32 v86, s79, v84
    v_add_u32 v87, s79, v85
    s_mov_b32 s28, s48
    s_mov_b32 s29, s49
    s_mov_b32 s30, 1024
    s_mov_b32 s31, 0x00020000
    buffer_load_dwordx4 a[128:131], v93, s[4:7], 0 offen offset:0
    buffer_load_dwordx4 a[136:139], v94, s[28:31], 0 offen offset:0
    buffer_load_dwordx4 a[132:135], v93, s[4:7], 0 offen offset:16
    buffer_load_dwordx4 a[140:143], v94, s[28:31], 0 offen offset:16
    buffer_load_dwordx4 a[144:147], v95, s[12:15], 0 offen sc1
    s_mov_b32 s83, 200000
Lpoll_18:
    buffer_load_dword v92, v89, s[12:15], s74 offen sc1
    s_waitcnt vmcnt(0)
Lpchk_20:
    v_cmp_ne_u32 vcc, 0, v92
    s_nop 1
    s_cmp_eq_u64 vcc, -1
    s_cbranch_scc1 Lpdone_19
    s_sub_u32 s83, s83, 1
    s_cbranch_scc1 Lpdone_19
    s_sleep 1
    s_branch Lpoll_18
Lpdone_19:
L_phase2:
    buffer_load_dwordx4 v[96:99], v84, s[12:15], s76 offen offset:0 sc1
    buffer_load_dwordx4 v[100:103], v85, s[12:15], s76 offen offset:0 sc1
    buffer_load_dwordx4 v[104:107], v84, s[12:15], s76 offen offset:2048 sc1
    buffer_load_dwordx4 v[108:111], v85, s[12:15], s76 offen offset:2048 sc1
    s_add_u32 s76, s76, 4096
    buffer_load_dwordx4 v[112:115], v84, s[12:15], s76 offen offset:0 sc1
    buffer_load_dwordx4 v[116:119], v85, s[12:15], s76 offen offset:0 sc1
    buffer_load_dwordx4 v[120:123], v84, s[12:15], s76 offen offset:2048 sc1
    buffer_load_dwordx4 v[124:127], v85, s[12:15], s76 offen offset:2048 sc1
    s_add_u32 s76, s76, 4096
    buffer_load_dwordx4 v[128:131], v84, s[12:15], s76 offen offset:0 sc1
    buffer_load_dwordx4 v[132:135], v85, s[12:15], s76 offen offset:0 sc1
    buffer_load_dwordx4 v[136:139], v84, s[12:15], s76 offen offset:2048 sc1
    buffer_load_dwordx4 v[140:143], v85, s[12:15], s76 offen offset:2048 sc1
    s_add_u32 s76, s76, 4096
    v_accvgpr_read_b32 v224, a128
    v_accvgpr_read_b32 v225, a129
    v_accvgpr_read_b32 v226, a130
    v_accvgpr_read_b32 v227, a131
    v_accvgpr_read_b32 v228, a132
    v_accvgpr_read_b32 v229, a133
    v_accvgpr_read_b32 v230, a134
    v_accvgpr_read_b32 v231, a135
    v_accvgpr_read_b32 v232, a136
    v_accvgpr_read_b32 v233, a137
    v_accvgpr_read_b32 v234, a138
    v_accvgpr_read_b32 v235, a139
    v_accvgpr_read_b32 v236, a140
    v_accvgpr_read_b32 v237, a141
    v_accvgpr_read_b32 v238, a142
    v_accvgpr_read_b32 v239, a143
    v_accvgpr_read_b32 v240, a144
    v_accvgpr_read_b32 v241, a145
    v_accvgpr_read_b32 v242, a146
    v_accvgpr_read_b32 v243, a147
    s_mov_b32 s28, s58
    s_mov_b32 s29, s59
    s_mov_b32 s30, 4194304
    s_mov_b32 s31, 0x00020000
    v_permlane32_swap_b32 v224, v226
    v_permlane32_swap_b32 v225, v227
    v_permlane32_swap_b32 v228, v230
    v_permlane32_swap_b32 v229, v231
    v_permlane32_swap_b32 v232, v234
    v_permlane32_swap_b32 v233, v235
    v_permlane32_swap_b32 v236, v238
    v_permlane32_swap_b32 v237, v239
    s_waitcnt vmcnt(10)
    v_mfma_f32_32x32x16_bf16 a[128:143], a[192:195], v[96:99], 0
    v_lshlrev_b32 v7, 4, v1
    s_xor_b32 s79, s64, 1
    s_mul_i32 s79, s79, 12288
    s_add_u32 s80, s79, 102400
    v_add_u32 v32, s80, v7
    v_mfma_f32_32x32x16_bf16 a[144:159], a[196:199], v[96:99], 0
    s_add_u32 s79, s79, 0
    v_add_u32 v12, s79, v7
    s_xor_b32 s79, s64, 2
    s_mul_i32 s79, s79, 12288
    s_add_u32 s80, s79, 106496
    v_mfma_f32_32x32x16_bf16 a[160:175], a[192:195], v[100:103], 0
    v_add_u32 v33, s80, v7
    s_add_u32 s79, s79, 4096
    v_add_u32 v13, s79, v7
    s_xor_b32 s79, s64, 3
    buffer_load_dwordx4 v[144:147], v84, s[12:15], s76 offen offset:0 sc1
    v_mfma_f32_32x32x16_bf16 a[176:191], a[196:199], v[100:103], 0
    s_lshl_b32 s80, s79, 12
    s_add_u32 s80, s80, 147456
    s_mul_i32 s79, s79, 12288
    v_add_u32 v34, s80, v7
    buffer_load_dwordx4 v[148:151], v85, s[12:15], s76 offen offset:0 sc1
    s_waitcnt vmcnt(10)
    v_mfma_f32_32x32x16_bf16 a[128:143], a[200:203], v[104:107], a[128:143]
    s_add_u32 s79, s79, 8192
    v_add_u32 v14, s79, v7
    s_lshl_b32 s79, s64, 12
    s_add_u32 s79, s79, 147456
    v_add_u32 v35, s77, v7
    v_mfma_f32_32x32x16_bf16 a[144:159], a[204:207], v[104:107], a[144:159]
    v_add_u32 v36, s79, v7
    v_add_u32 v37, s78, v7
    s_add_u32 s79, s78, 49152
    v_and_b32 v2, 31, v1
    v_lshl_add_u32 v2, v2, 7, s79
    v_mfma_f32_32x32x16_bf16 a[160:175], a[200:203], v[108:111], a[160:175]
    v_lshrrev_b32 v3, 5, v1
    v_and_b32 v4, 7, v1
    v_xor_b32 v3, v3, v4
    v_lshl_add_u32 v8, v3, 4, v2
    buffer_load_dwordx4 v[152:155], v84, s[12:15], s76 offen offset:2048 sc1
    v_mfma_f32_32x32x16_bf16 a[176:191], a[204:207], v[108:111], a[176:191]
    v_xor_b32 v9, 32, v8
    v_xor_b32 v10, 64, v8
    v_xor_b32 v11, 96, v8
    v_lshrrev_b32 v3, 3, v1
    buffer_load_dwordx4 v[156:159], v85, s[12:15], s76 offen offset:2048 sc1
    s_add_u32 s76, s76, 4096
    s_waitcnt vmcnt(10)
    v_mfma_f32_32x32x16_bf16 a[128:143], a[208:211], v[112:115], a[128:143]
    v_xor_b32 v4, v4, v3
    v_lshl_add_u32 v3, v3, 7, s79
    v_lshl_add_u32 v38, v4, 4, v3
    s_mov_b32 s96, 16384
    s_mov_b32 s97, 131072
    v_mfma_f32_32x32x16_bf16 a[144:159], a[212:215], v[112:115], a[144:159]
    s_mov_b32 s98, 147456
    v_lshlrev_b32 v192, 16, v224
    v_and_b32 v193, s84, v224
    v_lshlrev_b32 v208, 16, v232
    v_and_b32 v209, s84, v232
    v_mfma_f32_32x32x16_bf16 a[160:175], a[208:211], v[116:119], a[160:175]
    v_lshlrev_b32 v194, 16, v225
    v_and_b32 v195, s84, v225
    v_lshlrev_b32 v210, 16, v233
    v_and_b32 v211, s84, v233
    buffer_load_dwordx4 v[160:163], v84, s[12:15], s76 offen offset:0 sc1
    v_mfma_f32_32x32x16_bf16 a[176:191], a[212:215], v[116:119], a[176:191]
    v_lshlrev_b32 v196, 16, v228
    v_and_b32 v197, s84, v228
    v_lshlrev_b32 v212, 16, v236
    v_and_b32 v213, s84, v236
    buffer_load_dwordx4 v[164:167], v85, s[12:15], s76 offen offset:0 sc1
    s_waitcnt vmcnt(10)
    v_mfma_f32_32x32x16_bf16 a[128:143], a[216:219], v[120:123], a[128:143]
    v_lshlrev_b32 v198, 16, v229
    v_and_b32 v199, s84, v229
    v_lshlrev_b32 v214, 16, v237
    v_and_b32 v215, s84, v237
    v_lshlrev_b32 v200, 16, v226
    v_mfma_f32_32x32x16_bf16 a[144:159], a[220:223], v[120:123], a[144:159]
    v_and_b32 v201, s84, v226
    v_lshlrev_b32 v216, 16, v234
    v_and_b32 v217, s84, v234
    v_lshlrev_b32 v202, 16, v227
    v_and_b32 v203, s84, v227
    v_mfma_f32_32x32x16_bf16 a[160:175], a[216:219], v[124:127], a[160:175]
    v_lshlrev_b32 v218, 16, v235
    v_and_b32 v219, s84, v235
    v_lshlrev_b32 v204, 16, v230
    v_and_b32 v205, s84, v230
    buffer_load_dwordx4 v[168:171], v84, s[12:15], s76 offen offset:2048 sc1
    v_mfma_f32_32x32x16_bf16 a[176:191], a[220:223], v[124:127], a[176:191]
    v_lshlrev_b32 v220, 16, v238
    v_and_b32 v221, s84, v238
    v_lshlrev_b32 v206, 16, v231
    v_and_b32 v207, s84, v231
    buffer_load_dwordx4 v[172:175], v85, s[12:15], s76 offen offset:2048 sc1
    s_add_u32 s76, s76, 4096
    s_waitcnt vmcnt(10)
    v_mfma_f32_32x32x16_bf16 a[128:143], a[224:227], v[128:131], a[128:143]
    v_lshlrev_b32 v222, 16, v239
    v_and_b32 v223, s84, v239
    v_sub_f32 v176, v192, v243
    v_mul_f32 v208, v208, v241
    v_mul_f32 v176, v176, v208
    v_mfma_f32_32x32x16_bf16 a[144:159], a[228:231], v[128:131], a[144:159]
    v_sub_f32 v177, v193, v243
    v_mul_f32 v209, v209, v241
    v_mul_f32 v177, v177, v209
    v_sub_f32 v178, v194, v243
    v_mul_f32 v210, v210, v241
    v_mfma_f32_32x32x16_bf16 a[160:175], a[224:227], v[132:135], a[160:175]
    v_mul_f32 v178, v178, v210
    v_sub_f32 v179, v195, v243
    v_mul_f32 v211, v211, v241
    v_mul_f32 v179, v179, v211
    buffer_load_dwordx4 v[96:99], v84, s[12:15], s76 offen offset:0 sc1
    v_mfma_f32_32x32x16_bf16 a[176:191], a[228:231], v[132:135], a[176:191]
    v_sub_f32 v180, v196, v243
    v_mul_f32 v212, v212, v241
    v_mul_f32 v180, v180, v212
    v_sub_f32 v181, v197, v243
    buffer_load_dwordx4 v[100:103], v85, s[12:15], s76 offen offset:0 sc1
    s_waitcnt vmcnt(10)
    v_mfma_f32_32x32x16_bf16 a[128:143], a[232:235], v[136:139], a[128:143]
    v_mul_f32 v213, v213, v241
    v_mul_f32 v181, v181, v213
    v_sub_f32 v182, v198, v243
    v_mul_f32 v214, v214, v241
    v_mul_f32 v182, v182, v214
    v_mfma_f32_32x32x16_bf16 a[144:159], a[236:239], v[136:139], a[144:159]
    v_sub_f32 v183, v199, v243
    v_mul_f32 v215, v215, v241
    v_mul_f32 v183, v183, v215
    v_sub_f32 v184, v200, v243
    v_mul_f32 v216, v216, v241
    v_mfma_f32_32x32x16_bf16 a[160:175], a[232:235], v[140:143], a[160:175]
    v_mul_f32 v184, v184, v216
    v_sub_f32 v185, v201, v243
    v_mul_f32 v217, v217, v241
    v_mul_f32 v185, v185, v217
    buffer_load_dwordx4 v[104:107], v84, s[12:15], s76 offen offset:2048 sc1
    v_mfma_f32_32x32x16_bf16 a[176:191], a[236:239], v[140:143], a[176:191]
    v_sub_f32 v186, v202, v243
    v_mul_f32 v218, v218, v241
    v_mul_f32 v186, v186, v218
    v_sub_f32 v187, v203, v243
    buffer_load_dwordx4 v[108:111], v85, s[12:15], s76 offen offset:2048 sc1
    s_add_u32 s76, s76, 4096
    s_waitcnt vmcnt(10)
    v_mfma_f32_32x32x16_bf16 a[128:143], a[240:243], v[144:147], a[128:143]
    v_mul_f32 v219, v219, v241
    v_mul_f32 v187, v187, v219
    v_sub_f32 v188, v204, v243
    v_mul_f32 v220, v220, v241
    v_mul_f32 v188, v188, v220
    v_mfma_f32_32x32x16_bf16 a[144:159], a[244:247], v[144:147], a[144:159]
    v_sub_f32 v189, v205, v243
    v_mul_f32 v221, v221, v241
    v_mul_f32 v189, v189, v221
    v_sub_f32 v190, v206, v243
    v_mul_f32 v222, v222, v241
    v_mfma_f32_32x32x16_bf16 a[160:175], a[240:243], v[148:151], a[160:175]
    v_mul_f32 v190, v190, v222
    v_sub_f32 v191, v207, v243
    v_mul_f32 v223, v223, v241
    v_mul_f32 v191, v191, v223
    buffer_load_dwordx4 v[112:115], v84, s[12:15], s76 offen offset:0 sc1
    v_mfma_f32_32x32x16_bf16 a[176:191], a[244:247], v[148:151], a[176:191]
    buffer_load_dwordx4 v[116:119], v85, s[12:15], s76 offen offset:0 sc1
    s_waitcnt vmcnt(10)
    v_mfma_f32_32x32x16_bf16 a[128:143], a[248:251], v[152:155], a[128:143]
    ds_read_b64_tr_b16 v[40:41], v28 offset:0
    ds_read_b64_tr_b16 v[42:43], v28 offset:1024
    v_mfma_f32_32x32x16_bf16 a[144:159], a[252:255], v[152:155], a[144:159]
    ds_read_b64_tr_b16 v[44:45], v29 offset:0
    ds_read_b64_tr_b16 v[46:47], v29 offset:1024
    v_mfma_f32_32x32x16_bf16 a[160:175], a[248:251], v[156:159], a[160:175]
    buffer_load_dwordx4 v[120:123], v84, s[12:15], s76 offen offset:2048 sc1
    v_mfma_f32_32x32x16_bf16 a[176:191], a[252:255], v[156:159], a[176:191]
    s_barrier
    buffer_load_dwordx4 v[124:127], v85, s[12:15], s76 offen offset:2048 sc1
    s_add_u32 s76, s76, 4096
    s_waitcnt vmcnt(10)
    s_waitcnt lgkmcnt(0)
    v_mfma_f32_32x32x16_bf16 a[128:143], v[40:43], v[160:163], a[128:143]
    ds_read_b64_tr_b16 v[48:49], v28 offset:2048
    ds_read_b64_tr_b16 v[50:51], v28 offset:3072
    v_mfma_f32_32x32x16_bf16 a[144:159], v[44:47], v[160:163], a[144:159]
    ds_read_b64_tr_b16 v[52:53], v29 offset:2048
    ds_read_b64_tr_b16 v[54:55], v29 offset:3072
    v_mfma_f32_32x32x16_bf16 a[160:175], v[40:43], v[164:167], a[160:175]
    buffer_load_dwordx4 v[128:131], v84, s[12:15], s76 offen offset:0 sc1
    v_mfma_f32_32x32x16_bf16 a[176:191], v[44:47], v[164:167], a[176:191]
    buffer_load_dwordx4 v[132:135], v85, s[12:15], s76 offen offset:0 sc1
    s_waitcnt vmcnt(10)
    s_waitcnt lgkmcnt(0)
    v_mfma_f32_32x32x16_bf16 a[128:143], v[48:51], v[168:171], a[128:143]
    ds_read_b64_tr_b16 v[40:41], v28 offset:4096
    ds_read_b64_tr_b16 v[42:43], v28 offset:5120
    v_mfma_f32_32x32x16_bf16 a[144:159], v[52:55], v[168:171], a[144:159]
    ds_read_b64_tr_b16 v[44:45], v29 offset:4096
    ds_read_b64_tr_b16 v[46:47], v29 offset:5120
    v_mfma_f32_32x32x16_bf16 a[160:175], v[48:51], v[172:175], a[160:175]
    buffer_load_dwordx4 v[136:139], v84, s[12:15], s76 offen offset:2048 sc1
    v_mfma_f32_32x32x16_bf16 a[176:191], v[52:55], v[172:175], a[176:191]
    buffer_load_dwordx4 v[140:143], v85, s[12:15], s76 offen offset:2048 sc1
    s_add_u32 s76, s76, 4096
    s_waitcnt vmcnt(10)
    s_waitcnt lgkmcnt(0)
    v_mfma_f32_32x32x16_bf16 a[128:143], v[40:43], v[96:99], a[128:143]
    ds_read_b64_tr_b16 v[48:49], v28 offset:6144
    ds_read_b64_tr_b16 v[50:51], v28 offset:7168
    v_mfma_f32_32x32x16_bf16 a[144:159], v[44:47], v[96:99], a[144:159]
    ds_read_b64_tr_b16 v[52:53], v29 offset:6144
    ds_read_b64_tr_b16 v[54:55], v29 offset:7168
    v_mfma_f32_32x32x16_bf16 a[160:175], v[40:43], v[100:103], a[160:175]
    buffer_load_dwordx4 v[144:147], v84, s[12:15], s76 offen offset:0 sc1
    v_mfma_f32_32x32x16_bf16 a[176:191], v[44:47], v[100:103], a[176:191]
    buffer_load_dwordx4 v[148:151], v85, s[12:15], s76 offen offset:0 sc1
    s_waitcnt vmcnt(10)
    s_waitcnt lgkmcnt(0)
    v_mfma_f32_32x32x16_bf16 a[128:143], v[48:51], v[104:107], a[128:143]
    ds_read_b64_tr_b16 v[40:41], v28 offset:8192
    ds_read_b64_tr_b16 v[42:43], v28 offset:9216
    v_mfma_f32_32x32x16_bf16 a[144:159], v[52:55], v[104:107], a[144:159]
    ds_read_b64_tr_b16 v[44:45], v29 offset:8192
    ds_read_b64_tr_b16 v[46:47], v29 offset:9216
    v_mfma_f32_32x32x16_bf16 a[160:175], v[48:51], v[108:111], a[160:175]
    buffer_load_dwordx4 v[152:155], v84, s[12:15], s76 offen offset:2048 sc1
    v_mfma_f32_32x32x16_bf16 a[176:191], v[52:55], v[108:111], a[176:191]
    buffer_load_dwordx4 v[156:159], v85, s[12:15], s76 offen offset:2048 sc1
    s_add_u32 s76, s76, 4096
    s_waitcnt vmcnt(10)
    s_waitcnt lgkmcnt(0)
    v_mfma_f32_32x32x16_bf16 a[128:143], v[40:43], v[112:115], a[128:143]
    ds_read_b64_tr_b16 v[48:49], v28 offset:10240
    ds_read_b64_tr_b16 v[50:51], v28 offset:11264
    v_mfma_f32_32x32x16_bf16 a[144:159], v[44:47], v[112:115], a[144:159]
    ds_read_b64_tr_b16 v[52:53], v29 offset:10240
    ds_read_b64_tr_b16 v[54:55], v29 offset:11264
    v_mfma_f32_32x32x16_bf16 a[160:175], v[40:43], v[116:119], a[160:175]
    buffer_load_dwordx4 v[160:163], v84, s[12:15], s76 offen offset:0 sc1
    v_mfma_f32_32x32x16_bf16 a[176:191], v[44:47], v[116:119], a[176:191]
    buffer_load_dwordx4 v[164:167], v85, s[12:15], s76 offen offset:0 sc1
    s_waitcnt vmcnt(10)
    s_waitcnt lgkmcnt(0)
    v_mfma_f32_32x32x16_bf16 a[128:143], v[48:51], v[120:123], a[128:143]
    ds_read_b64_tr_b16 v[40:41], v28 offset:49152
    ds_read_b64_tr_b16 v[42:43], v28 offset:50176
    buffer_load_dword v92, v90, s[12:15], s74 offen sc1
    v_mfma_f32_32x32x16_bf16 a[144:159], v[52:55], v[120:123], a[144:159]
    ds_read_b64_tr_b16 v[44:45], v29 offset:49152
    ds_read_b64_tr_b16 v[46:47], v29 offset:50176
    v_mfma_f32_32x32x16_bf16 a[160:175], v[48:51], v[124:127], a[160:175]
    buffer_load_dwordx4 v[168:171], v84, s[12:15], s76 offen offset:2048 sc1
    v_mfma_f32_32x32x16_bf16 a[176:191], v[52:55], v[124:127], a[176:191]
    buffer_load_dwordx4 v[172:175], v85, s[12:15], s76 offen offset:2048 sc1
    s_add_u32 s76, s76, 4096
    s_waitcnt vmcnt(11)
    s_waitcnt lgkmcnt(0)
    v_mfma_f32_32x32x16_bf16 a[128:143], v[40:43], v[128:131], a[128:143]
    ds_read_b64_tr_b16 v[48:49], v28 offset:51200
    ds_read_b64_tr_b16 v[50:51], v28 offset:52224
    v_mfma_f32_32x32x16_bf16 a[144:159], v[44:47], v[128:131], a[144:159]
    ds_read_b64_tr_b16 v[52:53], v29 offset:51200
    ds_read_b64_tr_b16 v[54:55], v29 offset:52224
    v_mfma_f32_32x32x16_bf16 a[160:175], v[40:43], v[132:135], a[160:175]
    buffer_load_dwordx4 v[96:99], v86, s[12:15], s76 offen offset:0 sc1
    v_mfma_f32_32x32x16_bf16 a[176:191], v[44:47], v[132:135], a[176:191]
    buffer_load_dwordx4 v[100:103], v87, s[12:15], s76 offen offset:0 sc1
    s_waitcnt vmcnt(11)
    s_waitcnt lgkmcnt(0)
    v_mfma_f32_32x32x16_bf16 a[128:143], v[48:51], v[136:139], a[128:143]
    ds_read_b64_tr_b16 v[40:41], v28 offset:53248
    ds_read_b64_tr_b16 v[42:43], v28 offset:54272
    v_mfma_f32_32x32x16_bf16 a[144:159], v[52:55], v[136:139], a[144:159]
    ds_read_b64_tr_b16 v[44:45], v29 offset:53248
    ds_read_b64_tr_b16 v[46:47], v29 offset:54272
    v_mfma_f32_32x32x16_bf16 a[160:175], v[48:51], v[140:143], a[160:175]
    buffer_load_dwordx4 v[104:107], v86, s[12:15], s76 offen offset:2048 sc1
    v_mfma_f32_32x32x16_bf16 a[176:191], v[52:55], v[140:143], a[176:191]
    buffer_load_dwordx4 v[108:111], v87, s[12:15], s76 offen offset:2048 sc1
    s_add_u32 s76, s76, 4096
    s_waitcnt vmcnt(11)
    s_waitcnt lgkmcnt(0)
    v_mfma_f32_32x32x16_bf16 a[128:143], v[40:43], v[144:147], a[128:143]
    ds_read_b64_tr_b16 v[48:49], v28 offset:55296
    ds_read_b64_tr_b16 v[50:51], v28 offset:56320
    v_mfma_f32_32x32x16_bf16 a[144:159], v[44:47], v[144:147], a[144:159]
    ds_read_b64_tr_b16 v[52:53], v29 offset:55296
    ds_read_b64_tr_b16 v[54:55], v29 offset:56320
    s_waitcnt vmcnt(6)
    s_mov_b32 s83, 200000
    s_branch Lpchk_23
Lpoll_21:
    buffer_load_dword v92, v90, s[12:15], s74 offen sc1
    s_waitcnt vmcnt(0)
Lpchk_23:
    v_cmp_ne_u32 vcc, 0, v92
    s_nop 1
    s_cmp_eq_u64 vcc, -1
    s_cbranch_scc1 Lpdone_22
    s_sub_u32 s83, s83, 1
    s_cbranch_scc1 Lpdone_22
    s_sleep 1
    s_branch Lpoll_21
Lpdone_22:
    v_mfma_f32_32x32x16_bf16 a[160:175], v[40:43], v[148:151], a[160:175]
    buffer_load_dwordx4 v[112:115], v84, s[12:15], s73 offen offset:0 sc1
    v_mfma_f32_32x32x16_bf16 a[176:191], v[44:47], v[148:151], a[176:191]
    buffer_load_dwordx4 v[116:119], v85, s[12:15], s73 offen offset:0 sc1
    s_waitcnt lgkmcnt(0)
    v_mfma_f32_32x32x16_bf16 a[128:143], v[48:51], v[152:155], a[128:143]
    ds_read_b64_tr_b16 v[40:41], v28 offset:57344
    ds_read_b64_tr_b16 v[42:43], v28 offset:58368
    v_mfma_f32_32x32x16_bf16 a[144:159], v[52:55], v[152:155], a[144:159]
    ds_read_b64_tr_b16 v[44:45], v29 offset:57344
    ds_read_b64_tr_b16 v[46:47], v29 offset:58368
    v_mfma_f32_32x32x16_bf16 a[160:175], v[48:51], v[156:159], a[160:175]
    buffer_load_dwordx4 v[120:123], v84, s[12:15], s73 offen offset:2048 sc1
    v_mfma_f32_32x32x16_bf16 a[176:191], v[52:55], v[156:159], a[176:191]
    buffer_load_dwordx4 v[124:127], v85, s[12:15], s73 offen offset:2048 sc1
    s_add_u32 s73, s73, 4096
    s_waitcnt lgkmcnt(0)
    v_mfma_f32_32x32x16_bf16 a[128:143], v[40:43], v[160:163], a[128:143]
    ds_read_b64_tr_b16 v[48:49], v28 offset:59392
    ds_read_b64_tr_b16 v[50:51], v28 offset:60416
    v_mfma_f32_32x32x16_bf16 a[144:159], v[44:47], v[160:163], a[144:159]
    ds_read_b64_tr_b16 v[52:53], v29 offset:59392
    ds_read_b64_tr_b16 v[54:55], v29 offset:60416
    v_mfma_f32_32x32x16_bf16 a[160:175], v[40:43], v[164:167], a[160:175]
    buffer_load_dwordx4 v[128:131], v84, s[12:15], s73 offen offset:0 sc1
    v_mfma_f32_32x32x16_bf16 a[176:191], v[44:47], v[164:167], a[176:191]
    buffer_load_dwordx4 v[132:135], v85, s[12:15], s73 offen offset:0 sc1
    s_waitcnt vmcnt(10)
    s_waitcnt lgkmcnt(0)
    v_mfma_f32_32x32x16_bf16 a[128:143], v[48:51], v[168:171], a[128:143]
    ds_read_b64_tr_b16 v[40:41], v30 offset:0
    ds_read_b64_tr_b16 v[42:43], v30 offset:1024
    v_mfma_f32_32x32x16_bf16 a[144:159], v[52:55], v[168:171], a[144:159]
    ds_read_b64_tr_b16 v[44:45], v31 offset:0
    ds_read_b64_tr_b16 v[46:47], v31 offset:1024
    v_mfma_f32_32x32x16_bf16 a[160:175], v[48:51], v[172:175], a[160:175]
    buffer_load_dwordx4 v[136:139], v84, s[12:15], s73 offen offset:2048 sc1
    v_mfma_f32_32x32x16_bf16 a[176:191], v[52:55], v[172:175], a[176:191]
    buffer_load_dwordx4 v[140:143], v85, s[12:15], s73 offen offset:2048 sc1
    s_add_u32 s73, s73, 4096
    s_waitcnt vmcnt(10)
    s_waitcnt lgkmcnt(0)
    v_mfma_f32_32x32x16_bf16 a[128:143], v[40:43], v[96:99], a[128:143]
    ds_read_b64_tr_b16 v[48:49], v30 offset:2048
    ds_read_b64_tr_b16 v[50:51], v30 offset:3072
    v_mfma_f32_32x32x16_bf16 a[144:159], v[44:47], v[96:99], a[144:159]
    ds_read_b64_tr_b16 v[52:53], v31 offset:2048
    ds_read_b64_tr_b16 v[54:55], v31 offset:3072
    v_mfma_f32_32x32x16_bf16 a[160:175], v[40:43], v[100:103], a[160:175]
    buffer_load_dwordx4 v[144:147], v84, s[12:15], s73 offen offset:0 sc1
    v_mfma_f32_32x32x16_bf16 a[176:191], v[44:47], v[100:103], a[176:191]
    buffer_load_dwordx4 v[148:151], v85, s[12:15], s73 offen offset:0 sc1
    s_waitcnt vmcnt(10)
    s_waitcnt lgkmcnt(0)
    v_mfma_f32_32x32x16_bf16 a[128:143], v[48:51], v[104:107], a[128:143]
    v_mfma_f32_32x32x16_bf16 a[144:159], v[52:55], v[104:107], a[144:159]
    v_mfma_f32_32x32x16_bf16 a[160:175], v[48:51], v[108:111], a[160:175]
    buffer_load_dwordx4 v[152:155], v84, s[12:15], s73 offen offset:2048 sc1
    v_mfma_f32_32x32x16_bf16 a[176:191], v[52:55], v[108:111], a[176:191]
    buffer_load_dwordx4 v[156:159], v85, s[12:15], s73 offen offset:2048 sc1
    s_add_u32 s73, s73, 4096
    s_waitcnt vmcnt(10)
    v_mfma_f32_32x32x16_bf16 a[192:207], a[0:3], v[112:115], 0
    s_nop 5
    ds_write_b128 v32, a[144:147] offset:0
    ds_write_b128 v32, a[148:151] offset:1024
    v_mfma_f32_32x32x16_bf16 a[208:223], a[4:7], v[112:115], 0
    buffer_load_dwordx4 v[160:163], v84, s[12:15], s73 offen offset:0 sc1
    ds_write_b128 v32, a[152:155] offset:2048
    ds_write_b128 v32, a[156:159] offset:3072
    v_mfma_f32_32x32x16_bf16 a[224:239], a[0:3], v[116:119], 0
    ds_write_b128 v33, a[160:163] offset:0
    ds_write_b128 v33, a[164:167] offset:1024
    v_mfma_f32_32x32x16_bf16 a[240:255], a[4:7], v[116:119], 0
    buffer_load_dwordx4 v[164:167], v85, s[12:15], s73 offen offset:0 sc1
    ds_write_b128 v33, a[168:171] offset:2048
    ds_write_b128 v33, a[172:175] offset:3072
    s_waitcnt vmcnt(10)
    v_mfma_f32_32x32x16_bf16 a[192:207], a[8:11], v[120:123], a[192:207]
    ds_write_b128 v34, a[176:179] offset:0
    ds_write_b128 v34, a[180:183] offset:1024
    v_mfma_f32_32x32x16_bf16 a[208:223], a[12:15], v[120:123], a[208:223]
    buffer_load_dwordx4 v[168:171], v84, s[12:15], s73 offen offset:2048 sc1
    ds_write_b128 v34, a[184:187] offset:2048
    ds_write_b128 v34, a[188:191] offset:3072
    v_mfma_f32_32x32x16_bf16 a[224:239], a[8:11], v[124:127], a[224:239]
    v_accvgpr_read_b32 v208, a128
    v_accvgpr_read_b32 v209, a129
    v_accvgpr_read_b32 v210, a130
    v_accvgpr_read_b32 v211, a131
    v_mfma_f32_32x32x16_bf16 a[240:255], a[12:15], v[124:127], a[240:255]
    buffer_load_dwordx4 v[172:175], v85, s[12:15], s73 offen offset:2048 sc1
    s_add_u32 s73, s73, 4096
    v_accvgpr_read_b32 v212, a132
    v_accvgpr_read_b32 v213, a133
    s_waitcnt vmcnt(10)
    v_mfma_f32_32x32x16_bf16 a[192:207], a[16:19], v[128:131], a[192:207]
    v_accvgpr_read_b32 v214, a134
    v_accvgpr_read_b32 v215, a135
    v_accvgpr_read_b32 v216, a136
    v_accvgpr_read_b32 v217, a137
    v_mfma_f32_32x32x16_bf16 a[208:223], a[20:23], v[128:131], a[208:223]
    buffer_load_dwordx4 v[96:99], v84, s[12:15], s73 offen offset:0 sc1
    v_accvgpr_read_b32 v218, a138
    v_accvgpr_read_b32 v219, a139
    v_accvgpr_read_b32 v220, a140
    v_mfma_f32_32x32x16_bf16 a[224:239], a[16:19], v[132:135], a[224:239]
    v_accvgpr_read_b32 v221, a141
    v_accvgpr_read_b32 v222, a142
    v_accvgpr_read_b32 v223, a143
    s_waitcnt lgkmcnt(0)
    v_mfma_f32_32x32x16_bf16 a[240:255], a[20:23], v[132:135], a[240:255]
    buffer_load_dwordx4 v[100:103], v85, s[12:15], s73 offen offset:0 sc1
    s_barrier
    ds_read_b128 v[56:59], v35 offset:4096
    ds_read_b128 v[60:63], v35 offset:5120
    s_waitcnt vmcnt(10)
    v_mfma_f32_32x32x16_bf16 a[192:207], a[24:27], v[136:139], a[192:207]
    ds_read_b128 v[64:67], v35 offset:6144
    ds_read_b128 v[68:71], v35 offset:7168
    ds_read_b128 v[224:227], v35 offset:8192
    ds_read_b128 v[228:231], v35 offset:9216
    v_mfma_f32_32x32x16_bf16 a[208:223], a[28:31], v[136:139], a[208:223]
    buffer_load_dwordx4 v[104:107], v84, s[12:15], s73 offen offset:2048 sc1
    ds_read_b128 v[232:235], v35 offset:10240
    ds_read_b128 v[236:239], v35 offset:11264
    ds_read_b128 v[240:243], v36 offset:0
    v_mfma_f32_32x32x16_bf16 a[224:239], a[24:27], v[140:143], a[224:239]
    ds_read_b128 v[244:247], v36 offset:1024
    ds_read_b128 v[248:251], v36 offset:2048
    ds_read_b128 v[252:255], v36 offset:3072
    s_waitcnt lgkmcnt(8)
    v_mfma_f32_32x32x16_bf16 a[240:255], a[28:31], v[140:143], a[240:255]
    buffer_load_dwordx4 v[108:111], v85, s[12:15], s73 offen offset:2048 sc1
    s_add_u32 s73, s73, 4096
    v_add_f32 v208, v208, v56
    v_add_f32 v209, v209, v57
    s_waitcnt vmcnt(10)
    v_mfma_f32_32x32x16_bf16 a[192:207], a[32:35], v[144:147], a[192:207]
    v_add_f32 v210, v210, v58
    v_add_f32 v211, v211, v59
    v_add_f32 v212, v212, v60
    v_add_f32 v213, v213, v61
    v_mfma_f32_32x32x16_bf16 a[208:223], a[36:39], v[144:147], a[208:223]
    buffer_load_dwordx4 v[112:115], v84, s[12:15], s73 offen offset:0 sc1
    v_add_f32 v214, v214, v62
    v_add_f32 v215, v215, v63
    v_add_f32 v216, v216, v64
    v_mfma_f32_32x32x16_bf16 a[224:239], a[32:35], v[148:151], a[224:239]
    v_add_f32 v217, v217, v65
    v_add_f32 v218, v218, v66
    v_add_f32 v219, v219, v67
    v_add_f32 v220, v220, v68
    v_mfma_f32_32x32x16_bf16 a[240:255], a[36:39], v[148:151], a[240:255]
    buffer_load_dwordx4 v[116:119], v85, s[12:15], s73 offen offset:0 sc1
    v_add_f32 v221, v221, v69
    v_add_f32 v222, v222, v70
    v_add_f32 v223, v223, v71
    s_waitcnt vmcnt(10)
    v_mfma_f32_32x32x16_bf16 a[192:207], a[40:43], v[152:155], a[192:207]
    s_waitcnt lgkmcnt(4)
    v_add_f32 v208, v208, v224
    v_add_f32 v209, v209, v225
    v_add_f32 v210, v210, v226
    v_mfma_f32_32x32x16_bf16 a[208:223], a[44:47], v[152:155], a[208:223]
    buffer_load_dwordx4 v[120:123], v84, s[12:15], s73 offen offset:2048 sc1
    v_add_f32 v211, v211, v227
    v_add_f32 v212, v212, v228
    v_add_f32 v213, v213, v229
    v_mfma_f32_32x32x16_bf16 a[224:239], a[40:43], v[156:159], a[224:239]
    v_add_f32 v214, v214, v230
    v_add_f32 v215, v215, v231
    v_add_f32 v216, v216, v232
    v_add_f32 v217, v217, v233
    v_mfma_f32_32x32x16_bf16 a[240:255], a[44:47], v[156:159], a[240:255]
    buffer_load_dwordx4 v[124:127], v85, s[12:15], s73 offen offset:2048 sc1
    s_add_u32 s73, s73, 4096
    v_add_f32 v218, v218, v234
    v_add_f32 v219, v219, v235
    s_waitcnt vmcnt(10)
    v_mfma_f32_32x32x16_bf16 a[192:207], a[48:51], v[160:163], a[192:207]
    v_add_f32 v220, v220, v236
    v_add_f32 v221, v221, v237
    v_add_f32 v222, v222, v238
    v_add_f32 v223, v223, v239
    v_mfma_f32_32x32x16_bf16 a[208:223], a[52:55], v[160:163], a[208:223]
    buffer_load_dwordx4 v[128:131], v84, s[12:15], s73 offen offset:0 sc1
    s_waitcnt lgkmcnt(0)
    v_add_f32 v208, v208, v240
    v_add_f32 v209, v209, v241
    v_mfma_f32_32x32x16_bf16 a[224:239], a[48:51], v[164:167], a[224:239]
    v_add_f32 v210, v210, v242
    v_add_f32 v211, v211, v243
    v_add_f32 v212, v212, v244
    v_add_f32 v213, v213, v245
    v_mfma_f32_32x32x16_bf16 a[240:255], a[52:55], v[164:167], a[240:255]
    buffer_load_dwordx4 v[132:135], v85, s[12:15], s73 offen offset:0 sc1
    v_add_f32 v214, v214, v246
    v_add_f32 v215, v215, v247
    v_add_f32 v216, v216, v248
    s_waitcnt vmcnt(10)
    v_mfma_f32_32x32x16_bf16 a[192:207], a[56:59], v[168:171], a[192:207]
    v_add_f32 v217, v217, v249
    v_add_f32 v218, v218, v250
    v_add_f32 v219, v219, v251
    v_add_f32 v220, v220, v252
    v_mfma_f32_32x32x16_bf16 a[208:223], a[60:63], v[168:171], a[208:223]
    buffer_load_dwordx4 v[136:139], v84, s[12:15], s73 offen offset:2048 sc1
    v_add_f32 v221, v221, v253
    v_add_f32 v222, v222, v254
    v_add_f32 v223, v223, v255
    v_mfma_f32_32x32x16_bf16 a[224:239], a[56:59], v[172:175], a[224:239]
    s_mov_b32 s79, 0xbfb8aa3b
    v_mul_f32 v40, s79, v208
    v_mul_f32 v41, s79, v209
    v_mul_f32 v42, s79, v210
    v_mfma_f32_32x32x16_bf16 a[240:255], a[60:63], v[172:175], a[240:255]
    buffer_load_dwordx4 v[140:143], v85, s[12:15], s73 offen offset:2048 sc1
    s_add_u32 s73, s73, 4096
    v_mul_f32 v43, s79, v211
    v_mul_f32 v44, s79, v212
    s_waitcnt vmcnt(10)
    v_mfma_f32_32x32x16_bf16 a[192:207], a[64:67], v[96:99], a[192:207]
    v_mul_f32 v45, s79, v213
    v_mul_f32 v46, s79, v214
    v_mul_f32 v47, s79, v215
    v_mul_f32 v48, s79, v216
    v_mfma_f32_32x32x16_bf16 a[208:223], a[68:71], v[96:99], a[208:223]
    buffer_load_dwordx4 v[144:147], v84, s[12:15], s73 offen offset:0 sc1
    v_mul_f32 v49, s79, v217
    v_mul_f32 v50, s79, v218
    v_mul_f32 v51, s79, v219
    v_mfma_f32_32x32x16_bf16 a[224:239], a[64:67], v[100:103], a[224:239]
    v_mul_f32 v52, s79, v220
    v_mul_f32 v53, s79, v221
    v_mul_f32 v54, s79, v222
    v_mul_f32 v55, s79, v223
    v_mfma_f32_32x32x16_bf16 a[240:255], a[68:71], v[100:103], a[240:255]
    buffer_load_dwordx4 v[148:151], v85, s[12:15], s73 offen offset:0 sc1
    v_exp_f32 v40, v40
    v_exp_f32 v41, v41
    s_waitcnt vmcnt(10)
    v_mfma_f32_32x32x16_bf16 a[192:207], a[72:75], v[104:107], a[192:207]
    v_exp_f32 v42, v42
    v_exp_f32 v43, v43
    v_mfma_f32_32x32x16_bf16 a[208:223], a[76:79], v[104:107], a[208:223]
    buffer_load_dwordx4 v[152:155], v84, s[12:15], s73 offen offset:2048 sc1
    v_exp_f32 v44, v44
    v_exp_f32 v45, v45
    v_mfma_f32_32x32x16_bf16 a[224:239], a[72:75], v[108:111], a[224:239]
    v_exp_f32 v46, v46
    v_exp_f32 v47, v47
    v_mfma_f32_32x32x16_bf16 a[240:255], a[76:79], v[108:111], a[240:255]
    buffer_load_dwordx4 v[156:159], v85, s[12:15], s73 offen offset:2048 sc1
    s_add_u32 s73, s73, 4096
    v_exp_f32 v48, v48
    s_waitcnt vmcnt(10)
    v_mfma_f32_32x32x16_bf16 a[192:207], a[80:83], v[112:115], a[192:207]
    v_exp_f32 v49, v49
    v_exp_f32 v50, v50
    v_mfma_f32_32x32x16_bf16 a[208:223], a[84:87], v[112:115], a[208:223]
    v_exp_f32 v51, v51
    v_exp_f32 v52, v52
    v_mfma_f32_32x32x16_bf16 a[224:239], a[80:83], v[116:119], a[224:239]
    v_exp_f32 v53, v53
    v_exp_f32 v54, v54
    v_mfma_f32_32x32x16_bf16 a[240:255], a[84:87], v[116:119], a[240:255]
    v_exp_f32 v55, v55
    v_add_f32 v40, 1.0, v40
    v_add_f32 v41, 1.0, v41
    s_waitcnt vmcnt(8)
    v_mfma_f32_32x32x16_bf16 a[192:207], a[88:91], v[120:123], a[192:207]
    v_add_f32 v42, 1.0, v42
    v_add_f32 v43, 1.0, v43
    v_add_f32 v44, 1.0, v44
    v_add_f32 v45, 1.0, v45
    v_mfma_f32_32x32x16_bf16 a[208:223], a[92:95], v[120:123], a[208:223]
    v_add_f32 v46, 1.0, v46
    v_add_f32 v47, 1.0, v47
    v_add_f32 v48, 1.0, v48
    v_add_f32 v49, 1.0, v49
    v_mfma_f32_32x32x16_bf16 a[224:239], a[88:91], v[124:127], a[224:239]
    v_add_f32 v50, 1.0, v50
    v_add_f32 v51, 1.0, v51
    v_add_f32 v52, 1.0, v52
    v_add_f32 v53, 1.0, v53
    v_mfma_f32_32x32x16_bf16 a[240:255], a[92:95], v[124:127], a[240:255]
    v_add_f32 v54, 1.0, v54
    v_add_f32 v55, 1.0, v55
    v_rcp_f32 v40, v40
    s_waitcnt vmcnt(6)
    v_mfma_f32_32x32x16_bf16 a[192:207], a[96:99], v[128:131], a[192:207]
    v_rcp_f32 v41, v41
    v_rcp_f32 v42, v42
    v_mfma_f32_32x32x16_bf16 a[208:223], a[100:103], v[128:131], a[208:223]
    v_rcp_f32 v43, v43
    v_rcp_f32 v44, v44
    v_mfma_f32_32x32x16_bf16 a[224:239], a[96:99], v[132:135], a[224:239]
    v_rcp_f32 v45, v45
    v_rcp_f32 v46, v46
    v_mfma_f32_32x32x16_bf16 a[240:255], a[100:103], v[132:135], a[240:255]
    v_rcp_f32 v47, v47
    v_rcp_f32 v48, v48
    s_waitcnt vmcnt(4)
    v_mfma_f32_32x32x16_bf16 a[192:207], a[104:107], v[136:139], a[192:207]
    v_rcp_f32 v49, v49
    v_rcp_f32 v50, v50
    v_mfma_f32_32x32x16_bf16 a[208:223], a[108:111], v[136:139], a[208:223]
    v_rcp_f32 v51, v51
    v_rcp_f32 v52, v52
    v_mfma_f32_32x32x16_bf16 a[224:239], a[104:107], v[140:143], a[224:239]
    v_rcp_f32 v53, v53
    v_rcp_f32 v54, v54
    v_mfma_f32_32x32x16_bf16 a[240:255], a[108:111], v[140:143], a[240:255]
    v_rcp_f32 v55, v55
    v_mul_f32 v208, v208, v40
    v_mul_f32 v209, v209, v41
    v_mul_f32 v210, v210, v42
    v_mul_f32 v211, v211, v43
    v_mul_f32 v212, v212, v44
    v_mul_f32 v213, v213, v45
    v_mul_f32 v214, v214, v46
    v_mul_f32 v215, v215, v47
    v_mul_f32 v216, v216, v48
    v_mul_f32 v217, v217, v49
    v_mul_f32 v218, v218, v50
    v_mul_f32 v219, v219, v51
    v_mul_f32 v220, v220, v52
    v_mul_f32 v221, v221, v53
    v_mul_f32 v222, v222, v54
    v_mul_f32 v223, v223, v55
    s_waitcnt vmcnt(2)
    v_mfma_f32_32x32x16_bf16 a[208:223], a[116:119], v[144:147], a[208:223]
    v_mfma_f32_32x32x16_bf16 a[224:239], a[112:115], v[148:151], a[224:239]
    v_mfma_f32_32x32x16_bf16 a[240:255], a[116:119], v[148:151], a[240:255]
    s_waitcnt vmcnt(0)
    v_mfma_f32_32x32x16_bf16 a[208:223], a[124:127], v[152:155], a[208:223]
    v_mfma_f32_32x32x16_bf16 a[224:239], a[120:123], v[156:159], a[224:239]
    v_mfma_f32_32x32x16_bf16 a[240:255], a[124:127], v[156:159], a[240:255]
    v_mfma_f32_32x32x16_bf16 a[192:207], a[112:115], v[144:147], a[192:207]
    v_mfma_f32_32x32x16_bf16 a[192:207], a[120:123], v[152:155], a[192:207]
    s_nop 7
    ds_write_b128 v12, a[208:211] offset:0
    ds_write_b128 v12, a[212:215] offset:1024
    ds_write_b128 v12, a[216:219] offset:2048
    ds_write_b128 v12, a[220:223] offset:3072
    ds_write_b128 v13, a[224:227] offset:0
    ds_write_b128 v13, a[228:231] offset:1024
    ds_write_b128 v13, a[232:235] offset:2048
    ds_write_b128 v13, a[236:239] offset:3072
    ds_write_b128 v14, a[240:243] offset:0
    ds_write_b128 v14, a[244:247] offset:1024
    ds_write_b128 v14, a[248:251] offset:2048
    ds_write_b128 v14, a[252:255] offset:3072
    v_accvgpr_read_b32 v40, a192
    v_accvgpr_read_b32 v41, a193
    v_accvgpr_read_b32 v42, a194
    v_accvgpr_read_b32 v43, a195
    v_accvgpr_read_b32 v44, a196
    v_accvgpr_read_b32 v45, a197
    v_accvgpr_read_b32 v46, a198
    v_accvgpr_read_b32 v47, a199
    v_accvgpr_read_b32 v48, a200
    v_accvgpr_read_b32 v49, a201
    v_accvgpr_read_b32 v50, a202
    v_accvgpr_read_b32 v51, a203
    v_accvgpr_read_b32 v52, a204
    v_accvgpr_read_b32 v53, a205
    v_accvgpr_read_b32 v54, a206
    v_accvgpr_read_b32 v55, a207
    v_pk_add_f32 v[176:177], v[176:177], v[40:41]
    v_pk_add_f32 v[178:179], v[178:179], v[42:43]
    v_pk_add_f32 v[180:181], v[180:181], v[44:45]
    v_pk_add_f32 v[182:183], v[182:183], v[46:47]
    v_pk_add_f32 v[184:185], v[184:185], v[48:49]
    v_pk_add_f32 v[186:187], v[186:187], v[50:51]
    v_pk_add_f32 v[188:189], v[188:189], v[52:53]
    v_pk_add_f32 v[190:191], v[190:191], v[54:55]
    s_waitcnt lgkmcnt(0)
    s_barrier
    ds_read_b128 v[96:99], v37 offset:0
    ds_read_b128 v[112:115], v37 offset:4096
    ds_read_b128 v[128:131], v37 offset:8192
    ds_read_b128 v[100:103], v37 offset:1024
    ds_read_b128 v[116:119], v37 offset:5120
    ds_read_b128 v[132:135], v37 offset:9216
    ds_read_b128 v[104:107], v37 offset:2048
    ds_read_b128 v[120:123], v37 offset:6144
    ds_read_b128 v[136:139], v37 offset:10240
    ds_read_b128 v[108:111], v37 offset:3072
    ds_read_b128 v[124:127], v37 offset:7168
    ds_read_b128 v[140:143], v37 offset:11264
    s_waitcnt lgkmcnt(9)
    v_pk_add_f32 v[176:177], v[176:177], v[96:97]
    v_pk_add_f32 v[178:179], v[178:179], v[98:99]
    v_pk_add_f32 v[176:177], v[176:177], v[112:113]
    v_pk_add_f32 v[178:179], v[178:179], v[114:115]
    v_pk_add_f32 v[176:177], v[176:177], v[128:129]
    v_pk_add_f32 v[178:179], v[178:179], v[130:131]
    v_pk_fma_f32 v[176:177], v[176:177], v[208:209], v[192:193]
    v_pk_fma_f32 v[178:179], v[178:179], v[210:211], v[194:195]
    ds_write_b128 v8, v[176:179]
    s_waitcnt lgkmcnt(7)
    v_pk_add_f32 v[180:181], v[180:181], v[100:101]
    v_pk_add_f32 v[182:183], v[182:183], v[102:103]
    v_pk_add_f32 v[180:181], v[180:181], v[116:117]
    v_pk_add_f32 v[182:183], v[182:183], v[118:119]
    v_pk_add_f32 v[180:181], v[180:181], v[132:133]
    v_pk_add_f32 v[182:183], v[182:183], v[134:135]
    v_pk_fma_f32 v[180:181], v[180:181], v[212:213], v[196:197]
    v_pk_fma_f32 v[182:183], v[182:183], v[214:215], v[198:199]
    ds_write_b128 v9, v[180:183]
    s_waitcnt lgkmcnt(5)
    v_pk_add_f32 v[184:185], v[184:185], v[104:105]
    v_pk_add_f32 v[186:187], v[186:187], v[106:107]
    v_pk_add_f32 v[184:185], v[184:185], v[120:121]
    v_pk_add_f32 v[186:187], v[186:187], v[122:123]
    v_pk_add_f32 v[184:185], v[184:185], v[136:137]
    v_pk_add_f32 v[186:187], v[186:187], v[138:139]
    v_pk_fma_f32 v[184:185], v[184:185], v[216:217], v[200:201]
    v_pk_fma_f32 v[186:187], v[186:187], v[218:219], v[202:203]
    ds_write_b128 v10, v[184:187]
    s_waitcnt lgkmcnt(3)
    v_pk_add_f32 v[188:189], v[188:189], v[108:109]
    v_pk_add_f32 v[190:191], v[190:191], v[110:111]
    v_pk_add_f32 v[188:189], v[188:189], v[124:125]
    v_pk_add_f32 v[190:191], v[190:191], v[126:127]
    v_pk_add_f32 v[188:189], v[188:189], v[140:141]
    v_pk_add_f32 v[190:191], v[190:191], v[142:143]
    v_pk_fma_f32 v[188:189], v[188:189], v[220:221], v[204:205]
    v_pk_fma_f32 v[190:191], v[190:191], v[222:223], v[206:207]
    ds_write_b128 v11, v[188:191]
    ds_read_b128 v[144:147], v38 offset:0
    ds_read_b128 v[148:151], v38 offset:1024
    ds_read_b128 v[152:155], v38 offset:2048
    ds_read_b128 v[156:159], v38 offset:3072
    s_waitcnt lgkmcnt(3)
    buffer_store_dwordx4 v[144:147], v88, s[28:31], 0 offen sc1
    s_waitcnt lgkmcnt(2)
    buffer_store_dwordx4 v[148:151], v88, s[28:31], s96 offen sc1
    s_waitcnt lgkmcnt(1)
    buffer_store_dwordx4 v[152:155], v88, s[28:31], s97 offen sc1
    s_waitcnt lgkmcnt(0)
    buffer_store_dwordx4 v[156:159], v88, s[28:31], s98 offen sc1
L_end:
    s_endpgm
.section .rodata,"a"
.p2align 6
.amdhsa_kernel recurrent_scan__ssm_conv_s5__glu_gated_geglu__prompt_kernel
.amdhsa_next_free_vgpr 512
.amdhsa_next_free_sgpr 100
.amdhsa_accum_offset 256
.amdhsa_group_segment_fixed_size 0
.amdhsa_kernarg_size 128
.amdhsa_user_sgpr_count 2
.amdhsa_user_sgpr_kernarg_segment_ptr 1
.amdhsa_system_sgpr_workgroup_id_x 1
.amdhsa_float_denorm_mode_32 3
.end_amdhsa_kernel
```
